```python
import torch

def _softmax(x, axis=-1):
    return torch.softmax(x, dim=axis)
def _gelu(x):
    return torch.nn.functional.gelu(x, approximate="tanh")
def _silu(x):
    return torch.nn.functional.silu(x)
def _sigmoid(x):
    return torch.sigmoid(x)
def _layernorm(x, axis=-1, eps=1e-5):
    m = x.mean(dim=axis, keepdim=True)
    v = x.var(dim=axis, keepdim=True, unbiased=False)
    return (x - m) / torch.sqrt(v + eps)
def _scatter_add(tgt, idx, src, axis=0):
    return tgt.clone().index_add_(axis, idx, src)
def _segment_sum(src, seg, n):
    out = torch.zeros((n,) + src.shape[1:], dtype=src.dtype)
    return out.index_add_(0, seg, src)
def _pad(x, pw):
    flat = tuple(v for pair in reversed(pw) for v in pair)
    return torch.nn.functional.pad(x, flat)

kernel_name = 'recurrent_scan__ssm_conv_s5__glu_gated_bilinear__prompt'

def setup_inputs():

    _w = (lambda a: (lambda t: t.to(torch.bfloat16) if t.is_floating_point() else t)(torch.as_tensor(a)))
    def _A_setup():
        B, S, D = 1, 2048, 512
        P = D
        Lambda_re = -0.5 * (lambda _x: torch.exp(torch.as_tensor(_x)))((lambda *s: torch.randn(*s, dtype=torch.bfloat16) * 0.8)(P))
        Lambda_im = (lambda *s: torch.randn(*s, dtype=torch.bfloat16) * 0.8)(P) * 1.0
        B_re = (lambda *s: torch.randn(*s, dtype=torch.bfloat16) * 1.6)(P, D) * (D ** -0.5)
        B_im = (lambda *s: torch.randn(*s, dtype=torch.bfloat16) * 0.8)(P, D) * (D ** -0.5)
        C_re = (lambda *s: torch.randn(*s, dtype=torch.bfloat16) * 1.6)(D, P) * (P ** -0.5)
        C_im = (lambda *s: torch.randn(*s, dtype=torch.bfloat16) * 0.8)(D, P) * (P ** -0.5)
        log_dt = (lambda *s: torch.randn(*s, dtype=torch.bfloat16) * 0.8)(P) * 0.3 - 2.0
        Dskip = (lambda *s: torch.randn(*s, dtype=torch.bfloat16) * 0.8)(D)
        return {
            "x": _w((lambda *s: torch.randn(*s, dtype=torch.bfloat16) * 0.05)(B, S, D)),
            "Lambda_re": _w(Lambda_re),
            "Lambda_im": _w(Lambda_im),
            "B_re": _w(B_re),
            "B_im": _w(B_im),
            "C_re": _w(C_re),
            "C_im": _w(C_im),
            "log_dt": _w(log_dt),
            "Dskip": _w(Dskip),
        }
    _A_in = _A_setup()

    def _B_setup():
        B, S, D, F = 1, 2048, 512, 1792
        return {
            "x": _w((lambda *s: torch.randn(*s, dtype=torch.bfloat16) * 0.05)(B, S, D)),
            "w_gate": _w((lambda *s: torch.randn(*s, dtype=torch.bfloat16) * 0.2)(D, F) * (D ** -0.5)),
            "w_up": _w((lambda *s: torch.randn(*s, dtype=torch.bfloat16) * 0.2)(D, F) * (D ** -0.5)),
            "w_down": _w((lambda *s: torch.randn(*s, dtype=torch.bfloat16) * 0.2)(F, D) * (F ** -0.5)),
        }
    _B_in = _B_setup()

    return {
        "A_x": _A_in["x"],
        "A_Lambda_re": _A_in["Lambda_re"],
        "A_Lambda_im": _A_in["Lambda_im"],
        "A_B_re": _A_in["B_re"],
        "A_B_im": _A_in["B_im"],
        "A_C_re": _A_in["C_re"],
        "A_C_im": _A_in["C_im"],
        "A_log_dt": _A_in["log_dt"],
        "A_Dskip": _A_in["Dskip"],
        "B_x": _B_in["x"],
        "B_w_gate": _B_in["w_gate"],
        "B_w_up": _B_in["w_up"],
        "B_w_down": _B_in["w_down"],
    }

def reference(A_x, A_Lambda_re, A_Lambda_im, A_B_re, A_B_im, A_C_re, A_C_im, A_log_dt, A_Dskip, B_x, B_w_gate, B_w_up, B_w_down):
    def _A_ref(x, Lambda_re, Lambda_im, B_re, B_im, C_re, C_im, log_dt, Dskip):
        Bsz, L, H = x.shape
        Lam = Lambda_re + 1j * Lambda_im
        Bmat = B_re + 1j * B_im
        Cmat = C_re + 1j * C_im
        dt = torch.exp(log_dt)
        Lam_bar = torch.exp(dt * Lam)
        B_bar = ((Lam_bar - 1.0) / Lam)[:, None] * Bmat
        Bu = torch.einsum("bld,pd->blp", x + 0j, B_bar)
        h = torch.zeros_like(Bu[:, 0, :])
        hs = []
        for t in range(L):
            h = Lam_bar[None, :] * h + Bu[:, t, :]
            hs.append(h)
        hseq = torch.stack(hs, 1)
        y = 2.0 * torch.einsum("blp,dp->bld", hseq, Cmat).real + x * Dskip[None, None, :]
        return y

    def _B_ref(x, w_gate, w_up, w_down):
        g = torch.einsum("bsd,df->bsf", x, w_gate)
        u = torch.einsum("bsd,df->bsf", x, w_up)
        h = g * u
        return torch.einsum("bsf,fd->bsd", h, w_down)

    x = A_x
    xn = _layernorm(x, axis=-1)
    s = _A_ref(xn, A_Lambda_re, A_Lambda_im, A_B_re, A_B_im, A_C_re, A_C_im, A_log_dt, A_Dskip)
    g = _silu(_B_ref(xn, B_w_gate, B_w_up, B_w_down))
    return x + s * g
```

```asm
; @launch kernel=k0_kernel grid=(928,1,1) block=(256,1,1) lds=131584
; @launch kernel=k1_kernel grid=(256,1,1) block=(256,1,1) lds=147456
; @launch kernel=k3_kernel grid=(256,1,1) block=(256,1,1) lds=131072
.amdgcn_target "amdgcn-amd-amdhsa--gfx950"
.text
.p2align 8
.type k0_kernel,@function
k0_kernel:
    s_cmp_ge_u32 s2, 928
    s_cbranch_scc1 K0_EXIT
    s_cmp_ge_u32 s2, 256
    s_cbranch_scc1 K0_TRANS
    s_load_dwordx2 s[4:5], s[0:1], 0
    s_load_dwordx2 s[6:7], s[0:1], 8
    s_load_dwordx2 s[8:9], s[0:1], 16
    s_load_dwordx2 s[10:11], s[0:1], 24
    s_load_dwordx2 s[12:13], s[0:1], 32
    s_load_dwordx2 s[14:15], s[0:1], 56
    s_load_dwordx2 s[16:17], s[0:1], 120
    v_and_b32 v1, 63, v0
    v_lshrrev_b32 v2, 6, v0
    s_lshr_b32 s56, s2, 2
    s_and_b32 s57, s2, 3
    s_nop 0
    v_readfirstlane_b32 s58, v2
    s_waitcnt lgkmcnt(0)

    s_mov_b32 s20, s4
    s_and_b32 s21, s5, 0xffff
    s_mov_b32 s22, 0x200000
    s_mov_b32 s23, 0x20000
    s_mov_b32 s24, s16
    s_and_b32 s25, s17, 0xffff
    s_mov_b32 s26, 0x200000
    s_mov_b32 s27, 0x20000
    s_mov_b32 s28, s10
    s_and_b32 s29, s11, 0xffff
    s_mov_b32 s30, 0x80000
    s_mov_b32 s31, 0x20000
    s_mov_b32 s32, s12
    s_and_b32 s33, s13, 0xffff
    s_mov_b32 s34, 0x80000
    s_mov_b32 s35, 0x20000
    s_add_u32 s36, s16, 0x800000
    s_addc_u32 s37, s17, 0
    s_and_b32 s37, s37, 0xffff
    s_mov_b32 s38, 0x800000
    s_mov_b32 s39, 0x20000
    s_add_u32 s40, s16, 0x1000000
    s_addc_u32 s41, s17, 0
    s_and_b32 s41, s41, 0xffff
    s_mov_b32 s42, 0x40000
    s_mov_b32 s43, 0x20000
    s_mov_b32 s44, s6
    s_and_b32 s45, s7, 0xffff
    s_mov_b32 s46, 0x400
    s_mov_b32 s47, 0x20000
    s_mov_b32 s48, s8
    s_and_b32 s49, s9, 0xffff
    s_mov_b32 s50, 0x400
    s_mov_b32 s51, 0x20000
    s_mov_b32 s52, s14
    s_and_b32 s53, s15, 0xffff
    s_mov_b32 s54, 0x400
    s_mov_b32 s55, 0x20000
    s_lshl_b32 s59, s56, 5
    s_lshl_b32 s60, s58, 3
    s_add_u32 s59, s59, s60
    s_lshl_b32 s59, s59, 10
    s_add_u32 s60, s59, 4096
    v_lshlrev_b32 v3, 4, v1

    buffer_load_dwordx4 v[16:19], v3, s[20:23], s59 offen offset:0
    buffer_load_dwordx4 v[20:23], v3, s[20:23], s59 offen offset:1024
    buffer_load_dwordx4 v[24:27], v3, s[20:23], s59 offen offset:2048
    buffer_load_dwordx4 v[28:31], v3, s[20:23], s59 offen offset:3072
    buffer_load_dwordx4 v[32:35], v3, s[20:23], s60 offen offset:0
    buffer_load_dwordx4 v[36:39], v3, s[20:23], s60 offen offset:1024
    buffer_load_dwordx4 v[40:43], v3, s[20:23], s60 offen offset:2048
    buffer_load_dwordx4 v[44:47], v3, s[20:23], s60 offen offset:3072
    s_waitcnt vmcnt(7)
    v_lshlrev_b32 v48, 16, v16
    v_and_b32 v49, 0xffff0000, v16
    v_lshlrev_b32 v50, 16, v17
    v_and_b32 v51, 0xffff0000, v17
    v_lshlrev_b32 v52, 16, v18
    v_and_b32 v53, 0xffff0000, v18
    v_lshlrev_b32 v54, 16, v19
    v_and_b32 v55, 0xffff0000, v19
    v_add_f32 v112, v48, v49
    v_mul_f32 v120, v48, v48
    v_fma_f32 v120, v49, v49, v120
    v_add_f32 v112, v112, v50
    v_fma_f32 v120, v50, v50, v120
    v_add_f32 v112, v112, v51
    v_fma_f32 v120, v51, v51, v120
    v_add_f32 v112, v112, v52
    v_fma_f32 v120, v52, v52, v120
    v_add_f32 v112, v112, v53
    v_fma_f32 v120, v53, v53, v120
    v_add_f32 v112, v112, v54
    v_fma_f32 v120, v54, v54, v120
    v_add_f32 v112, v112, v55
    v_fma_f32 v120, v55, v55, v120
    s_waitcnt vmcnt(6)
    v_lshlrev_b32 v56, 16, v20
    v_and_b32 v57, 0xffff0000, v20
    v_lshlrev_b32 v58, 16, v21
    v_and_b32 v59, 0xffff0000, v21
    v_lshlrev_b32 v60, 16, v22
    v_and_b32 v61, 0xffff0000, v22
    v_lshlrev_b32 v62, 16, v23
    v_and_b32 v63, 0xffff0000, v23
    v_add_f32 v113, v56, v57
    v_mul_f32 v121, v56, v56
    v_fma_f32 v121, v57, v57, v121
    v_add_f32 v113, v113, v58
    v_fma_f32 v121, v58, v58, v121
    v_add_f32 v113, v113, v59
    v_fma_f32 v121, v59, v59, v121
    v_add_f32 v113, v113, v60
    v_fma_f32 v121, v60, v60, v121
    v_add_f32 v113, v113, v61
    v_fma_f32 v121, v61, v61, v121
    v_add_f32 v113, v113, v62
    v_fma_f32 v121, v62, v62, v121
    v_add_f32 v113, v113, v63
    v_fma_f32 v121, v63, v63, v121
    s_waitcnt vmcnt(5)
    v_lshlrev_b32 v64, 16, v24
    v_and_b32 v65, 0xffff0000, v24
    v_lshlrev_b32 v66, 16, v25
    v_and_b32 v67, 0xffff0000, v25
    v_lshlrev_b32 v68, 16, v26
    v_and_b32 v69, 0xffff0000, v26
    v_lshlrev_b32 v70, 16, v27
    v_and_b32 v71, 0xffff0000, v27
    v_add_f32 v114, v64, v65
    v_mul_f32 v122, v64, v64
    v_fma_f32 v122, v65, v65, v122
    v_add_f32 v114, v114, v66
    v_fma_f32 v122, v66, v66, v122
    v_add_f32 v114, v114, v67
    v_fma_f32 v122, v67, v67, v122
    v_add_f32 v114, v114, v68
    v_fma_f32 v122, v68, v68, v122
    v_add_f32 v114, v114, v69
    v_fma_f32 v122, v69, v69, v122
    v_add_f32 v114, v114, v70
    v_fma_f32 v122, v70, v70, v122
    v_add_f32 v114, v114, v71
    v_fma_f32 v122, v71, v71, v122
    s_waitcnt vmcnt(4)
    v_lshlrev_b32 v72, 16, v28
    v_and_b32 v73, 0xffff0000, v28
    v_lshlrev_b32 v74, 16, v29
    v_and_b32 v75, 0xffff0000, v29
    v_lshlrev_b32 v76, 16, v30
    v_and_b32 v77, 0xffff0000, v30
    v_lshlrev_b32 v78, 16, v31
    v_and_b32 v79, 0xffff0000, v31
    v_add_f32 v115, v72, v73
    v_mul_f32 v123, v72, v72
    v_fma_f32 v123, v73, v73, v123
    v_add_f32 v115, v115, v74
    v_fma_f32 v123, v74, v74, v123
    v_add_f32 v115, v115, v75
    v_fma_f32 v123, v75, v75, v123
    v_add_f32 v115, v115, v76
    v_fma_f32 v123, v76, v76, v123
    v_add_f32 v115, v115, v77
    v_fma_f32 v123, v77, v77, v123
    v_add_f32 v115, v115, v78
    v_fma_f32 v123, v78, v78, v123
    v_add_f32 v115, v115, v79
    v_fma_f32 v123, v79, v79, v123
    s_waitcnt vmcnt(3)
    v_lshlrev_b32 v80, 16, v32
    v_and_b32 v81, 0xffff0000, v32
    v_lshlrev_b32 v82, 16, v33
    v_and_b32 v83, 0xffff0000, v33
    v_lshlrev_b32 v84, 16, v34
    v_and_b32 v85, 0xffff0000, v34
    v_lshlrev_b32 v86, 16, v35
    v_and_b32 v87, 0xffff0000, v35
    v_add_f32 v116, v80, v81
    v_mul_f32 v124, v80, v80
    v_fma_f32 v124, v81, v81, v124
    v_add_f32 v116, v116, v82
    v_fma_f32 v124, v82, v82, v124
    v_add_f32 v116, v116, v83
    v_fma_f32 v124, v83, v83, v124
    v_add_f32 v116, v116, v84
    v_fma_f32 v124, v84, v84, v124
    v_add_f32 v116, v116, v85
    v_fma_f32 v124, v85, v85, v124
    v_add_f32 v116, v116, v86
    v_fma_f32 v124, v86, v86, v124
    v_add_f32 v116, v116, v87
    v_fma_f32 v124, v87, v87, v124
    s_waitcnt vmcnt(2)
    v_lshlrev_b32 v88, 16, v36
    v_and_b32 v89, 0xffff0000, v36
    v_lshlrev_b32 v90, 16, v37
    v_and_b32 v91, 0xffff0000, v37
    v_lshlrev_b32 v92, 16, v38
    v_and_b32 v93, 0xffff0000, v38
    v_lshlrev_b32 v94, 16, v39
    v_and_b32 v95, 0xffff0000, v39
    v_add_f32 v117, v88, v89
    v_mul_f32 v125, v88, v88
    v_fma_f32 v125, v89, v89, v125
    v_add_f32 v117, v117, v90
    v_fma_f32 v125, v90, v90, v125
    v_add_f32 v117, v117, v91
    v_fma_f32 v125, v91, v91, v125
    v_add_f32 v117, v117, v92
    v_fma_f32 v125, v92, v92, v125
    v_add_f32 v117, v117, v93
    v_fma_f32 v125, v93, v93, v125
    v_add_f32 v117, v117, v94
    v_fma_f32 v125, v94, v94, v125
    v_add_f32 v117, v117, v95
    v_fma_f32 v125, v95, v95, v125
    s_waitcnt vmcnt(1)
    v_lshlrev_b32 v96, 16, v40
    v_and_b32 v97, 0xffff0000, v40
    v_lshlrev_b32 v98, 16, v41
    v_and_b32 v99, 0xffff0000, v41
    v_lshlrev_b32 v100, 16, v42
    v_and_b32 v101, 0xffff0000, v42
    v_lshlrev_b32 v102, 16, v43
    v_and_b32 v103, 0xffff0000, v43
    v_add_f32 v118, v96, v97
    v_mul_f32 v126, v96, v96
    v_fma_f32 v126, v97, v97, v126
    v_add_f32 v118, v118, v98
    v_fma_f32 v126, v98, v98, v126
    v_add_f32 v118, v118, v99
    v_fma_f32 v126, v99, v99, v126
    v_add_f32 v118, v118, v100
    v_fma_f32 v126, v100, v100, v126
    v_add_f32 v118, v118, v101
    v_fma_f32 v126, v101, v101, v126
    v_add_f32 v118, v118, v102
    v_fma_f32 v126, v102, v102, v126
    v_add_f32 v118, v118, v103
    v_fma_f32 v126, v103, v103, v126
    s_waitcnt vmcnt(0)
    v_lshlrev_b32 v104, 16, v44
    v_and_b32 v105, 0xffff0000, v44
    v_lshlrev_b32 v106, 16, v45
    v_and_b32 v107, 0xffff0000, v45
    v_lshlrev_b32 v108, 16, v46
    v_and_b32 v109, 0xffff0000, v46
    v_lshlrev_b32 v110, 16, v47
    v_and_b32 v111, 0xffff0000, v47
    v_add_f32 v119, v104, v105
    v_mul_f32 v127, v104, v104
    v_fma_f32 v127, v105, v105, v127
    v_add_f32 v119, v119, v106
    v_fma_f32 v127, v106, v106, v127
    v_add_f32 v119, v119, v107
    v_fma_f32 v127, v107, v107, v127
    v_add_f32 v119, v119, v108
    v_fma_f32 v127, v108, v108, v127
    v_add_f32 v119, v119, v109
    v_fma_f32 v127, v109, v109, v127
    v_add_f32 v119, v119, v110
    v_fma_f32 v127, v110, v110, v127
    v_add_f32 v119, v119, v111
    v_fma_f32 v127, v111, v111, v127
    v_add_f32_dpp v112, v112, v112 quad_perm:[1,0,3,2] row_mask:0xf bank_mask:0xf
    v_add_f32_dpp v113, v113, v113 quad_perm:[1,0,3,2] row_mask:0xf bank_mask:0xf
    v_add_f32_dpp v114, v114, v114 quad_perm:[1,0,3,2] row_mask:0xf bank_mask:0xf
    v_add_f32_dpp v115, v115, v115 quad_perm:[1,0,3,2] row_mask:0xf bank_mask:0xf
    v_add_f32_dpp v116, v116, v116 quad_perm:[1,0,3,2] row_mask:0xf bank_mask:0xf
    v_add_f32_dpp v117, v117, v117 quad_perm:[1,0,3,2] row_mask:0xf bank_mask:0xf
    v_add_f32_dpp v118, v118, v118 quad_perm:[1,0,3,2] row_mask:0xf bank_mask:0xf
    v_add_f32_dpp v119, v119, v119 quad_perm:[1,0,3,2] row_mask:0xf bank_mask:0xf
    v_add_f32_dpp v120, v120, v120 quad_perm:[1,0,3,2] row_mask:0xf bank_mask:0xf
    v_add_f32_dpp v121, v121, v121 quad_perm:[1,0,3,2] row_mask:0xf bank_mask:0xf
    v_add_f32_dpp v122, v122, v122 quad_perm:[1,0,3,2] row_mask:0xf bank_mask:0xf
    v_add_f32_dpp v123, v123, v123 quad_perm:[1,0,3,2] row_mask:0xf bank_mask:0xf
    v_add_f32_dpp v124, v124, v124 quad_perm:[1,0,3,2] row_mask:0xf bank_mask:0xf
    v_add_f32_dpp v125, v125, v125 quad_perm:[1,0,3,2] row_mask:0xf bank_mask:0xf
    v_add_f32_dpp v126, v126, v126 quad_perm:[1,0,3,2] row_mask:0xf bank_mask:0xf
    v_add_f32_dpp v127, v127, v127 quad_perm:[1,0,3,2] row_mask:0xf bank_mask:0xf
    v_add_f32_dpp v112, v112, v112 quad_perm:[2,3,0,1] row_mask:0xf bank_mask:0xf
    v_add_f32_dpp v113, v113, v113 quad_perm:[2,3,0,1] row_mask:0xf bank_mask:0xf
    v_add_f32_dpp v114, v114, v114 quad_perm:[2,3,0,1] row_mask:0xf bank_mask:0xf
    v_add_f32_dpp v115, v115, v115 quad_perm:[2,3,0,1] row_mask:0xf bank_mask:0xf
    v_add_f32_dpp v116, v116, v116 quad_perm:[2,3,0,1] row_mask:0xf bank_mask:0xf
    v_add_f32_dpp v117, v117, v117 quad_perm:[2,3,0,1] row_mask:0xf bank_mask:0xf
    v_add_f32_dpp v118, v118, v118 quad_perm:[2,3,0,1] row_mask:0xf bank_mask:0xf
    v_add_f32_dpp v119, v119, v119 quad_perm:[2,3,0,1] row_mask:0xf bank_mask:0xf
    v_add_f32_dpp v120, v120, v120 quad_perm:[2,3,0,1] row_mask:0xf bank_mask:0xf
    v_add_f32_dpp v121, v121, v121 quad_perm:[2,3,0,1] row_mask:0xf bank_mask:0xf
    v_add_f32_dpp v122, v122, v122 quad_perm:[2,3,0,1] row_mask:0xf bank_mask:0xf
    v_add_f32_dpp v123, v123, v123 quad_perm:[2,3,0,1] row_mask:0xf bank_mask:0xf
    v_add_f32_dpp v124, v124, v124 quad_perm:[2,3,0,1] row_mask:0xf bank_mask:0xf
    v_add_f32_dpp v125, v125, v125 quad_perm:[2,3,0,1] row_mask:0xf bank_mask:0xf
    v_add_f32_dpp v126, v126, v126 quad_perm:[2,3,0,1] row_mask:0xf bank_mask:0xf
    v_add_f32_dpp v127, v127, v127 quad_perm:[2,3,0,1] row_mask:0xf bank_mask:0xf
    v_add_f32_dpp v112, v112, v112 row_ror:4 row_mask:0xf bank_mask:0xf
    v_add_f32_dpp v113, v113, v113 row_ror:4 row_mask:0xf bank_mask:0xf
    v_add_f32_dpp v114, v114, v114 row_ror:4 row_mask:0xf bank_mask:0xf
    v_add_f32_dpp v115, v115, v115 row_ror:4 row_mask:0xf bank_mask:0xf
    v_add_f32_dpp v116, v116, v116 row_ror:4 row_mask:0xf bank_mask:0xf
    v_add_f32_dpp v117, v117, v117 row_ror:4 row_mask:0xf bank_mask:0xf
    v_add_f32_dpp v118, v118, v118 row_ror:4 row_mask:0xf bank_mask:0xf
    v_add_f32_dpp v119, v119, v119 row_ror:4 row_mask:0xf bank_mask:0xf
    v_add_f32_dpp v120, v120, v120 row_ror:4 row_mask:0xf bank_mask:0xf
    v_add_f32_dpp v121, v121, v121 row_ror:4 row_mask:0xf bank_mask:0xf
    v_add_f32_dpp v122, v122, v122 row_ror:4 row_mask:0xf bank_mask:0xf
    v_add_f32_dpp v123, v123, v123 row_ror:4 row_mask:0xf bank_mask:0xf
    v_add_f32_dpp v124, v124, v124 row_ror:4 row_mask:0xf bank_mask:0xf
    v_add_f32_dpp v125, v125, v125 row_ror:4 row_mask:0xf bank_mask:0xf
    v_add_f32_dpp v126, v126, v126 row_ror:4 row_mask:0xf bank_mask:0xf
    v_add_f32_dpp v127, v127, v127 row_ror:4 row_mask:0xf bank_mask:0xf
    v_add_f32_dpp v112, v112, v112 row_ror:8 row_mask:0xf bank_mask:0xf
    v_add_f32_dpp v113, v113, v113 row_ror:8 row_mask:0xf bank_mask:0xf
    v_add_f32_dpp v114, v114, v114 row_ror:8 row_mask:0xf bank_mask:0xf
    v_add_f32_dpp v115, v115, v115 row_ror:8 row_mask:0xf bank_mask:0xf
    v_add_f32_dpp v116, v116, v116 row_ror:8 row_mask:0xf bank_mask:0xf
    v_add_f32_dpp v117, v117, v117 row_ror:8 row_mask:0xf bank_mask:0xf
    v_add_f32_dpp v118, v118, v118 row_ror:8 row_mask:0xf bank_mask:0xf
    v_add_f32_dpp v119, v119, v119 row_ror:8 row_mask:0xf bank_mask:0xf
    v_add_f32_dpp v120, v120, v120 row_ror:8 row_mask:0xf bank_mask:0xf
    v_add_f32_dpp v121, v121, v121 row_ror:8 row_mask:0xf bank_mask:0xf
    v_add_f32_dpp v122, v122, v122 row_ror:8 row_mask:0xf bank_mask:0xf
    v_add_f32_dpp v123, v123, v123 row_ror:8 row_mask:0xf bank_mask:0xf
    v_add_f32_dpp v124, v124, v124 row_ror:8 row_mask:0xf bank_mask:0xf
    v_add_f32_dpp v125, v125, v125 row_ror:8 row_mask:0xf bank_mask:0xf
    v_add_f32_dpp v126, v126, v126 row_ror:8 row_mask:0xf bank_mask:0xf
    v_add_f32_dpp v127, v127, v127 row_ror:8 row_mask:0xf bank_mask:0xf
    v_mov_b32 v128, v112
    v_mov_b32 v129, v113
    v_mov_b32 v130, v114
    v_mov_b32 v131, v115
    v_mov_b32 v132, v116
    v_mov_b32 v133, v117
    v_mov_b32 v134, v118
    v_mov_b32 v135, v119
    v_mov_b32 v136, v120
    v_mov_b32 v137, v121
    v_mov_b32 v138, v122
    v_mov_b32 v139, v123
    v_mov_b32 v140, v124
    v_mov_b32 v141, v125
    v_mov_b32 v142, v126
    v_mov_b32 v143, v127
    s_nop 1
    v_permlane16_swap_b32 v112, v128
    v_permlane16_swap_b32 v113, v129
    v_permlane16_swap_b32 v114, v130
    v_permlane16_swap_b32 v115, v131
    v_permlane16_swap_b32 v116, v132
    v_permlane16_swap_b32 v117, v133
    v_permlane16_swap_b32 v118, v134
    v_permlane16_swap_b32 v119, v135
    v_permlane16_swap_b32 v120, v136
    v_permlane16_swap_b32 v121, v137
    v_permlane16_swap_b32 v122, v138
    v_permlane16_swap_b32 v123, v139
    v_permlane16_swap_b32 v124, v140
    v_permlane16_swap_b32 v125, v141
    v_permlane16_swap_b32 v126, v142
    v_permlane16_swap_b32 v127, v143
    v_add_f32 v112, v112, v128
    v_add_f32 v113, v113, v129
    v_add_f32 v114, v114, v130
    v_add_f32 v115, v115, v131
    v_add_f32 v116, v116, v132
    v_add_f32 v117, v117, v133
    v_add_f32 v118, v118, v134
    v_add_f32 v119, v119, v135
    v_add_f32 v120, v120, v136
    v_add_f32 v121, v121, v137
    v_add_f32 v122, v122, v138
    v_add_f32 v123, v123, v139
    v_add_f32 v124, v124, v140
    v_add_f32 v125, v125, v141
    v_add_f32 v126, v126, v142
    v_add_f32 v127, v127, v143
    v_mov_b32 v128, v112
    v_mov_b32 v129, v113
    v_mov_b32 v130, v114
    v_mov_b32 v131, v115
    v_mov_b32 v132, v116
    v_mov_b32 v133, v117
    v_mov_b32 v134, v118
    v_mov_b32 v135, v119
    v_mov_b32 v136, v120
    v_mov_b32 v137, v121
    v_mov_b32 v138, v122
    v_mov_b32 v139, v123
    v_mov_b32 v140, v124
    v_mov_b32 v141, v125
    v_mov_b32 v142, v126
    v_mov_b32 v143, v127
    s_nop 1
    v_permlane32_swap_b32 v112, v128
    v_permlane32_swap_b32 v113, v129
    v_permlane32_swap_b32 v114, v130
    v_permlane32_swap_b32 v115, v131
    v_permlane32_swap_b32 v116, v132
    v_permlane32_swap_b32 v117, v133
    v_permlane32_swap_b32 v118, v134
    v_permlane32_swap_b32 v119, v135
    v_permlane32_swap_b32 v120, v136
    v_permlane32_swap_b32 v121, v137
    v_permlane32_swap_b32 v122, v138
    v_permlane32_swap_b32 v123, v139
    v_permlane32_swap_b32 v124, v140
    v_permlane32_swap_b32 v125, v141
    v_permlane32_swap_b32 v126, v142
    v_permlane32_swap_b32 v127, v143
    v_add_f32 v112, v112, v128
    v_add_f32 v113, v113, v129
    v_add_f32 v114, v114, v130
    v_add_f32 v115, v115, v131
    v_add_f32 v116, v116, v132
    v_add_f32 v117, v117, v133
    v_add_f32 v118, v118, v134
    v_add_f32 v119, v119, v135
    v_add_f32 v120, v120, v136
    v_add_f32 v121, v121, v137
    v_add_f32 v122, v122, v138
    v_add_f32 v123, v123, v139
    v_add_f32 v124, v124, v140
    v_add_f32 v125, v125, v141
    v_add_f32 v126, v126, v142
    v_add_f32 v127, v127, v143
    v_mov_b32 v144, 0x3b000000
    v_mul_f32 v112, v112, v144
    v_mul_f32 v120, v120, v144
    v_fma_f32 v120, -v112, v112, v120
    v_max_f32 v120, 0, v120
    v_cvt_pk_bf16_f32 v112, v112, v112
    v_lshlrev_b32 v112, 16, v112
    v_cvt_pk_bf16_f32 v120, v120, v120
    v_lshlrev_b32 v120, 16, v120
    v_add_f32 v120, 0x3727c5ac, v120
    v_cvt_pk_bf16_f32 v120, v120, v120
    v_lshlrev_b32 v120, 16, v120
    v_sqrt_f32 v120, v120
    s_nop 0
    v_cvt_pk_bf16_f32 v120, v120, v120
    v_lshlrev_b32 v120, 16, v120
    v_rcp_f32 v120, v120
    v_mul_f32 v113, v113, v144
    v_mul_f32 v121, v121, v144
    v_fma_f32 v121, -v113, v113, v121
    v_max_f32 v121, 0, v121
    v_cvt_pk_bf16_f32 v113, v113, v113
    v_lshlrev_b32 v113, 16, v113
    v_cvt_pk_bf16_f32 v121, v121, v121
    v_lshlrev_b32 v121, 16, v121
    v_add_f32 v121, 0x3727c5ac, v121
    v_cvt_pk_bf16_f32 v121, v121, v121
    v_lshlrev_b32 v121, 16, v121
    v_sqrt_f32 v121, v121
    s_nop 0
    v_cvt_pk_bf16_f32 v121, v121, v121
    v_lshlrev_b32 v121, 16, v121
    v_rcp_f32 v121, v121
    v_mul_f32 v114, v114, v144
    v_mul_f32 v122, v122, v144
    v_fma_f32 v122, -v114, v114, v122
    v_max_f32 v122, 0, v122
    v_cvt_pk_bf16_f32 v114, v114, v114
    v_lshlrev_b32 v114, 16, v114
    v_cvt_pk_bf16_f32 v122, v122, v122
    v_lshlrev_b32 v122, 16, v122
    v_add_f32 v122, 0x3727c5ac, v122
    v_cvt_pk_bf16_f32 v122, v122, v122
    v_lshlrev_b32 v122, 16, v122
    v_sqrt_f32 v122, v122
    s_nop 0
    v_cvt_pk_bf16_f32 v122, v122, v122
    v_lshlrev_b32 v122, 16, v122
    v_rcp_f32 v122, v122
    v_mul_f32 v115, v115, v144
    v_mul_f32 v123, v123, v144
    v_fma_f32 v123, -v115, v115, v123
    v_max_f32 v123, 0, v123
    v_cvt_pk_bf16_f32 v115, v115, v115
    v_lshlrev_b32 v115, 16, v115
    v_cvt_pk_bf16_f32 v123, v123, v123
    v_lshlrev_b32 v123, 16, v123
    v_add_f32 v123, 0x3727c5ac, v123
    v_cvt_pk_bf16_f32 v123, v123, v123
    v_lshlrev_b32 v123, 16, v123
    v_sqrt_f32 v123, v123
    s_nop 0
    v_cvt_pk_bf16_f32 v123, v123, v123
    v_lshlrev_b32 v123, 16, v123
    v_rcp_f32 v123, v123
    v_mul_f32 v116, v116, v144
    v_mul_f32 v124, v124, v144
    v_fma_f32 v124, -v116, v116, v124
    v_max_f32 v124, 0, v124
    v_cvt_pk_bf16_f32 v116, v116, v116
    v_lshlrev_b32 v116, 16, v116
    v_cvt_pk_bf16_f32 v124, v124, v124
    v_lshlrev_b32 v124, 16, v124
    v_add_f32 v124, 0x3727c5ac, v124
    v_cvt_pk_bf16_f32 v124, v124, v124
    v_lshlrev_b32 v124, 16, v124
    v_sqrt_f32 v124, v124
    s_nop 0
    v_cvt_pk_bf16_f32 v124, v124, v124
    v_lshlrev_b32 v124, 16, v124
    v_rcp_f32 v124, v124
    v_mul_f32 v117, v117, v144
    v_mul_f32 v125, v125, v144
    v_fma_f32 v125, -v117, v117, v125
    v_max_f32 v125, 0, v125
    v_cvt_pk_bf16_f32 v117, v117, v117
    v_lshlrev_b32 v117, 16, v117
    v_cvt_pk_bf16_f32 v125, v125, v125
    v_lshlrev_b32 v125, 16, v125
    v_add_f32 v125, 0x3727c5ac, v125
    v_cvt_pk_bf16_f32 v125, v125, v125
    v_lshlrev_b32 v125, 16, v125
    v_sqrt_f32 v125, v125
    s_nop 0
    v_cvt_pk_bf16_f32 v125, v125, v125
    v_lshlrev_b32 v125, 16, v125
    v_rcp_f32 v125, v125
    v_mul_f32 v118, v118, v144
    v_mul_f32 v126, v126, v144
    v_fma_f32 v126, -v118, v118, v126
    v_max_f32 v126, 0, v126
    v_cvt_pk_bf16_f32 v118, v118, v118
    v_lshlrev_b32 v118, 16, v118
    v_cvt_pk_bf16_f32 v126, v126, v126
    v_lshlrev_b32 v126, 16, v126
    v_add_f32 v126, 0x3727c5ac, v126
    v_cvt_pk_bf16_f32 v126, v126, v126
    v_lshlrev_b32 v126, 16, v126
    v_sqrt_f32 v126, v126
    s_nop 0
    v_cvt_pk_bf16_f32 v126, v126, v126
    v_lshlrev_b32 v126, 16, v126
    v_rcp_f32 v126, v126
    v_mul_f32 v119, v119, v144
    v_mul_f32 v127, v127, v144
    v_fma_f32 v127, -v119, v119, v127
    v_max_f32 v127, 0, v127
    v_cvt_pk_bf16_f32 v119, v119, v119
    v_lshlrev_b32 v119, 16, v119
    v_cvt_pk_bf16_f32 v127, v127, v127
    v_lshlrev_b32 v127, 16, v127
    v_add_f32 v127, 0x3727c5ac, v127
    v_cvt_pk_bf16_f32 v127, v127, v127
    v_lshlrev_b32 v127, 16, v127
    v_sqrt_f32 v127, v127
    s_nop 0
    v_cvt_pk_bf16_f32 v127, v127, v127
    v_lshlrev_b32 v127, 16, v127
    v_rcp_f32 v127, v127
    s_nop 0
    s_mul_i32 s61, s58, 8320
    v_lshlrev_b32 v4, 4, v1
    v_add_u32 v4, s61, v4

    v_sub_f32 v48, v48, v112
    v_sub_f32 v49, v49, v112
    v_cvt_pk_bf16_f32 v16, v48, v49
    v_lshlrev_b32 v48, 16, v16
    v_and_b32 v49, 0xffff0000, v16
    v_mul_f32 v48, v48, v120
    v_mul_f32 v49, v49, v120
    v_cvt_pk_bf16_f32 v16, v48, v49
    v_sub_f32 v50, v50, v112
    v_sub_f32 v51, v51, v112
    v_cvt_pk_bf16_f32 v17, v50, v51
    v_lshlrev_b32 v50, 16, v17
    v_and_b32 v51, 0xffff0000, v17
    v_mul_f32 v50, v50, v120
    v_mul_f32 v51, v51, v120
    v_cvt_pk_bf16_f32 v17, v50, v51
    v_sub_f32 v52, v52, v112
    v_sub_f32 v53, v53, v112
    v_cvt_pk_bf16_f32 v18, v52, v53
    v_lshlrev_b32 v52, 16, v18
    v_and_b32 v53, 0xffff0000, v18
    v_mul_f32 v52, v52, v120
    v_mul_f32 v53, v53, v120
    v_cvt_pk_bf16_f32 v18, v52, v53
    v_sub_f32 v54, v54, v112
    v_sub_f32 v55, v55, v112
    v_cvt_pk_bf16_f32 v19, v54, v55
    v_lshlrev_b32 v54, 16, v19
    v_and_b32 v55, 0xffff0000, v19
    v_mul_f32 v54, v54, v120
    v_mul_f32 v55, v55, v120
    v_cvt_pk_bf16_f32 v19, v54, v55
    ds_write_b128 v4, v[16:19] offset:0
    v_sub_f32 v56, v56, v113
    v_sub_f32 v57, v57, v113
    v_cvt_pk_bf16_f32 v20, v56, v57
    v_lshlrev_b32 v56, 16, v20
    v_and_b32 v57, 0xffff0000, v20
    v_mul_f32 v56, v56, v121
    v_mul_f32 v57, v57, v121
    v_cvt_pk_bf16_f32 v20, v56, v57
    v_sub_f32 v58, v58, v113
    v_sub_f32 v59, v59, v113
    v_cvt_pk_bf16_f32 v21, v58, v59
    v_lshlrev_b32 v58, 16, v21
    v_and_b32 v59, 0xffff0000, v21
    v_mul_f32 v58, v58, v121
    v_mul_f32 v59, v59, v121
    v_cvt_pk_bf16_f32 v21, v58, v59
    v_sub_f32 v60, v60, v113
    v_sub_f32 v61, v61, v113
    v_cvt_pk_bf16_f32 v22, v60, v61
    v_lshlrev_b32 v60, 16, v22
    v_and_b32 v61, 0xffff0000, v22
    v_mul_f32 v60, v60, v121
    v_mul_f32 v61, v61, v121
    v_cvt_pk_bf16_f32 v22, v60, v61
    v_sub_f32 v62, v62, v113
    v_sub_f32 v63, v63, v113
    v_cvt_pk_bf16_f32 v23, v62, v63
    v_lshlrev_b32 v62, 16, v23
    v_and_b32 v63, 0xffff0000, v23
    v_mul_f32 v62, v62, v121
    v_mul_f32 v63, v63, v121
    v_cvt_pk_bf16_f32 v23, v62, v63
    ds_write_b128 v4, v[20:23] offset:1040
    v_sub_f32 v64, v64, v114
    v_sub_f32 v65, v65, v114
    v_cvt_pk_bf16_f32 v24, v64, v65
    v_lshlrev_b32 v64, 16, v24
    v_and_b32 v65, 0xffff0000, v24
    v_mul_f32 v64, v64, v122
    v_mul_f32 v65, v65, v122
    v_cvt_pk_bf16_f32 v24, v64, v65
    v_sub_f32 v66, v66, v114
    v_sub_f32 v67, v67, v114
    v_cvt_pk_bf16_f32 v25, v66, v67
    v_lshlrev_b32 v66, 16, v25
    v_and_b32 v67, 0xffff0000, v25
    v_mul_f32 v66, v66, v122
    v_mul_f32 v67, v67, v122
    v_cvt_pk_bf16_f32 v25, v66, v67
    v_sub_f32 v68, v68, v114
    v_sub_f32 v69, v69, v114
    v_cvt_pk_bf16_f32 v26, v68, v69
    v_lshlrev_b32 v68, 16, v26
    v_and_b32 v69, 0xffff0000, v26
    v_mul_f32 v68, v68, v122
    v_mul_f32 v69, v69, v122
    v_cvt_pk_bf16_f32 v26, v68, v69
    v_sub_f32 v70, v70, v114
    v_sub_f32 v71, v71, v114
    v_cvt_pk_bf16_f32 v27, v70, v71
    v_lshlrev_b32 v70, 16, v27
    v_and_b32 v71, 0xffff0000, v27
    v_mul_f32 v70, v70, v122
    v_mul_f32 v71, v71, v122
    v_cvt_pk_bf16_f32 v27, v70, v71
    ds_write_b128 v4, v[24:27] offset:2080
    v_sub_f32 v72, v72, v115
    v_sub_f32 v73, v73, v115
    v_cvt_pk_bf16_f32 v28, v72, v73
    v_lshlrev_b32 v72, 16, v28
    v_and_b32 v73, 0xffff0000, v28
    v_mul_f32 v72, v72, v123
    v_mul_f32 v73, v73, v123
    v_cvt_pk_bf16_f32 v28, v72, v73
    v_sub_f32 v74, v74, v115
    v_sub_f32 v75, v75, v115
    v_cvt_pk_bf16_f32 v29, v74, v75
    v_lshlrev_b32 v74, 16, v29
    v_and_b32 v75, 0xffff0000, v29
    v_mul_f32 v74, v74, v123
    v_mul_f32 v75, v75, v123
    v_cvt_pk_bf16_f32 v29, v74, v75
    v_sub_f32 v76, v76, v115
    v_sub_f32 v77, v77, v115
    v_cvt_pk_bf16_f32 v30, v76, v77
    v_lshlrev_b32 v76, 16, v30
    v_and_b32 v77, 0xffff0000, v30
    v_mul_f32 v76, v76, v123
    v_mul_f32 v77, v77, v123
    v_cvt_pk_bf16_f32 v30, v76, v77
    v_sub_f32 v78, v78, v115
    v_sub_f32 v79, v79, v115
    v_cvt_pk_bf16_f32 v31, v78, v79
    v_lshlrev_b32 v78, 16, v31
    v_and_b32 v79, 0xffff0000, v31
    v_mul_f32 v78, v78, v123
    v_mul_f32 v79, v79, v123
    v_cvt_pk_bf16_f32 v31, v78, v79
    ds_write_b128 v4, v[28:31] offset:3120
    v_sub_f32 v80, v80, v116
    v_sub_f32 v81, v81, v116
    v_cvt_pk_bf16_f32 v32, v80, v81
    v_lshlrev_b32 v80, 16, v32
    v_and_b32 v81, 0xffff0000, v32
    v_mul_f32 v80, v80, v124
    v_mul_f32 v81, v81, v124
    v_cvt_pk_bf16_f32 v32, v80, v81
    v_sub_f32 v82, v82, v116
    v_sub_f32 v83, v83, v116
    v_cvt_pk_bf16_f32 v33, v82, v83
    v_lshlrev_b32 v82, 16, v33
    v_and_b32 v83, 0xffff0000, v33
    v_mul_f32 v82, v82, v124
    v_mul_f32 v83, v83, v124
    v_cvt_pk_bf16_f32 v33, v82, v83
    v_sub_f32 v84, v84, v116
    v_sub_f32 v85, v85, v116
    v_cvt_pk_bf16_f32 v34, v84, v85
    v_lshlrev_b32 v84, 16, v34
    v_and_b32 v85, 0xffff0000, v34
    v_mul_f32 v84, v84, v124
    v_mul_f32 v85, v85, v124
    v_cvt_pk_bf16_f32 v34, v84, v85
    v_sub_f32 v86, v86, v116
    v_sub_f32 v87, v87, v116
    v_cvt_pk_bf16_f32 v35, v86, v87
    v_lshlrev_b32 v86, 16, v35
    v_and_b32 v87, 0xffff0000, v35
    v_mul_f32 v86, v86, v124
    v_mul_f32 v87, v87, v124
    v_cvt_pk_bf16_f32 v35, v86, v87
    ds_write_b128 v4, v[32:35] offset:4160
    v_sub_f32 v88, v88, v117
    v_sub_f32 v89, v89, v117
    v_cvt_pk_bf16_f32 v36, v88, v89
    v_lshlrev_b32 v88, 16, v36
    v_and_b32 v89, 0xffff0000, v36
    v_mul_f32 v88, v88, v125
    v_mul_f32 v89, v89, v125
    v_cvt_pk_bf16_f32 v36, v88, v89
    v_sub_f32 v90, v90, v117
    v_sub_f32 v91, v91, v117
    v_cvt_pk_bf16_f32 v37, v90, v91
    v_lshlrev_b32 v90, 16, v37
    v_and_b32 v91, 0xffff0000, v37
    v_mul_f32 v90, v90, v125
    v_mul_f32 v91, v91, v125
    v_cvt_pk_bf16_f32 v37, v90, v91
    v_sub_f32 v92, v92, v117
    v_sub_f32 v93, v93, v117
    v_cvt_pk_bf16_f32 v38, v92, v93
    v_lshlrev_b32 v92, 16, v38
    v_and_b32 v93, 0xffff0000, v38
    v_mul_f32 v92, v92, v125
    v_mul_f32 v93, v93, v125
    v_cvt_pk_bf16_f32 v38, v92, v93
    v_sub_f32 v94, v94, v117
    v_sub_f32 v95, v95, v117
    v_cvt_pk_bf16_f32 v39, v94, v95
    v_lshlrev_b32 v94, 16, v39
    v_and_b32 v95, 0xffff0000, v39
    v_mul_f32 v94, v94, v125
    v_mul_f32 v95, v95, v125
    v_cvt_pk_bf16_f32 v39, v94, v95
    ds_write_b128 v4, v[36:39] offset:5200
    v_sub_f32 v96, v96, v118
    v_sub_f32 v97, v97, v118
    v_cvt_pk_bf16_f32 v40, v96, v97
    v_lshlrev_b32 v96, 16, v40
    v_and_b32 v97, 0xffff0000, v40
    v_mul_f32 v96, v96, v126
    v_mul_f32 v97, v97, v126
    v_cvt_pk_bf16_f32 v40, v96, v97
    v_sub_f32 v98, v98, v118
    v_sub_f32 v99, v99, v118
    v_cvt_pk_bf16_f32 v41, v98, v99
    v_lshlrev_b32 v98, 16, v41
    v_and_b32 v99, 0xffff0000, v41
    v_mul_f32 v98, v98, v126
    v_mul_f32 v99, v99, v126
    v_cvt_pk_bf16_f32 v41, v98, v99
    v_sub_f32 v100, v100, v118
    v_sub_f32 v101, v101, v118
    v_cvt_pk_bf16_f32 v42, v100, v101
    v_lshlrev_b32 v100, 16, v42
    v_and_b32 v101, 0xffff0000, v42
    v_mul_f32 v100, v100, v126
    v_mul_f32 v101, v101, v126
    v_cvt_pk_bf16_f32 v42, v100, v101
    v_sub_f32 v102, v102, v118
    v_sub_f32 v103, v103, v118
    v_cvt_pk_bf16_f32 v43, v102, v103
    v_lshlrev_b32 v102, 16, v43
    v_and_b32 v103, 0xffff0000, v43
    v_mul_f32 v102, v102, v126
    v_mul_f32 v103, v103, v126
    v_cvt_pk_bf16_f32 v43, v102, v103
    ds_write_b128 v4, v[40:43] offset:6240
    v_sub_f32 v104, v104, v119
    v_sub_f32 v105, v105, v119
    v_cvt_pk_bf16_f32 v44, v104, v105
    v_lshlrev_b32 v104, 16, v44
    v_and_b32 v105, 0xffff0000, v44
    v_mul_f32 v104, v104, v127
    v_mul_f32 v105, v105, v127
    v_cvt_pk_bf16_f32 v44, v104, v105
    v_sub_f32 v106, v106, v119
    v_sub_f32 v107, v107, v119
    v_cvt_pk_bf16_f32 v45, v106, v107
    v_lshlrev_b32 v106, 16, v45
    v_and_b32 v107, 0xffff0000, v45
    v_mul_f32 v106, v106, v127
    v_mul_f32 v107, v107, v127
    v_cvt_pk_bf16_f32 v45, v106, v107
    v_sub_f32 v108, v108, v119
    v_sub_f32 v109, v109, v119
    v_cvt_pk_bf16_f32 v46, v108, v109
    v_lshlrev_b32 v108, 16, v46
    v_and_b32 v109, 0xffff0000, v46
    v_mul_f32 v108, v108, v127
    v_mul_f32 v109, v109, v127
    v_cvt_pk_bf16_f32 v46, v108, v109
    v_sub_f32 v110, v110, v119
    v_sub_f32 v111, v111, v119
    v_cvt_pk_bf16_f32 v47, v110, v111
    v_lshlrev_b32 v110, 16, v47
    v_and_b32 v111, 0xffff0000, v47
    v_mul_f32 v110, v110, v127
    v_mul_f32 v111, v111, v127
    v_cvt_pk_bf16_f32 v47, v110, v111
    ds_write_b128 v4, v[44:47] offset:7280
    s_cmp_eq_u32 s57, 0
    s_cbranch_scc0 K0_NOXN

    buffer_store_dwordx4 v[16:19], v3, s[24:27], s59 offen offset:0
    buffer_store_dwordx4 v[20:23], v3, s[24:27], s59 offen offset:1024
    buffer_store_dwordx4 v[24:27], v3, s[24:27], s59 offen offset:2048
    buffer_store_dwordx4 v[28:31], v3, s[24:27], s59 offen offset:3072
    buffer_store_dwordx4 v[32:35], v3, s[24:27], s60 offen offset:0
    buffer_store_dwordx4 v[36:39], v3, s[24:27], s60 offen offset:1024
    buffer_store_dwordx4 v[40:43], v3, s[24:27], s60 offen offset:2048
    buffer_store_dwordx4 v[44:47], v3, s[24:27], s60 offen offset:3072
K0_NOXN:
    s_waitcnt vmcnt(0) lgkmcnt(0)
    s_barrier
    v_and_b32 v7, 15, v1
    v_lshrrev_b32 v8, 4, v1
    s_lshl_b32 s61, s57, 7
    s_lshl_b32 s62, s58, 5
    s_add_u32 s61, s61, s62
    v_add_u32 v5, s61, v7
    v_lshlrev_b32 v5, 10, v5
    v_lshlrev_b32 v9, 5, v8
    v_add_u32 v5, v5, v9
    v_mul_u32_u24 v6, 1040, v7
    v_add_u32 v6, v6, v9
    s_movk_i32 s62, 0x4000

    v_mov_b32 v16, 0
    v_mov_b32 v17, 0
    v_mov_b32 v18, 0
    v_mov_b32 v19, 0
    v_mov_b32 v20, 0
    v_mov_b32 v21, 0
    v_mov_b32 v22, 0
    v_mov_b32 v23, 0
    v_mov_b32 v24, 0
    v_mov_b32 v25, 0
    v_mov_b32 v26, 0
    v_mov_b32 v27, 0
    v_mov_b32 v28, 0
    v_mov_b32 v29, 0
    v_mov_b32 v30, 0
    v_mov_b32 v31, 0
    v_mov_b32 v32, 0
    v_mov_b32 v33, 0
    v_mov_b32 v34, 0
    v_mov_b32 v35, 0
    v_mov_b32 v36, 0
    v_mov_b32 v37, 0
    v_mov_b32 v38, 0
    v_mov_b32 v39, 0
    v_mov_b32 v40, 0
    v_mov_b32 v41, 0
    v_mov_b32 v42, 0
    v_mov_b32 v43, 0
    v_mov_b32 v44, 0
    v_mov_b32 v45, 0
    v_mov_b32 v46, 0
    v_mov_b32 v47, 0
    v_lshrrev_b32 v10, 3, v1
    v_and_b32 v11, 7, v1
    v_xor_b32 v11, v11, v10
    v_lshlrev_b32 v5, 10, v10
    v_lshl_add_u32 v5, v11, 4, v5
    v_and_b32 v11, 7, v1
    v_xor_b32 v11, v8, v11
    v_lshlrev_b32 v12, 7, v7
    v_lshl_add_u32 v13, v11, 4, v12
    v_xor_b32 v11, 4, v11
    v_lshl_add_u32 v14, v11, 4, v12
    s_mul_i32 s66, s58, 24576
    s_add_u32 s66, s66, 33280
    v_add_u32 v13, s66, v13
    v_add_u32 v14, s66, v14
    s_lshl_b32 s67, s61, 10
    v_lshl_add_u32 v6, v8, 4, 0
    v_mul_u32_u24 v10, 1040, v7
    v_add_u32 v6, v6, v10

    s_add_u32 s68, s66, 0
    s_add_u32 s69, s67, 0
    s_mov_b32 m0, s68
    s_add_u32 s68, s68, 1024
    buffer_load_dwordx4 v5, s[28:31], s69 offen lds
    s_add_u32 s69, s67, 8192
    s_mov_b32 m0, s68
    s_add_u32 s68, s68, 1024
    buffer_load_dwordx4 v5, s[28:31], s69 offen lds
    s_add_u32 s69, s67, 16384
    s_mov_b32 m0, s68
    s_add_u32 s68, s68, 1024
    buffer_load_dwordx4 v5, s[28:31], s69 offen lds
    s_add_u32 s69, s67, 24576
    s_mov_b32 m0, s68
    s_add_u32 s68, s68, 1024
    buffer_load_dwordx4 v5, s[28:31], s69 offen lds
    s_add_u32 s69, s67, 0
    s_mov_b32 m0, s68
    s_add_u32 s68, s68, 1024
    buffer_load_dwordx4 v5, s[32:35], s69 offen lds
    s_add_u32 s69, s67, 8192
    s_mov_b32 m0, s68
    s_add_u32 s68, s68, 1024
    buffer_load_dwordx4 v5, s[32:35], s69 offen lds
    s_add_u32 s69, s67, 16384
    s_mov_b32 m0, s68
    s_add_u32 s68, s68, 1024
    buffer_load_dwordx4 v5, s[32:35], s69 offen lds
    s_add_u32 s69, s67, 24576
    s_mov_b32 m0, s68
    s_add_u32 s68, s68, 1024
    buffer_load_dwordx4 v5, s[32:35], s69 offen lds
    s_add_u32 s68, s66, 8192
    s_add_u32 s69, s67, 128
    s_mov_b32 m0, s68
    s_add_u32 s68, s68, 1024
    buffer_load_dwordx4 v5, s[28:31], s69 offen lds
    s_add_u32 s69, s67, 8320
    s_mov_b32 m0, s68
    s_add_u32 s68, s68, 1024
    buffer_load_dwordx4 v5, s[28:31], s69 offen lds
    s_add_u32 s69, s67, 16512
    s_mov_b32 m0, s68
    s_add_u32 s68, s68, 1024
    buffer_load_dwordx4 v5, s[28:31], s69 offen lds
    s_add_u32 s69, s67, 24704
    s_mov_b32 m0, s68
    s_add_u32 s68, s68, 1024
    buffer_load_dwordx4 v5, s[28:31], s69 offen lds
    s_add_u32 s69, s67, 128
    s_mov_b32 m0, s68
    s_add_u32 s68, s68, 1024
    buffer_load_dwordx4 v5, s[32:35], s69 offen lds
    s_add_u32 s69, s67, 8320
    s_mov_b32 m0, s68
    s_add_u32 s68, s68, 1024
    buffer_load_dwordx4 v5, s[32:35], s69 offen lds
    s_add_u32 s69, s67, 16512
    s_mov_b32 m0, s68
    s_add_u32 s68, s68, 1024
    buffer_load_dwordx4 v5, s[32:35], s69 offen lds
    s_add_u32 s69, s67, 24704
    s_mov_b32 m0, s68
    s_add_u32 s68, s68, 1024
    buffer_load_dwordx4 v5, s[32:35], s69 offen lds
    s_add_u32 s68, s66, 16384
    s_add_u32 s69, s67, 256
    s_mov_b32 m0, s68
    s_add_u32 s68, s68, 1024
    buffer_load_dwordx4 v5, s[28:31], s69 offen lds
    s_add_u32 s69, s67, 8448
    s_mov_b32 m0, s68
    s_add_u32 s68, s68, 1024
    buffer_load_dwordx4 v5, s[28:31], s69 offen lds
    s_add_u32 s69, s67, 16640
    s_mov_b32 m0, s68
    s_add_u32 s68, s68, 1024
    buffer_load_dwordx4 v5, s[28:31], s69 offen lds
    s_add_u32 s69, s67, 24832
    s_mov_b32 m0, s68
    s_add_u32 s68, s68, 1024
    buffer_load_dwordx4 v5, s[28:31], s69 offen lds
    s_add_u32 s69, s67, 256
    s_mov_b32 m0, s68
    s_add_u32 s68, s68, 1024
    buffer_load_dwordx4 v5, s[32:35], s69 offen lds
    s_add_u32 s69, s67, 8448
    s_mov_b32 m0, s68
    s_add_u32 s68, s68, 1024
    buffer_load_dwordx4 v5, s[32:35], s69 offen lds
    s_add_u32 s69, s67, 16640
    s_mov_b32 m0, s68
    s_add_u32 s68, s68, 1024
    buffer_load_dwordx4 v5, s[32:35], s69 offen lds
    s_add_u32 s69, s67, 24832
    s_mov_b32 m0, s68
    s_add_u32 s68, s68, 1024
    buffer_load_dwordx4 v5, s[32:35], s69 offen lds
    s_waitcnt vmcnt(16)
    ds_read_b128 v[48:51], v6 offset:0
    ds_read_b128 v[56:59], v6 offset:16640
    ds_read_b128 v[64:67], v13 offset:0
    ds_read_b128 v[68:71], v13 offset:2048
    ds_read_b128 v[72:75], v13 offset:4096
    ds_read_b128 v[76:79], v13 offset:6144
    ds_read_b128 v[52:55], v6 offset:64
    ds_read_b128 v[60:63], v6 offset:16704
    ds_read_b128 v[80:83], v14 offset:0
    ds_read_b128 v[84:87], v14 offset:2048
    ds_read_b128 v[88:91], v14 offset:4096
    ds_read_b128 v[92:95], v14 offset:6144
    s_waitcnt lgkmcnt(0)
    v_mfma_f32_16x16x32_bf16 v[16:19], v[48:51], v[64:67], v[16:19]
    v_mfma_f32_16x16x32_bf16 v[20:23], v[48:51], v[68:71], v[20:23]
    v_mfma_f32_16x16x32_bf16 v[24:27], v[48:51], v[72:75], v[24:27]
    v_mfma_f32_16x16x32_bf16 v[28:31], v[48:51], v[76:79], v[28:31]
    v_mfma_f32_16x16x32_bf16 v[32:35], v[56:59], v[64:67], v[32:35]
    v_mfma_f32_16x16x32_bf16 v[36:39], v[56:59], v[68:71], v[36:39]
    v_mfma_f32_16x16x32_bf16 v[40:43], v[56:59], v[72:75], v[40:43]
    v_mfma_f32_16x16x32_bf16 v[44:47], v[56:59], v[76:79], v[44:47]
    v_mfma_f32_16x16x32_bf16 v[16:19], v[52:55], v[80:83], v[16:19]
    v_mfma_f32_16x16x32_bf16 v[20:23], v[52:55], v[84:87], v[20:23]
    v_mfma_f32_16x16x32_bf16 v[24:27], v[52:55], v[88:91], v[24:27]
    v_mfma_f32_16x16x32_bf16 v[28:31], v[52:55], v[92:95], v[28:31]
    v_mfma_f32_16x16x32_bf16 v[32:35], v[60:63], v[80:83], v[32:35]
    v_mfma_f32_16x16x32_bf16 v[36:39], v[60:63], v[84:87], v[36:39]
    v_mfma_f32_16x16x32_bf16 v[40:43], v[60:63], v[88:91], v[40:43]
    v_mfma_f32_16x16x32_bf16 v[44:47], v[60:63], v[92:95], v[44:47]
    s_add_u32 s68, s66, 0
    s_add_u32 s69, s67, 384
    s_mov_b32 m0, s68
    s_add_u32 s68, s68, 1024
    buffer_load_dwordx4 v5, s[28:31], s69 offen lds
    s_add_u32 s69, s67, 8576
    s_mov_b32 m0, s68
    s_add_u32 s68, s68, 1024
    buffer_load_dwordx4 v5, s[28:31], s69 offen lds
    s_add_u32 s69, s67, 16768
    s_mov_b32 m0, s68
    s_add_u32 s68, s68, 1024
    buffer_load_dwordx4 v5, s[28:31], s69 offen lds
    s_add_u32 s69, s67, 24960
    s_mov_b32 m0, s68
    s_add_u32 s68, s68, 1024
    buffer_load_dwordx4 v5, s[28:31], s69 offen lds
    s_add_u32 s69, s67, 384
    s_mov_b32 m0, s68
    s_add_u32 s68, s68, 1024
    buffer_load_dwordx4 v5, s[32:35], s69 offen lds
    s_add_u32 s69, s67, 8576
    s_mov_b32 m0, s68
    s_add_u32 s68, s68, 1024
    buffer_load_dwordx4 v5, s[32:35], s69 offen lds
    s_add_u32 s69, s67, 16768
    s_mov_b32 m0, s68
    s_add_u32 s68, s68, 1024
    buffer_load_dwordx4 v5, s[32:35], s69 offen lds
    s_add_u32 s69, s67, 24960
    s_mov_b32 m0, s68
    s_add_u32 s68, s68, 1024
    buffer_load_dwordx4 v5, s[32:35], s69 offen lds
    s_waitcnt vmcnt(16)
    ds_read_b128 v[48:51], v6 offset:128
    ds_read_b128 v[56:59], v6 offset:16768
    ds_read_b128 v[64:67], v13 offset:8192
    ds_read_b128 v[68:71], v13 offset:10240
    ds_read_b128 v[72:75], v13 offset:12288
    ds_read_b128 v[76:79], v13 offset:14336
    ds_read_b128 v[52:55], v6 offset:192
    ds_read_b128 v[60:63], v6 offset:16832
    ds_read_b128 v[80:83], v14 offset:8192
    ds_read_b128 v[84:87], v14 offset:10240
    ds_read_b128 v[88:91], v14 offset:12288
    ds_read_b128 v[92:95], v14 offset:14336
    s_waitcnt lgkmcnt(0)
    v_mfma_f32_16x16x32_bf16 v[16:19], v[48:51], v[64:67], v[16:19]
    v_mfma_f32_16x16x32_bf16 v[20:23], v[48:51], v[68:71], v[20:23]
    v_mfma_f32_16x16x32_bf16 v[24:27], v[48:51], v[72:75], v[24:27]
    v_mfma_f32_16x16x32_bf16 v[28:31], v[48:51], v[76:79], v[28:31]
    v_mfma_f32_16x16x32_bf16 v[32:35], v[56:59], v[64:67], v[32:35]
    v_mfma_f32_16x16x32_bf16 v[36:39], v[56:59], v[68:71], v[36:39]
    v_mfma_f32_16x16x32_bf16 v[40:43], v[56:59], v[72:75], v[40:43]
    v_mfma_f32_16x16x32_bf16 v[44:47], v[56:59], v[76:79], v[44:47]
    v_mfma_f32_16x16x32_bf16 v[16:19], v[52:55], v[80:83], v[16:19]
    v_mfma_f32_16x16x32_bf16 v[20:23], v[52:55], v[84:87], v[20:23]
    v_mfma_f32_16x16x32_bf16 v[24:27], v[52:55], v[88:91], v[24:27]
    v_mfma_f32_16x16x32_bf16 v[28:31], v[52:55], v[92:95], v[28:31]
    v_mfma_f32_16x16x32_bf16 v[32:35], v[60:63], v[80:83], v[32:35]
    v_mfma_f32_16x16x32_bf16 v[36:39], v[60:63], v[84:87], v[36:39]
    v_mfma_f32_16x16x32_bf16 v[40:43], v[60:63], v[88:91], v[40:43]
    v_mfma_f32_16x16x32_bf16 v[44:47], v[60:63], v[92:95], v[44:47]
    s_add_u32 s68, s66, 8192
    s_add_u32 s69, s67, 512
    s_mov_b32 m0, s68
    s_add_u32 s68, s68, 1024
    buffer_load_dwordx4 v5, s[28:31], s69 offen lds
    s_add_u32 s69, s67, 8704
    s_mov_b32 m0, s68
    s_add_u32 s68, s68, 1024
    buffer_load_dwordx4 v5, s[28:31], s69 offen lds
    s_add_u32 s69, s67, 16896
    s_mov_b32 m0, s68
    s_add_u32 s68, s68, 1024
    buffer_load_dwordx4 v5, s[28:31], s69 offen lds
    s_add_u32 s69, s67, 25088
    s_mov_b32 m0, s68
    s_add_u32 s68, s68, 1024
    buffer_load_dwordx4 v5, s[28:31], s69 offen lds
    s_add_u32 s69, s67, 512
    s_mov_b32 m0, s68
    s_add_u32 s68, s68, 1024
    buffer_load_dwordx4 v5, s[32:35], s69 offen lds
    s_add_u32 s69, s67, 8704
    s_mov_b32 m0, s68
    s_add_u32 s68, s68, 1024
    buffer_load_dwordx4 v5, s[32:35], s69 offen lds
    s_add_u32 s69, s67, 16896
    s_mov_b32 m0, s68
    s_add_u32 s68, s68, 1024
    buffer_load_dwordx4 v5, s[32:35], s69 offen lds
    s_add_u32 s69, s67, 25088
    s_mov_b32 m0, s68
    s_add_u32 s68, s68, 1024
    buffer_load_dwordx4 v5, s[32:35], s69 offen lds
    s_waitcnt vmcnt(16)
    ds_read_b128 v[48:51], v6 offset:256
    ds_read_b128 v[56:59], v6 offset:16896
    ds_read_b128 v[64:67], v13 offset:16384
    ds_read_b128 v[68:71], v13 offset:18432
    ds_read_b128 v[72:75], v13 offset:20480
    ds_read_b128 v[76:79], v13 offset:22528
    ds_read_b128 v[52:55], v6 offset:320
    ds_read_b128 v[60:63], v6 offset:16960
    ds_read_b128 v[80:83], v14 offset:16384
    ds_read_b128 v[84:87], v14 offset:18432
    ds_read_b128 v[88:91], v14 offset:20480
    ds_read_b128 v[92:95], v14 offset:22528
    s_waitcnt lgkmcnt(0)
    v_mfma_f32_16x16x32_bf16 v[16:19], v[48:51], v[64:67], v[16:19]
    v_mfma_f32_16x16x32_bf16 v[20:23], v[48:51], v[68:71], v[20:23]
    v_mfma_f32_16x16x32_bf16 v[24:27], v[48:51], v[72:75], v[24:27]
    v_mfma_f32_16x16x32_bf16 v[28:31], v[48:51], v[76:79], v[28:31]
    v_mfma_f32_16x16x32_bf16 v[32:35], v[56:59], v[64:67], v[32:35]
    v_mfma_f32_16x16x32_bf16 v[36:39], v[56:59], v[68:71], v[36:39]
    v_mfma_f32_16x16x32_bf16 v[40:43], v[56:59], v[72:75], v[40:43]
    v_mfma_f32_16x16x32_bf16 v[44:47], v[56:59], v[76:79], v[44:47]
    v_mfma_f32_16x16x32_bf16 v[16:19], v[52:55], v[80:83], v[16:19]
    v_mfma_f32_16x16x32_bf16 v[20:23], v[52:55], v[84:87], v[20:23]
    v_mfma_f32_16x16x32_bf16 v[24:27], v[52:55], v[88:91], v[24:27]
    v_mfma_f32_16x16x32_bf16 v[28:31], v[52:55], v[92:95], v[28:31]
    v_mfma_f32_16x16x32_bf16 v[32:35], v[60:63], v[80:83], v[32:35]
    v_mfma_f32_16x16x32_bf16 v[36:39], v[60:63], v[84:87], v[36:39]
    v_mfma_f32_16x16x32_bf16 v[40:43], v[60:63], v[88:91], v[40:43]
    v_mfma_f32_16x16x32_bf16 v[44:47], v[60:63], v[92:95], v[44:47]
    s_add_u32 s68, s66, 16384
    s_add_u32 s69, s67, 640
    s_mov_b32 m0, s68
    s_add_u32 s68, s68, 1024
    buffer_load_dwordx4 v5, s[28:31], s69 offen lds
    s_add_u32 s69, s67, 8832
    s_mov_b32 m0, s68
    s_add_u32 s68, s68, 1024
    buffer_load_dwordx4 v5, s[28:31], s69 offen lds
    s_add_u32 s69, s67, 17024
    s_mov_b32 m0, s68
    s_add_u32 s68, s68, 1024
    buffer_load_dwordx4 v5, s[28:31], s69 offen lds
    s_add_u32 s69, s67, 25216
    s_mov_b32 m0, s68
    s_add_u32 s68, s68, 1024
    buffer_load_dwordx4 v5, s[28:31], s69 offen lds
    s_add_u32 s69, s67, 640
    s_mov_b32 m0, s68
    s_add_u32 s68, s68, 1024
    buffer_load_dwordx4 v5, s[32:35], s69 offen lds
    s_add_u32 s69, s67, 8832
    s_mov_b32 m0, s68
    s_add_u32 s68, s68, 1024
    buffer_load_dwordx4 v5, s[32:35], s69 offen lds
    s_add_u32 s69, s67, 17024
    s_mov_b32 m0, s68
    s_add_u32 s68, s68, 1024
    buffer_load_dwordx4 v5, s[32:35], s69 offen lds
    s_add_u32 s69, s67, 25216
    s_mov_b32 m0, s68
    s_add_u32 s68, s68, 1024
    buffer_load_dwordx4 v5, s[32:35], s69 offen lds
    s_waitcnt vmcnt(16)
    ds_read_b128 v[48:51], v6 offset:384
    ds_read_b128 v[56:59], v6 offset:17024
    ds_read_b128 v[64:67], v13 offset:0
    ds_read_b128 v[68:71], v13 offset:2048
    ds_read_b128 v[72:75], v13 offset:4096
    ds_read_b128 v[76:79], v13 offset:6144
    ds_read_b128 v[52:55], v6 offset:448
    ds_read_b128 v[60:63], v6 offset:17088
    ds_read_b128 v[80:83], v14 offset:0
    ds_read_b128 v[84:87], v14 offset:2048
    ds_read_b128 v[88:91], v14 offset:4096
    ds_read_b128 v[92:95], v14 offset:6144
    s_waitcnt lgkmcnt(0)
    v_mfma_f32_16x16x32_bf16 v[16:19], v[48:51], v[64:67], v[16:19]
    v_mfma_f32_16x16x32_bf16 v[20:23], v[48:51], v[68:71], v[20:23]
    v_mfma_f32_16x16x32_bf16 v[24:27], v[48:51], v[72:75], v[24:27]
    v_mfma_f32_16x16x32_bf16 v[28:31], v[48:51], v[76:79], v[28:31]
    v_mfma_f32_16x16x32_bf16 v[32:35], v[56:59], v[64:67], v[32:35]
    v_mfma_f32_16x16x32_bf16 v[36:39], v[56:59], v[68:71], v[36:39]
    v_mfma_f32_16x16x32_bf16 v[40:43], v[56:59], v[72:75], v[40:43]
    v_mfma_f32_16x16x32_bf16 v[44:47], v[56:59], v[76:79], v[44:47]
    v_mfma_f32_16x16x32_bf16 v[16:19], v[52:55], v[80:83], v[16:19]
    v_mfma_f32_16x16x32_bf16 v[20:23], v[52:55], v[84:87], v[20:23]
    v_mfma_f32_16x16x32_bf16 v[24:27], v[52:55], v[88:91], v[24:27]
    v_mfma_f32_16x16x32_bf16 v[28:31], v[52:55], v[92:95], v[28:31]
    v_mfma_f32_16x16x32_bf16 v[32:35], v[60:63], v[80:83], v[32:35]
    v_mfma_f32_16x16x32_bf16 v[36:39], v[60:63], v[84:87], v[36:39]
    v_mfma_f32_16x16x32_bf16 v[40:43], v[60:63], v[88:91], v[40:43]
    v_mfma_f32_16x16x32_bf16 v[44:47], v[60:63], v[92:95], v[44:47]
    s_add_u32 s68, s66, 0
    s_add_u32 s69, s67, 768
    s_mov_b32 m0, s68
    s_add_u32 s68, s68, 1024
    buffer_load_dwordx4 v5, s[28:31], s69 offen lds
    s_add_u32 s69, s67, 8960
    s_mov_b32 m0, s68
    s_add_u32 s68, s68, 1024
    buffer_load_dwordx4 v5, s[28:31], s69 offen lds
    s_add_u32 s69, s67, 17152
    s_mov_b32 m0, s68
    s_add_u32 s68, s68, 1024
    buffer_load_dwordx4 v5, s[28:31], s69 offen lds
    s_add_u32 s69, s67, 25344
    s_mov_b32 m0, s68
    s_add_u32 s68, s68, 1024
    buffer_load_dwordx4 v5, s[28:31], s69 offen lds
    s_add_u32 s69, s67, 768
    s_mov_b32 m0, s68
    s_add_u32 s68, s68, 1024
    buffer_load_dwordx4 v5, s[32:35], s69 offen lds
    s_add_u32 s69, s67, 8960
    s_mov_b32 m0, s68
    s_add_u32 s68, s68, 1024
    buffer_load_dwordx4 v5, s[32:35], s69 offen lds
    s_add_u32 s69, s67, 17152
    s_mov_b32 m0, s68
    s_add_u32 s68, s68, 1024
    buffer_load_dwordx4 v5, s[32:35], s69 offen lds
    s_add_u32 s69, s67, 25344
    s_mov_b32 m0, s68
    s_add_u32 s68, s68, 1024
    buffer_load_dwordx4 v5, s[32:35], s69 offen lds
    s_waitcnt vmcnt(16)
    ds_read_b128 v[48:51], v6 offset:512
    ds_read_b128 v[56:59], v6 offset:17152
    ds_read_b128 v[64:67], v13 offset:8192
    ds_read_b128 v[68:71], v13 offset:10240
    ds_read_b128 v[72:75], v13 offset:12288
    ds_read_b128 v[76:79], v13 offset:14336
    ds_read_b128 v[52:55], v6 offset:576
    ds_read_b128 v[60:63], v6 offset:17216
    ds_read_b128 v[80:83], v14 offset:8192
    ds_read_b128 v[84:87], v14 offset:10240
    ds_read_b128 v[88:91], v14 offset:12288
    ds_read_b128 v[92:95], v14 offset:14336
    s_waitcnt lgkmcnt(0)
    v_mfma_f32_16x16x32_bf16 v[16:19], v[48:51], v[64:67], v[16:19]
    v_mfma_f32_16x16x32_bf16 v[20:23], v[48:51], v[68:71], v[20:23]
    v_mfma_f32_16x16x32_bf16 v[24:27], v[48:51], v[72:75], v[24:27]
    v_mfma_f32_16x16x32_bf16 v[28:31], v[48:51], v[76:79], v[28:31]
    v_mfma_f32_16x16x32_bf16 v[32:35], v[56:59], v[64:67], v[32:35]
    v_mfma_f32_16x16x32_bf16 v[36:39], v[56:59], v[68:71], v[36:39]
    v_mfma_f32_16x16x32_bf16 v[40:43], v[56:59], v[72:75], v[40:43]
    v_mfma_f32_16x16x32_bf16 v[44:47], v[56:59], v[76:79], v[44:47]
    v_mfma_f32_16x16x32_bf16 v[16:19], v[52:55], v[80:83], v[16:19]
    v_mfma_f32_16x16x32_bf16 v[20:23], v[52:55], v[84:87], v[20:23]
    v_mfma_f32_16x16x32_bf16 v[24:27], v[52:55], v[88:91], v[24:27]
    v_mfma_f32_16x16x32_bf16 v[28:31], v[52:55], v[92:95], v[28:31]
    v_mfma_f32_16x16x32_bf16 v[32:35], v[60:63], v[80:83], v[32:35]
    v_mfma_f32_16x16x32_bf16 v[36:39], v[60:63], v[84:87], v[36:39]
    v_mfma_f32_16x16x32_bf16 v[40:43], v[60:63], v[88:91], v[40:43]
    v_mfma_f32_16x16x32_bf16 v[44:47], v[60:63], v[92:95], v[44:47]
    s_add_u32 s68, s66, 8192
    s_add_u32 s69, s67, 896
    s_mov_b32 m0, s68
    s_add_u32 s68, s68, 1024
    buffer_load_dwordx4 v5, s[28:31], s69 offen lds
    s_add_u32 s69, s67, 9088
    s_mov_b32 m0, s68
    s_add_u32 s68, s68, 1024
    buffer_load_dwordx4 v5, s[28:31], s69 offen lds
    s_add_u32 s69, s67, 17280
    s_mov_b32 m0, s68
    s_add_u32 s68, s68, 1024
    buffer_load_dwordx4 v5, s[28:31], s69 offen lds
    s_add_u32 s69, s67, 25472
    s_mov_b32 m0, s68
    s_add_u32 s68, s68, 1024
    buffer_load_dwordx4 v5, s[28:31], s69 offen lds
    s_add_u32 s69, s67, 896
    s_mov_b32 m0, s68
    s_add_u32 s68, s68, 1024
    buffer_load_dwordx4 v5, s[32:35], s69 offen lds
    s_add_u32 s69, s67, 9088
    s_mov_b32 m0, s68
    s_add_u32 s68, s68, 1024
    buffer_load_dwordx4 v5, s[32:35], s69 offen lds
    s_add_u32 s69, s67, 17280
    s_mov_b32 m0, s68
    s_add_u32 s68, s68, 1024
    buffer_load_dwordx4 v5, s[32:35], s69 offen lds
    s_add_u32 s69, s67, 25472
    s_mov_b32 m0, s68
    s_add_u32 s68, s68, 1024
    buffer_load_dwordx4 v5, s[32:35], s69 offen lds
    s_waitcnt vmcnt(16)
    ds_read_b128 v[48:51], v6 offset:640
    ds_read_b128 v[56:59], v6 offset:17280
    ds_read_b128 v[64:67], v13 offset:16384
    ds_read_b128 v[68:71], v13 offset:18432
    ds_read_b128 v[72:75], v13 offset:20480
    ds_read_b128 v[76:79], v13 offset:22528
    ds_read_b128 v[52:55], v6 offset:704
    ds_read_b128 v[60:63], v6 offset:17344
    ds_read_b128 v[80:83], v14 offset:16384
    ds_read_b128 v[84:87], v14 offset:18432
    ds_read_b128 v[88:91], v14 offset:20480
    ds_read_b128 v[92:95], v14 offset:22528
    s_waitcnt lgkmcnt(0)
    v_mfma_f32_16x16x32_bf16 v[16:19], v[48:51], v[64:67], v[16:19]
    v_mfma_f32_16x16x32_bf16 v[20:23], v[48:51], v[68:71], v[20:23]
    v_mfma_f32_16x16x32_bf16 v[24:27], v[48:51], v[72:75], v[24:27]
    v_mfma_f32_16x16x32_bf16 v[28:31], v[48:51], v[76:79], v[28:31]
    v_mfma_f32_16x16x32_bf16 v[32:35], v[56:59], v[64:67], v[32:35]
    v_mfma_f32_16x16x32_bf16 v[36:39], v[56:59], v[68:71], v[36:39]
    v_mfma_f32_16x16x32_bf16 v[40:43], v[56:59], v[72:75], v[40:43]
    v_mfma_f32_16x16x32_bf16 v[44:47], v[56:59], v[76:79], v[44:47]
    v_mfma_f32_16x16x32_bf16 v[16:19], v[52:55], v[80:83], v[16:19]
    v_mfma_f32_16x16x32_bf16 v[20:23], v[52:55], v[84:87], v[20:23]
    v_mfma_f32_16x16x32_bf16 v[24:27], v[52:55], v[88:91], v[24:27]
    v_mfma_f32_16x16x32_bf16 v[28:31], v[52:55], v[92:95], v[28:31]
    v_mfma_f32_16x16x32_bf16 v[32:35], v[60:63], v[80:83], v[32:35]
    v_mfma_f32_16x16x32_bf16 v[36:39], v[60:63], v[84:87], v[36:39]
    v_mfma_f32_16x16x32_bf16 v[40:43], v[60:63], v[88:91], v[40:43]
    v_mfma_f32_16x16x32_bf16 v[44:47], v[60:63], v[92:95], v[44:47]
    s_waitcnt vmcnt(8)
    ds_read_b128 v[48:51], v6 offset:768
    ds_read_b128 v[56:59], v6 offset:17408
    ds_read_b128 v[64:67], v13 offset:0
    ds_read_b128 v[68:71], v13 offset:2048
    ds_read_b128 v[72:75], v13 offset:4096
    ds_read_b128 v[76:79], v13 offset:6144
    ds_read_b128 v[52:55], v6 offset:832
    ds_read_b128 v[60:63], v6 offset:17472
    ds_read_b128 v[80:83], v14 offset:0
    ds_read_b128 v[84:87], v14 offset:2048
    ds_read_b128 v[88:91], v14 offset:4096
    ds_read_b128 v[92:95], v14 offset:6144
    s_waitcnt lgkmcnt(0)
    v_mfma_f32_16x16x32_bf16 v[16:19], v[48:51], v[64:67], v[16:19]
    v_mfma_f32_16x16x32_bf16 v[20:23], v[48:51], v[68:71], v[20:23]
    v_mfma_f32_16x16x32_bf16 v[24:27], v[48:51], v[72:75], v[24:27]
    v_mfma_f32_16x16x32_bf16 v[28:31], v[48:51], v[76:79], v[28:31]
    v_mfma_f32_16x16x32_bf16 v[32:35], v[56:59], v[64:67], v[32:35]
    v_mfma_f32_16x16x32_bf16 v[36:39], v[56:59], v[68:71], v[36:39]
    v_mfma_f32_16x16x32_bf16 v[40:43], v[56:59], v[72:75], v[40:43]
    v_mfma_f32_16x16x32_bf16 v[44:47], v[56:59], v[76:79], v[44:47]
    v_mfma_f32_16x16x32_bf16 v[16:19], v[52:55], v[80:83], v[16:19]
    v_mfma_f32_16x16x32_bf16 v[20:23], v[52:55], v[84:87], v[20:23]
    v_mfma_f32_16x16x32_bf16 v[24:27], v[52:55], v[88:91], v[24:27]
    v_mfma_f32_16x16x32_bf16 v[28:31], v[52:55], v[92:95], v[28:31]
    v_mfma_f32_16x16x32_bf16 v[32:35], v[60:63], v[80:83], v[32:35]
    v_mfma_f32_16x16x32_bf16 v[36:39], v[60:63], v[84:87], v[36:39]
    v_mfma_f32_16x16x32_bf16 v[40:43], v[60:63], v[88:91], v[40:43]
    v_mfma_f32_16x16x32_bf16 v[44:47], v[60:63], v[92:95], v[44:47]
    s_waitcnt vmcnt(0)
    ds_read_b128 v[48:51], v6 offset:896
    ds_read_b128 v[56:59], v6 offset:17536
    ds_read_b128 v[64:67], v13 offset:8192
    ds_read_b128 v[68:71], v13 offset:10240
    ds_read_b128 v[72:75], v13 offset:12288
    ds_read_b128 v[76:79], v13 offset:14336
    ds_read_b128 v[52:55], v6 offset:960
    ds_read_b128 v[60:63], v6 offset:17600
    ds_read_b128 v[80:83], v14 offset:8192
    ds_read_b128 v[84:87], v14 offset:10240
    ds_read_b128 v[88:91], v14 offset:12288
    ds_read_b128 v[92:95], v14 offset:14336
    s_waitcnt lgkmcnt(0)
    v_mfma_f32_16x16x32_bf16 v[16:19], v[48:51], v[64:67], v[16:19]
    v_mfma_f32_16x16x32_bf16 v[20:23], v[48:51], v[68:71], v[20:23]
    v_mfma_f32_16x16x32_bf16 v[24:27], v[48:51], v[72:75], v[24:27]
    v_mfma_f32_16x16x32_bf16 v[28:31], v[48:51], v[76:79], v[28:31]
    v_mfma_f32_16x16x32_bf16 v[32:35], v[56:59], v[64:67], v[32:35]
    v_mfma_f32_16x16x32_bf16 v[36:39], v[56:59], v[68:71], v[36:39]
    v_mfma_f32_16x16x32_bf16 v[40:43], v[56:59], v[72:75], v[40:43]
    v_mfma_f32_16x16x32_bf16 v[44:47], v[56:59], v[76:79], v[44:47]
    v_mfma_f32_16x16x32_bf16 v[16:19], v[52:55], v[80:83], v[16:19]
    v_mfma_f32_16x16x32_bf16 v[20:23], v[52:55], v[84:87], v[20:23]
    v_mfma_f32_16x16x32_bf16 v[24:27], v[52:55], v[88:91], v[24:27]
    v_mfma_f32_16x16x32_bf16 v[28:31], v[52:55], v[92:95], v[28:31]
    v_mfma_f32_16x16x32_bf16 v[32:35], v[60:63], v[80:83], v[32:35]
    v_mfma_f32_16x16x32_bf16 v[36:39], v[60:63], v[84:87], v[36:39]
    v_mfma_f32_16x16x32_bf16 v[40:43], v[60:63], v[88:91], v[40:43]
    v_mfma_f32_16x16x32_bf16 v[44:47], v[60:63], v[92:95], v[44:47]
    s_nop 7
    s_nop 7
    v_add_u32 v64, s61, v7
    v_lshlrev_b32 v64, 1, v64
    buffer_load_ushort v66, v64, s[44:47], 0 offen
    buffer_load_ushort v67, v64, s[48:51], 0 offen
    buffer_load_ushort v68, v64, s[52:55], 0 offen
    buffer_load_ushort v69, v64, s[44:47], 0 offen offset:32
    buffer_load_ushort v70, v64, s[48:51], 0 offen offset:32
    buffer_load_ushort v71, v64, s[52:55], 0 offen offset:32
    s_waitcnt vmcnt(0)

    v_lshlrev_b32 v66, 16, v66
    v_lshlrev_b32 v67, 16, v67
    v_lshlrev_b32 v68, 16, v68
    v_lshlrev_b32 v69, 16, v69
    v_lshlrev_b32 v70, 16, v70
    v_lshlrev_b32 v71, 16, v71
    v_mul_f32 v80, 0x3fb8aa3b, v68
    v_exp_f32 v80, v80
    s_nop 0
    v_cvt_pk_bf16_f32 v80, v80, v80
    v_lshlrev_b32 v80, 16, v80
    v_mul_f32 v81, v80, v66
    v_mul_f32 v82, v80, v67
    v_mul_f32 v81, 0x3fb8aa3b, v81
    v_exp_f32 v81, v81
    v_mul_f32 v82, 0x3e22f983, v82
    v_cos_f32 v83, v82
    v_sin_f32 v84, v82
    s_nop 0
    v_mul_f32 v72, v81, v83
    v_mul_f32 v73, v81, v84
    v_mul_f32 v80, v66, v66
    v_fma_f32 v80, v67, v67, v80
    v_rcp_f32 v80, v80
    v_add_f32 v81, -1.0, v72
    v_mul_f32 v82, v81, v66
    v_fma_f32 v82, v73, v67, v82
    v_mul_f32 v83, v73, v66
    v_fma_f32 v83, -v81, v67, v83
    v_mul_f32 v74, v82, v80
    v_mul_f32 v75, v83, v80
    v_mul_f32 v80, 0x3fb8aa3b, v71
    v_exp_f32 v80, v80
    s_nop 0
    v_cvt_pk_bf16_f32 v80, v80, v80
    v_lshlrev_b32 v80, 16, v80
    v_mul_f32 v81, v80, v69
    v_mul_f32 v82, v80, v70
    v_mul_f32 v81, 0x3fb8aa3b, v81
    v_exp_f32 v81, v81
    v_mul_f32 v82, 0x3e22f983, v82
    v_cos_f32 v83, v82
    v_sin_f32 v84, v82
    s_nop 0
    v_mul_f32 v76, v81, v83
    v_mul_f32 v77, v81, v84
    v_mul_f32 v80, v69, v69
    v_fma_f32 v80, v70, v70, v80
    v_rcp_f32 v80, v80
    v_add_f32 v81, -1.0, v76
    v_mul_f32 v82, v81, v69
    v_fma_f32 v82, v77, v70, v82
    v_mul_f32 v83, v77, v69
    v_fma_f32 v83, -v81, v70, v83
    v_mul_f32 v78, v82, v80
    v_mul_f32 v79, v83, v80
    s_lshl_b32 s63, s56, 17
    v_lshlrev_b32 v90, 14, v8
    v_add_u32 v90, s63, v90
    v_add_u32 v91, s61, v7
    v_lshlrev_b32 v91, 2, v91
    v_add_u32 v90, v90, v91

    v_mul_f32 v89, v73, v73
    v_fma_f32 v89, v72, v72, -v89
    v_mul_f32 v93, v73, v72
    v_fma_f32 v93, v72, v73, v93
    v_mov_b32 v92, v89
    v_mul_f32 v89, v93, v93
    v_fma_f32 v89, v92, v92, -v89
    v_mul_f32 v95, v93, v92
    v_fma_f32 v95, v92, v93, v95
    v_mov_b32 v94, v89
    v_mul_f32 v89, v95, v95
    v_fma_f32 v89, v94, v94, -v89
    v_mul_f32 v97, v95, v94
    v_fma_f32 v97, v94, v95, v97
    v_mov_b32 v96, v89
    v_mul_f32 v89, v97, v95
    v_fma_f32 v89, v96, v94, -v89
    v_mul_f32 v99, v97, v94
    v_fma_f32 v99, v96, v95, v99
    v_mov_b32 v98, v89
    v_mul_f32 v89, v99, v73
    v_fma_f32 v89, v98, v72, -v89
    v_mul_f32 v87, v99, v72
    v_fma_f32 v87, v98, v73, v87
    v_mov_b32 v86, v89
    v_mul_f32 v104, v75, v24
    v_fma_f32 v104, v74, v16, -v104
    v_mul_f32 v105, v75, v16
    v_fma_f32 v105, v74, v24, v105
    v_add_u32 v106, 0x0, v90
    buffer_store_dword v104, v106, s[36:39], 0 offen
    buffer_store_dword v105, v106, s[36:39], 0 offen offset:2048
    v_mov_b32 v100, v104
    v_mov_b32 v101, v105
    v_mul_f32 v104, v75, v25
    v_fma_f32 v104, v74, v17, -v104
    v_mul_f32 v105, v75, v17
    v_fma_f32 v105, v74, v25, v105
    v_add_u32 v106, 0x1000, v90
    buffer_store_dword v104, v106, s[36:39], 0 offen
    buffer_store_dword v105, v106, s[36:39], 0 offen offset:2048
    v_mul_f32 v107, v101, v73
    v_fma_f32 v107, v100, v72, -v107
    v_mul_f32 v108, v101, v72
    v_fma_f32 v108, v100, v73, v108
    v_add_f32 v100, v107, v104
    v_add_f32 v101, v108, v105
    v_mul_f32 v104, v75, v26
    v_fma_f32 v104, v74, v18, -v104
    v_mul_f32 v105, v75, v18
    v_fma_f32 v105, v74, v26, v105
    v_add_u32 v106, 0x2000, v90
    buffer_store_dword v104, v106, s[36:39], 0 offen
    buffer_store_dword v105, v106, s[36:39], 0 offen offset:2048
    v_mul_f32 v107, v101, v73
    v_fma_f32 v107, v100, v72, -v107
    v_mul_f32 v108, v101, v72
    v_fma_f32 v108, v100, v73, v108
    v_add_f32 v100, v107, v104
    v_add_f32 v101, v108, v105
    v_mul_f32 v104, v75, v27
    v_fma_f32 v104, v74, v19, -v104
    v_mul_f32 v105, v75, v19
    v_fma_f32 v105, v74, v27, v105
    v_add_u32 v106, 0x3000, v90
    buffer_store_dword v104, v106, s[36:39], 0 offen
    buffer_store_dword v105, v106, s[36:39], 0 offen offset:2048
    v_mul_f32 v107, v101, v73
    v_fma_f32 v107, v100, v72, -v107
    v_mul_f32 v108, v101, v72
    v_fma_f32 v108, v100, v73, v108
    v_add_f32 v100, v107, v104
    v_add_f32 v101, v108, v105
    v_mul_f32 v104, v75, v40
    v_fma_f32 v104, v74, v32, -v104
    v_mul_f32 v105, v75, v32
    v_fma_f32 v105, v74, v40, v105
    v_add_u32 v106, 0x10000, v90
    buffer_store_dword v104, v106, s[36:39], 0 offen
    buffer_store_dword v105, v106, s[36:39], 0 offen offset:2048
    v_mul_f32 v107, v101, v87
    v_fma_f32 v107, v100, v86, -v107
    v_mul_f32 v108, v101, v86
    v_fma_f32 v108, v100, v87, v108
    v_add_f32 v100, v107, v104
    v_add_f32 v101, v108, v105
    v_mul_f32 v104, v75, v41
    v_fma_f32 v104, v74, v33, -v104
    v_mul_f32 v105, v75, v33
    v_fma_f32 v105, v74, v41, v105
    v_add_u32 v106, 0x11000, v90
    buffer_store_dword v104, v106, s[36:39], 0 offen
    buffer_store_dword v105, v106, s[36:39], 0 offen offset:2048
    v_mul_f32 v107, v101, v73
    v_fma_f32 v107, v100, v72, -v107
    v_mul_f32 v108, v101, v72
    v_fma_f32 v108, v100, v73, v108
    v_add_f32 v100, v107, v104
    v_add_f32 v101, v108, v105
    v_mul_f32 v104, v75, v42
    v_fma_f32 v104, v74, v34, -v104
    v_mul_f32 v105, v75, v34
    v_fma_f32 v105, v74, v42, v105
    v_add_u32 v106, 0x12000, v90
    buffer_store_dword v104, v106, s[36:39], 0 offen
    buffer_store_dword v105, v106, s[36:39], 0 offen offset:2048
    v_mul_f32 v107, v101, v73
    v_fma_f32 v107, v100, v72, -v107
    v_mul_f32 v108, v101, v72
    v_fma_f32 v108, v100, v73, v108
    v_add_f32 v100, v107, v104
    v_add_f32 v101, v108, v105
    v_mul_f32 v104, v75, v43
    v_fma_f32 v104, v74, v35, -v104
    v_mul_f32 v105, v75, v35
    v_fma_f32 v105, v74, v43, v105
    v_add_u32 v106, 0x13000, v90
    buffer_store_dword v104, v106, s[36:39], 0 offen
    buffer_store_dword v105, v106, s[36:39], 0 offen offset:2048
    v_mul_f32 v107, v101, v73
    v_fma_f32 v107, v100, v72, -v107
    v_mul_f32 v108, v101, v72
    v_fma_f32 v108, v100, v73, v108
    v_add_f32 v100, v107, v104
    v_add_f32 v101, v108, v105
    v_mov_b32 v107, 1.0
    v_mov_b32 v108, 0
    v_cmp_eq_u32 vcc, 2, v8
    s_nop 1
    v_cndmask_b32 v107, v107, v94, vcc
    v_cndmask_b32 v108, v108, v95, vcc
    v_cmp_eq_u32 vcc, 1, v8
    s_nop 1
    v_cndmask_b32 v107, v107, v96, vcc
    v_cndmask_b32 v108, v108, v97, vcc
    v_cmp_eq_u32 vcc, 0, v8
    s_nop 1
    v_cndmask_b32 v107, v107, v98, vcc
    v_cndmask_b32 v108, v108, v99, vcc

    v_mul_f32 v89, v101, v108
    v_fma_f32 v89, v100, v107, -v89
    v_mul_f32 v110, v101, v107
    v_fma_f32 v110, v100, v108, v110
    v_mov_b32 v109, v89
    v_mov_b32 v100, v109
    v_mov_b32 v101, v110
    v_mul_f32 v89, v77, v77
    v_fma_f32 v89, v76, v76, -v89
    v_mul_f32 v93, v77, v76
    v_fma_f32 v93, v76, v77, v93
    v_mov_b32 v92, v89
    v_mul_f32 v89, v93, v93
    v_fma_f32 v89, v92, v92, -v89
    v_mul_f32 v95, v93, v92
    v_fma_f32 v95, v92, v93, v95
    v_mov_b32 v94, v89
    v_mul_f32 v89, v95, v95
    v_fma_f32 v89, v94, v94, -v89
    v_mul_f32 v97, v95, v94
    v_fma_f32 v97, v94, v95, v97
    v_mov_b32 v96, v89
    v_mul_f32 v89, v97, v95
    v_fma_f32 v89, v96, v94, -v89
    v_mul_f32 v99, v97, v94
    v_fma_f32 v99, v96, v95, v99
    v_mov_b32 v98, v89
    v_mul_f32 v89, v99, v77
    v_fma_f32 v89, v98, v76, -v89
    v_mul_f32 v87, v99, v76
    v_fma_f32 v87, v98, v77, v87
    v_mov_b32 v86, v89
    v_mul_f32 v104, v79, v28
    v_fma_f32 v104, v78, v20, -v104
    v_mul_f32 v105, v79, v20
    v_fma_f32 v105, v78, v28, v105
    v_add_u32 v106, 0x40, v90
    buffer_store_dword v104, v106, s[36:39], 0 offen
    buffer_store_dword v105, v106, s[36:39], 0 offen offset:2048
    v_mov_b32 v102, v104
    v_mov_b32 v103, v105
    v_mul_f32 v104, v79, v29
    v_fma_f32 v104, v78, v21, -v104
    v_mul_f32 v105, v79, v21
    v_fma_f32 v105, v78, v29, v105
    v_add_u32 v106, 0x1040, v90
    buffer_store_dword v104, v106, s[36:39], 0 offen
    buffer_store_dword v105, v106, s[36:39], 0 offen offset:2048
    v_mul_f32 v107, v103, v77
    v_fma_f32 v107, v102, v76, -v107
    v_mul_f32 v108, v103, v76
    v_fma_f32 v108, v102, v77, v108
    v_add_f32 v102, v107, v104
    v_add_f32 v103, v108, v105
    v_mul_f32 v104, v79, v30
    v_fma_f32 v104, v78, v22, -v104
    v_mul_f32 v105, v79, v22
    v_fma_f32 v105, v78, v30, v105
    v_add_u32 v106, 0x2040, v90
    buffer_store_dword v104, v106, s[36:39], 0 offen
    buffer_store_dword v105, v106, s[36:39], 0 offen offset:2048
    v_mul_f32 v107, v103, v77
    v_fma_f32 v107, v102, v76, -v107
    v_mul_f32 v108, v103, v76
    v_fma_f32 v108, v102, v77, v108
    v_add_f32 v102, v107, v104
    v_add_f32 v103, v108, v105
    v_mul_f32 v104, v79, v31
    v_fma_f32 v104, v78, v23, -v104
    v_mul_f32 v105, v79, v23
    v_fma_f32 v105, v78, v31, v105
    v_add_u32 v106, 0x3040, v90
    buffer_store_dword v104, v106, s[36:39], 0 offen
    buffer_store_dword v105, v106, s[36:39], 0 offen offset:2048
    v_mul_f32 v107, v103, v77
    v_fma_f32 v107, v102, v76, -v107
    v_mul_f32 v108, v103, v76
    v_fma_f32 v108, v102, v77, v108
    v_add_f32 v102, v107, v104
    v_add_f32 v103, v108, v105
    v_mul_f32 v104, v79, v44
    v_fma_f32 v104, v78, v36, -v104
    v_mul_f32 v105, v79, v36
    v_fma_f32 v105, v78, v44, v105
    v_add_u32 v106, 0x10040, v90
    buffer_store_dword v104, v106, s[36:39], 0 offen
    buffer_store_dword v105, v106, s[36:39], 0 offen offset:2048
    v_mul_f32 v107, v103, v87
    v_fma_f32 v107, v102, v86, -v107
    v_mul_f32 v108, v103, v86
    v_fma_f32 v108, v102, v87, v108
    v_add_f32 v102, v107, v104
    v_add_f32 v103, v108, v105
    v_mul_f32 v104, v79, v45
    v_fma_f32 v104, v78, v37, -v104
    v_mul_f32 v105, v79, v37
    v_fma_f32 v105, v78, v45, v105
    v_add_u32 v106, 0x11040, v90
    buffer_store_dword v104, v106, s[36:39], 0 offen
    buffer_store_dword v105, v106, s[36:39], 0 offen offset:2048
    v_mul_f32 v107, v103, v77
    v_fma_f32 v107, v102, v76, -v107
    v_mul_f32 v108, v103, v76
    v_fma_f32 v108, v102, v77, v108
    v_add_f32 v102, v107, v104
    v_add_f32 v103, v108, v105
    v_mul_f32 v104, v79, v46
    v_fma_f32 v104, v78, v38, -v104
    v_mul_f32 v105, v79, v38
    v_fma_f32 v105, v78, v46, v105
    v_add_u32 v106, 0x12040, v90
    buffer_store_dword v104, v106, s[36:39], 0 offen
    buffer_store_dword v105, v106, s[36:39], 0 offen offset:2048
    v_mul_f32 v107, v103, v77
    v_fma_f32 v107, v102, v76, -v107
    v_mul_f32 v108, v103, v76
    v_fma_f32 v108, v102, v77, v108
    v_add_f32 v102, v107, v104
    v_add_f32 v103, v108, v105
    v_mul_f32 v104, v79, v47
    v_fma_f32 v104, v78, v39, -v104
    v_mul_f32 v105, v79, v39
    v_fma_f32 v105, v78, v47, v105
    v_add_u32 v106, 0x13040, v90
    buffer_store_dword v104, v106, s[36:39], 0 offen
    buffer_store_dword v105, v106, s[36:39], 0 offen offset:2048
    v_mul_f32 v107, v103, v77
    v_fma_f32 v107, v102, v76, -v107
    v_mul_f32 v108, v103, v76
    v_fma_f32 v108, v102, v77, v108
    v_add_f32 v102, v107, v104
    v_add_f32 v103, v108, v105
    v_mov_b32 v107, 1.0
    v_mov_b32 v108, 0
    v_cmp_eq_u32 vcc, 2, v8
    s_nop 1
    v_cndmask_b32 v107, v107, v94, vcc
    v_cndmask_b32 v108, v108, v95, vcc
    v_cmp_eq_u32 vcc, 1, v8
    s_nop 1
    v_cndmask_b32 v107, v107, v96, vcc
    v_cndmask_b32 v108, v108, v97, vcc
    v_cmp_eq_u32 vcc, 0, v8
    s_nop 1
    v_cndmask_b32 v107, v107, v98, vcc
    v_cndmask_b32 v108, v108, v99, vcc

    v_mul_f32 v89, v103, v108
    v_fma_f32 v89, v102, v107, -v89
    v_mul_f32 v110, v103, v107
    v_fma_f32 v110, v102, v108, v110
    v_mov_b32 v109, v89
    v_mov_b32 v102, v109
    v_mov_b32 v103, v110
    v_mov_b32 v112, v100
    v_mov_b32 v113, v101
    v_mov_b32 v114, v102
    v_mov_b32 v115, v103
    s_nop 1
    v_permlane16_swap_b32 v100, v112
    v_permlane16_swap_b32 v101, v113
    v_permlane16_swap_b32 v102, v114
    v_permlane16_swap_b32 v103, v115
    v_add_f32 v100, v100, v112
    v_add_f32 v101, v101, v113
    v_add_f32 v102, v102, v114
    v_add_f32 v103, v103, v115
    v_mov_b32 v112, v100
    v_mov_b32 v113, v101
    v_mov_b32 v114, v102
    v_mov_b32 v115, v103
    s_nop 1
    v_permlane32_swap_b32 v100, v112
    v_permlane32_swap_b32 v101, v113
    v_permlane32_swap_b32 v102, v114
    v_permlane32_swap_b32 v103, v115
    v_add_f32 v100, v100, v112
    v_add_f32 v101, v101, v113
    v_add_f32 v102, v102, v114
    v_add_f32 v103, v103, v115
    s_lshl_b32 s63, s56, 12
    v_add_u32 v91, s61, v7
    v_lshlrev_b32 v91, 2, v91
    v_add_u32 v91, s63, v91
    v_cmp_gt_u32 vcc, 16, v1
    s_and_saveexec_b64 s[64:65], vcc
    buffer_store_dword v100, v91, s[40:43], 0 offen
    buffer_store_dword v101, v91, s[40:43], 0 offen offset:2048
    buffer_store_dword v102, v91, s[40:43], 0 offen offset:64
    buffer_store_dword v103, v91, s[40:43], 0 offen offset:2112
    s_mov_b64 exec, s[64:65]
    s_endpgm

K0_TRANS:
    s_load_dwordx2 s[4:5], s[0:1], 80
    s_load_dwordx2 s[6:7], s[0:1], 88
    s_load_dwordx2 s[8:9], s[0:1], 96
    s_load_dwordx2 s[16:17], s[0:1], 120
    s_sub_u32 s56, s2, 256
    v_lshrrev_b32 v1, 3, v0
    v_and_b32 v2, 7, v0
    v_mul_u32_u24 v3, 1152, v2
    v_lshl_add_u32 v3, v1, 1, v3
    v_mul_u32_u24 v4, 144, v1
    v_lshl_add_u32 v4, v2, 4, v4
    s_waitcnt lgkmcnt(0)
    s_cmp_ge_u32 s56, 448
    s_cbranch_scc1 K0_T_DOWN

    s_add_u32 s24, s16, 0x200000
    s_addc_u32 s25, s17, 0
    s_and_b32 s25, s25, 0xffff
    s_mov_b32 s26, 0x380000
    s_mov_b32 s27, 0x20000
    s_cmp_ge_u32 s56, 224
    s_cbranch_scc1 K0_T_UP

    s_mov_b32 s20, s4
    s_and_b32 s21, s5, 0xffff
    s_mov_b32 s22, 0x1c0000
    s_mov_b32 s23, 0x20000
    s_mov_b32 s57, 0
    s_branch K0_T_GU
K0_T_UP:

    s_mov_b32 s20, s6
    s_and_b32 s21, s7, 0xffff
    s_mov_b32 s22, 0x1c0000
    s_mov_b32 s23, 0x20000
    s_sub_u32 s56, s56, 224
    s_mov_b32 s57, 64
K0_T_GU:
    s_and_b32 s58, s56, 7
    s_lshr_b32 s59, s56, 3
    s_mul_i32 s60, s58, 229376
    s_lshl_b32 s61, s59, 7
    s_add_u32 s60, s60, s61
    v_mul_u32_u24 v5, 3584, v1
    v_lshl_add_u32 v5, v2, 4, v5
    s_mov_b32 s62, 114688
    s_lshl_b32 s61, s59, 7
    s_add_u32 s61, s61, s57
    s_lshl_b32 s61, s61, 10
    s_lshl_b32 s63, s58, 7
    s_add_u32 s61, s61, s63
    v_lshlrev_b32 v6, 10, v1
    v_lshl_add_u32 v6, v2, 4, v6
    s_mov_b32 s63, 32768
    s_branch K0_T_BODY
K0_T_DOWN:

    s_add_u32 s24, s16, 0x600000
    s_addc_u32 s25, s17, 0
    s_and_b32 s25, s25, 0xffff
    s_mov_b32 s26, 0x1c0000
    s_mov_b32 s27, 0x20000
    s_mov_b32 s20, s8
    s_and_b32 s21, s9, 0xffff
    s_mov_b32 s22, 0x1c0000
    s_mov_b32 s23, 0x20000
    s_sub_u32 s56, s56, 448
    s_and_b32 s59, s56, 7
    s_lshr_b32 s58, s56, 3
    s_lshl_b32 s60, s58, 16
    s_lshl_b32 s61, s59, 7
    s_add_u32 s60, s60, s61
    v_lshlrev_b32 v5, 10, v1
    v_lshl_add_u32 v5, v2, 4, v5
    s_mov_b32 s62, 32768
    s_mul_i32 s61, s59, 229376
    s_lshl_b32 s63, s58, 7
    s_add_u32 s61, s61, s63
    v_mul_u32_u24 v6, 3584, v1
    v_lshl_add_u32 v6, v2, 4, v6
    s_mov_b32 s63, 114688
K0_T_BODY:
    buffer_load_dwordx4 v[8:11], v5, s[20:23], s60 offen
    s_add_u32 s60, s60, s62
    buffer_load_dwordx4 v[12:15], v5, s[20:23], s60 offen

    s_waitcnt vmcnt(1)
    ds_write_b16 v3, v8 offset:0
    ds_write_b16_d16_hi v3, v8 offset:144
    ds_write_b16 v3, v9 offset:288
    ds_write_b16_d16_hi v3, v9 offset:432
    ds_write_b16 v3, v10 offset:576
    ds_write_b16_d16_hi v3, v10 offset:720
    ds_write_b16 v3, v11 offset:864
    ds_write_b16_d16_hi v3, v11 offset:1008
    s_waitcnt vmcnt(0)
    ds_write_b16 v3, v12 offset:64
    ds_write_b16_d16_hi v3, v12 offset:208
    ds_write_b16 v3, v13 offset:352
    ds_write_b16_d16_hi v3, v13 offset:496
    ds_write_b16 v3, v14 offset:640
    ds_write_b16_d16_hi v3, v14 offset:784
    ds_write_b16 v3, v15 offset:928
    ds_write_b16_d16_hi v3, v15 offset:1072
    s_waitcnt lgkmcnt(0)
    s_barrier
    ds_read_b128 v[8:11], v4
    ds_read_b128 v[12:15], v4 offset:4608
    s_waitcnt lgkmcnt(1)
    buffer_store_dwordx4 v[8:11], v6, s[24:27], s61 offen
    s_add_u32 s61, s61, s63
    s_waitcnt lgkmcnt(0)
    buffer_store_dwordx4 v[12:15], v6, s[24:27], s61 offen
K0_EXIT:
    s_endpgm

.p2align 8
.type k1_kernel,@function
k1_kernel:
    s_cmp_ge_u32 s2, 256
    s_cbranch_scc1 K1_EXIT
    s_cmp_lt_u32 s2, 32
    s_cbranch_scc1 K1_SCAN
    s_load_dwordx2 s[16:17], s[0:1], 120
    v_and_b32 v1, 63, v0
    v_lshrrev_b32 v2, 6, v0
    s_sub_u32 s56, s2, 32
    s_and_b32 s57, s56, 7
    s_lshl_b32 s57, s57, 1
    s_lshr_b32 s58, s56, 3
    s_cmp_ge_u32 s58, 14
    s_cbranch_scc0 K1_NOADJ
    s_add_u32 s57, s57, 1
    s_sub_u32 s58, s58, 14
K1_NOADJ:
    v_readfirstlane_b32 s59, v2
    s_waitcnt lgkmcnt(0)

    s_mov_b32 s20, s16
    s_and_b32 s21, s17, 0xffff
    s_mov_b32 s22, 0x200000
    s_mov_b32 s23, 0x20000
    s_add_u32 s24, s16, 0x200000
    s_addc_u32 s25, s17, 0
    s_and_b32 s25, s25, 0xffff
    s_mov_b32 s26, 0x380000
    s_mov_b32 s27, 0x20000
    s_add_u32 s28, s16, 0x1600000
    s_addc_u32 s29, s17, 0
    s_and_b32 s29, s29, 0xffff
    s_mov_b32 s30, 0x700000
    s_mov_b32 s31, 0x20000
    v_lshrrev_b32 v4, 3, v1
    v_and_b32 v5, 7, v1
    v_xor_b32 v5, v5, v4
    v_lshlrev_b32 v3, 10, v4
    v_lshl_add_u32 v3, v5, 4, v3

    s_lshl_b32 s60, s57, 17
    s_lshl_b32 s61, s59, 15
    s_add_u32 s60, s60, s61
    s_lshl_b32 s61, s58, 18
    s_lshl_b32 s62, s59, 16
    s_add_u32 s61, s61, s62
    s_lshl_b32 s62, s59, 12
    s_lshl_b32 s63, s59, 13
    s_add_u32 s63, s63, 16384

    v_and_b32 v16, 15, v1
    v_lshrrev_b32 v17, 4, v1
    v_and_b32 v18, 7, v1
    v_xor_b32 v19, v17, v18
    v_lshlrev_b32 v20, 7, v16
    v_lshl_add_u32 v21, v19, 4, v20
    v_xor_b32 v19, 4, v19
    v_lshl_add_u32 v22, v19, 4, v20
    s_lshr_b32 s64, s59, 1
    s_lshl_b32 s64, s64, 13
    s_and_b32 s65, s59, 1
    s_lshl_b32 s65, s65, 14
    s_add_u32 s65, s65, 16384

    v_add_u32 v4, s64, v21
    v_add_u32 v5, s64, v22
    v_add_u32 v6, s65, v21
    v_add_u32 v7, s65, v22
    v_add_u32 v8, s64, v21
    v_add_u32 v9, s64, v22
    v_add_u32 v10, s65, v21
    v_add_u32 v11, s65, v22
    v_add_u32 v8, 49152, v8
    v_add_u32 v9, 49152, v9
    v_add_u32 v10, 49152, v10
    v_add_u32 v11, 49152, v11
    v_add_u32 v12, s64, v21
    v_add_u32 v13, s64, v22
    v_add_u32 v14, s65, v21
    v_add_u32 v15, s65, v22
    v_add_u32 v12, 98304, v12
    v_add_u32 v13, 98304, v13
    v_add_u32 v14, 98304, v14
    v_add_u32 v15, 98304, v15
    v_accvgpr_write_b32 a0, 0
    v_accvgpr_write_b32 a1, 0
    v_accvgpr_write_b32 a2, 0
    v_accvgpr_write_b32 a3, 0
    v_accvgpr_write_b32 a4, 0
    v_accvgpr_write_b32 a5, 0
    v_accvgpr_write_b32 a6, 0
    v_accvgpr_write_b32 a7, 0
    v_accvgpr_write_b32 a8, 0
    v_accvgpr_write_b32 a9, 0
    v_accvgpr_write_b32 a10, 0
    v_accvgpr_write_b32 a11, 0
    v_accvgpr_write_b32 a12, 0
    v_accvgpr_write_b32 a13, 0
    v_accvgpr_write_b32 a14, 0
    v_accvgpr_write_b32 a15, 0
    v_accvgpr_write_b32 a16, 0
    v_accvgpr_write_b32 a17, 0
    v_accvgpr_write_b32 a18, 0
    v_accvgpr_write_b32 a19, 0
    v_accvgpr_write_b32 a20, 0
    v_accvgpr_write_b32 a21, 0
    v_accvgpr_write_b32 a22, 0
    v_accvgpr_write_b32 a23, 0
    v_accvgpr_write_b32 a24, 0
    v_accvgpr_write_b32 a25, 0
    v_accvgpr_write_b32 a26, 0
    v_accvgpr_write_b32 a27, 0
    v_accvgpr_write_b32 a28, 0
    v_accvgpr_write_b32 a29, 0
    v_accvgpr_write_b32 a30, 0
    v_accvgpr_write_b32 a31, 0
    v_accvgpr_write_b32 a32, 0
    v_accvgpr_write_b32 a33, 0
    v_accvgpr_write_b32 a34, 0
    v_accvgpr_write_b32 a35, 0
    v_accvgpr_write_b32 a36, 0
    v_accvgpr_write_b32 a37, 0
    v_accvgpr_write_b32 a38, 0
    v_accvgpr_write_b32 a39, 0
    v_accvgpr_write_b32 a40, 0
    v_accvgpr_write_b32 a41, 0
    v_accvgpr_write_b32 a42, 0
    v_accvgpr_write_b32 a43, 0
    v_accvgpr_write_b32 a44, 0
    v_accvgpr_write_b32 a45, 0
    v_accvgpr_write_b32 a46, 0
    v_accvgpr_write_b32 a47, 0
    v_accvgpr_write_b32 a48, 0
    v_accvgpr_write_b32 a49, 0
    v_accvgpr_write_b32 a50, 0
    v_accvgpr_write_b32 a51, 0
    v_accvgpr_write_b32 a52, 0
    v_accvgpr_write_b32 a53, 0
    v_accvgpr_write_b32 a54, 0
    v_accvgpr_write_b32 a55, 0
    v_accvgpr_write_b32 a56, 0
    v_accvgpr_write_b32 a57, 0
    v_accvgpr_write_b32 a58, 0
    v_accvgpr_write_b32 a59, 0
    v_accvgpr_write_b32 a60, 0
    v_accvgpr_write_b32 a61, 0
    v_accvgpr_write_b32 a62, 0
    v_accvgpr_write_b32 a63, 0
    v_accvgpr_write_b32 a64, 0
    v_accvgpr_write_b32 a65, 0
    v_accvgpr_write_b32 a66, 0
    v_accvgpr_write_b32 a67, 0
    v_accvgpr_write_b32 a68, 0
    v_accvgpr_write_b32 a69, 0
    v_accvgpr_write_b32 a70, 0
    v_accvgpr_write_b32 a71, 0
    v_accvgpr_write_b32 a72, 0
    v_accvgpr_write_b32 a73, 0
    v_accvgpr_write_b32 a74, 0
    v_accvgpr_write_b32 a75, 0
    v_accvgpr_write_b32 a76, 0
    v_accvgpr_write_b32 a77, 0
    v_accvgpr_write_b32 a78, 0
    v_accvgpr_write_b32 a79, 0
    v_accvgpr_write_b32 a80, 0
    v_accvgpr_write_b32 a81, 0
    v_accvgpr_write_b32 a82, 0
    v_accvgpr_write_b32 a83, 0
    v_accvgpr_write_b32 a84, 0
    v_accvgpr_write_b32 a85, 0
    v_accvgpr_write_b32 a86, 0
    v_accvgpr_write_b32 a87, 0
    v_accvgpr_write_b32 a88, 0
    v_accvgpr_write_b32 a89, 0
    v_accvgpr_write_b32 a90, 0
    v_accvgpr_write_b32 a91, 0
    v_accvgpr_write_b32 a92, 0
    v_accvgpr_write_b32 a93, 0
    v_accvgpr_write_b32 a94, 0
    v_accvgpr_write_b32 a95, 0
    v_accvgpr_write_b32 a96, 0
    v_accvgpr_write_b32 a97, 0
    v_accvgpr_write_b32 a98, 0
    v_accvgpr_write_b32 a99, 0
    v_accvgpr_write_b32 a100, 0
    v_accvgpr_write_b32 a101, 0
    v_accvgpr_write_b32 a102, 0
    v_accvgpr_write_b32 a103, 0
    v_accvgpr_write_b32 a104, 0
    v_accvgpr_write_b32 a105, 0
    v_accvgpr_write_b32 a106, 0
    v_accvgpr_write_b32 a107, 0
    v_accvgpr_write_b32 a108, 0
    v_accvgpr_write_b32 a109, 0
    v_accvgpr_write_b32 a110, 0
    v_accvgpr_write_b32 a111, 0
    v_accvgpr_write_b32 a112, 0
    v_accvgpr_write_b32 a113, 0
    v_accvgpr_write_b32 a114, 0
    v_accvgpr_write_b32 a115, 0
    v_accvgpr_write_b32 a116, 0
    v_accvgpr_write_b32 a117, 0
    v_accvgpr_write_b32 a118, 0
    v_accvgpr_write_b32 a119, 0
    v_accvgpr_write_b32 a120, 0
    v_accvgpr_write_b32 a121, 0
    v_accvgpr_write_b32 a122, 0
    v_accvgpr_write_b32 a123, 0
    v_accvgpr_write_b32 a124, 0
    v_accvgpr_write_b32 a125, 0
    v_accvgpr_write_b32 a126, 0
    v_accvgpr_write_b32 a127, 0
    s_add_u32 s64, s60, 0
    s_add_u32 s65, s62, 0
    s_mov_b32 m0, s65
    s_nop 0
    buffer_load_dwordx4 v3, s[20:23], s64 offen lds
    s_add_u32 s64, s64, 8192
    s_add_u32 s65, s65, 1024
    s_mov_b32 m0, s65
    s_nop 0
    buffer_load_dwordx4 v3, s[20:23], s64 offen lds
    s_add_u32 s64, s64, 8192
    s_add_u32 s65, s65, 1024
    s_mov_b32 m0, s65
    s_nop 0
    buffer_load_dwordx4 v3, s[20:23], s64 offen lds
    s_add_u32 s64, s64, 8192
    s_add_u32 s65, s65, 1024
    s_mov_b32 m0, s65
    s_nop 0
    buffer_load_dwordx4 v3, s[20:23], s64 offen lds
    s_add_u32 s64, s61, 0
    s_add_u32 s65, s63, 0
    s_mov_b32 m0, s65
    s_nop 0
    buffer_load_dwordx4 v3, s[24:27], s64 offen lds
    s_add_u32 s64, s64, 8192
    s_add_u32 s65, s65, 1024
    s_mov_b32 m0, s65
    s_nop 0
    buffer_load_dwordx4 v3, s[24:27], s64 offen lds
    s_add_u32 s64, s64, 8192
    s_add_u32 s65, s65, 1024
    s_mov_b32 m0, s65
    s_nop 0
    buffer_load_dwordx4 v3, s[24:27], s64 offen lds
    s_add_u32 s64, s64, 8192
    s_add_u32 s65, s65, 1024
    s_mov_b32 m0, s65
    s_nop 0
    buffer_load_dwordx4 v3, s[24:27], s64 offen lds
    s_add_u32 s64, s64, 8192
    s_add_u32 s65, s65, 1024
    s_mov_b32 m0, s65
    s_nop 0
    buffer_load_dwordx4 v3, s[24:27], s64 offen lds
    s_add_u32 s64, s64, 8192
    s_add_u32 s65, s65, 1024
    s_mov_b32 m0, s65
    s_nop 0
    buffer_load_dwordx4 v3, s[24:27], s64 offen lds
    s_add_u32 s64, s64, 8192
    s_add_u32 s65, s65, 1024
    s_mov_b32 m0, s65
    s_nop 0
    buffer_load_dwordx4 v3, s[24:27], s64 offen lds
    s_add_u32 s64, s64, 8192
    s_add_u32 s65, s65, 1024
    s_mov_b32 m0, s65
    s_nop 0
    buffer_load_dwordx4 v3, s[24:27], s64 offen lds
    s_add_u32 s64, s60, 128
    s_add_u32 s65, s62, 49152
    s_mov_b32 m0, s65
    s_nop 0
    buffer_load_dwordx4 v3, s[20:23], s64 offen lds
    s_add_u32 s64, s64, 8192
    s_add_u32 s65, s65, 1024
    s_mov_b32 m0, s65
    s_nop 0
    buffer_load_dwordx4 v3, s[20:23], s64 offen lds
    s_add_u32 s64, s64, 8192
    s_add_u32 s65, s65, 1024
    s_mov_b32 m0, s65
    s_nop 0
    buffer_load_dwordx4 v3, s[20:23], s64 offen lds
    s_add_u32 s64, s64, 8192
    s_add_u32 s65, s65, 1024
    s_mov_b32 m0, s65
    s_nop 0
    buffer_load_dwordx4 v3, s[20:23], s64 offen lds
    s_add_u32 s64, s61, 128
    s_add_u32 s65, s63, 49152
    s_mov_b32 m0, s65
    s_nop 0
    buffer_load_dwordx4 v3, s[24:27], s64 offen lds
    s_add_u32 s64, s64, 8192
    s_add_u32 s65, s65, 1024
    s_mov_b32 m0, s65
    s_nop 0
    buffer_load_dwordx4 v3, s[24:27], s64 offen lds
    s_add_u32 s64, s64, 8192
    s_add_u32 s65, s65, 1024
    s_mov_b32 m0, s65
    s_nop 0
    buffer_load_dwordx4 v3, s[24:27], s64 offen lds
    s_add_u32 s64, s64, 8192
    s_add_u32 s65, s65, 1024
    s_mov_b32 m0, s65
    s_nop 0
    buffer_load_dwordx4 v3, s[24:27], s64 offen lds
    s_add_u32 s64, s64, 8192
    s_add_u32 s65, s65, 1024
    s_mov_b32 m0, s65
    s_nop 0
    buffer_load_dwordx4 v3, s[24:27], s64 offen lds
    s_add_u32 s64, s64, 8192
    s_add_u32 s65, s65, 1024
    s_mov_b32 m0, s65
    s_nop 0
    buffer_load_dwordx4 v3, s[24:27], s64 offen lds
    s_add_u32 s64, s64, 8192
    s_add_u32 s65, s65, 1024
    s_mov_b32 m0, s65
    s_nop 0
    buffer_load_dwordx4 v3, s[24:27], s64 offen lds
    s_add_u32 s64, s64, 8192
    s_add_u32 s65, s65, 1024
    s_mov_b32 m0, s65
    s_nop 0
    buffer_load_dwordx4 v3, s[24:27], s64 offen lds
    s_waitcnt vmcnt(12)
    s_barrier
    s_add_u32 s64, s60, 256
    s_add_u32 s65, s62, 98304
    s_mov_b32 m0, s65
    s_nop 0
    buffer_load_dwordx4 v3, s[20:23], s64 offen lds
    s_add_u32 s64, s64, 8192
    s_add_u32 s65, s65, 1024
    s_mov_b32 m0, s65
    s_nop 0
    buffer_load_dwordx4 v3, s[20:23], s64 offen lds
    s_add_u32 s64, s64, 8192
    s_add_u32 s65, s65, 1024
    s_mov_b32 m0, s65
    s_nop 0
    buffer_load_dwordx4 v3, s[20:23], s64 offen lds
    s_add_u32 s64, s64, 8192
    s_add_u32 s65, s65, 1024
    s_mov_b32 m0, s65
    s_nop 0
    buffer_load_dwordx4 v3, s[20:23], s64 offen lds
    s_add_u32 s64, s61, 256
    s_add_u32 s65, s63, 98304
    s_mov_b32 m0, s65
    s_nop 0
    buffer_load_dwordx4 v3, s[24:27], s64 offen lds
    s_add_u32 s64, s64, 8192
    s_add_u32 s65, s65, 1024
    s_mov_b32 m0, s65
    s_nop 0
    buffer_load_dwordx4 v3, s[24:27], s64 offen lds
    s_add_u32 s64, s64, 8192
    s_add_u32 s65, s65, 1024
    s_mov_b32 m0, s65
    s_nop 0
    buffer_load_dwordx4 v3, s[24:27], s64 offen lds
    s_add_u32 s64, s64, 8192
    s_add_u32 s65, s65, 1024
    s_mov_b32 m0, s65
    s_nop 0
    buffer_load_dwordx4 v3, s[24:27], s64 offen lds
    s_add_u32 s64, s64, 8192
    s_add_u32 s65, s65, 1024
    s_mov_b32 m0, s65
    s_nop 0
    buffer_load_dwordx4 v3, s[24:27], s64 offen lds
    s_add_u32 s64, s64, 8192
    s_add_u32 s65, s65, 1024
    s_mov_b32 m0, s65
    s_nop 0
    buffer_load_dwordx4 v3, s[24:27], s64 offen lds
    s_add_u32 s64, s64, 8192
    s_add_u32 s65, s65, 1024
    s_mov_b32 m0, s65
    s_nop 0
    buffer_load_dwordx4 v3, s[24:27], s64 offen lds
    s_add_u32 s64, s64, 8192
    s_add_u32 s65, s65, 1024
    s_mov_b32 m0, s65
    s_nop 0
    buffer_load_dwordx4 v3, s[24:27], s64 offen lds
    ds_read_b128 v[16:19], v4 offset:0
    ds_read_b128 v[20:23], v4 offset:2048
    ds_read_b128 v[24:27], v4 offset:4096
    ds_read_b128 v[28:31], v4 offset:6144
    ds_read_b128 v[32:35], v6 offset:0
    ds_read_b128 v[36:39], v6 offset:2048
    ds_read_b128 v[40:43], v6 offset:4096
    ds_read_b128 v[44:47], v6 offset:6144
    ds_read_b128 v[48:51], v6 offset:8192
    ds_read_b128 v[52:55], v6 offset:10240
    ds_read_b128 v[56:59], v6 offset:12288
    ds_read_b128 v[60:63], v6 offset:14336
    ds_read_b128 v[64:67], v5 offset:0
    ds_read_b128 v[68:71], v5 offset:2048
    ds_read_b128 v[72:75], v5 offset:4096
    ds_read_b128 v[76:79], v5 offset:6144
    ds_read_b128 v[80:83], v7 offset:0
    ds_read_b128 v[84:87], v7 offset:2048
    ds_read_b128 v[88:91], v7 offset:4096
    ds_read_b128 v[92:95], v7 offset:6144
    ds_read_b128 v[96:99], v7 offset:8192
    ds_read_b128 v[100:103], v7 offset:10240
    ds_read_b128 v[104:107], v7 offset:12288
    ds_read_b128 v[108:111], v7 offset:14336
    s_waitcnt lgkmcnt(12)
    v_mfma_f32_16x16x32_bf16 a[0:3], v[32:35], v[16:19], a[0:3]
    v_mfma_f32_16x16x32_bf16 a[4:7], v[36:39], v[16:19], a[4:7]
    v_mfma_f32_16x16x32_bf16 a[8:11], v[40:43], v[16:19], a[8:11]
    v_mfma_f32_16x16x32_bf16 a[12:15], v[44:47], v[16:19], a[12:15]
    v_mfma_f32_16x16x32_bf16 a[16:19], v[48:51], v[16:19], a[16:19]
    v_mfma_f32_16x16x32_bf16 a[20:23], v[52:55], v[16:19], a[20:23]
    v_mfma_f32_16x16x32_bf16 a[24:27], v[56:59], v[16:19], a[24:27]
    v_mfma_f32_16x16x32_bf16 a[28:31], v[60:63], v[16:19], a[28:31]
    v_mfma_f32_16x16x32_bf16 a[32:35], v[32:35], v[20:23], a[32:35]
    v_mfma_f32_16x16x32_bf16 a[36:39], v[36:39], v[20:23], a[36:39]
    v_mfma_f32_16x16x32_bf16 a[40:43], v[40:43], v[20:23], a[40:43]
    v_mfma_f32_16x16x32_bf16 a[44:47], v[44:47], v[20:23], a[44:47]
    v_mfma_f32_16x16x32_bf16 a[48:51], v[48:51], v[20:23], a[48:51]
    v_mfma_f32_16x16x32_bf16 a[52:55], v[52:55], v[20:23], a[52:55]
    v_mfma_f32_16x16x32_bf16 a[56:59], v[56:59], v[20:23], a[56:59]
    v_mfma_f32_16x16x32_bf16 a[60:63], v[60:63], v[20:23], a[60:63]
    v_mfma_f32_16x16x32_bf16 a[64:67], v[32:35], v[24:27], a[64:67]
    v_mfma_f32_16x16x32_bf16 a[68:71], v[36:39], v[24:27], a[68:71]
    v_mfma_f32_16x16x32_bf16 a[72:75], v[40:43], v[24:27], a[72:75]
    v_mfma_f32_16x16x32_bf16 a[76:79], v[44:47], v[24:27], a[76:79]
    v_mfma_f32_16x16x32_bf16 a[80:83], v[48:51], v[24:27], a[80:83]
    v_mfma_f32_16x16x32_bf16 a[84:87], v[52:55], v[24:27], a[84:87]
    v_mfma_f32_16x16x32_bf16 a[88:91], v[56:59], v[24:27], a[88:91]
    v_mfma_f32_16x16x32_bf16 a[92:95], v[60:63], v[24:27], a[92:95]
    v_mfma_f32_16x16x32_bf16 a[96:99], v[32:35], v[28:31], a[96:99]
    v_mfma_f32_16x16x32_bf16 a[100:103], v[36:39], v[28:31], a[100:103]
    v_mfma_f32_16x16x32_bf16 a[104:107], v[40:43], v[28:31], a[104:107]
    v_mfma_f32_16x16x32_bf16 a[108:111], v[44:47], v[28:31], a[108:111]
    v_mfma_f32_16x16x32_bf16 a[112:115], v[48:51], v[28:31], a[112:115]
    v_mfma_f32_16x16x32_bf16 a[116:119], v[52:55], v[28:31], a[116:119]
    v_mfma_f32_16x16x32_bf16 a[120:123], v[56:59], v[28:31], a[120:123]
    v_mfma_f32_16x16x32_bf16 a[124:127], v[60:63], v[28:31], a[124:127]
    s_waitcnt lgkmcnt(0)
    v_mfma_f32_16x16x32_bf16 a[0:3], v[80:83], v[64:67], a[0:3]
    v_mfma_f32_16x16x32_bf16 a[4:7], v[84:87], v[64:67], a[4:7]
    v_mfma_f32_16x16x32_bf16 a[8:11], v[88:91], v[64:67], a[8:11]
    v_mfma_f32_16x16x32_bf16 a[12:15], v[92:95], v[64:67], a[12:15]
    v_mfma_f32_16x16x32_bf16 a[16:19], v[96:99], v[64:67], a[16:19]
    v_mfma_f32_16x16x32_bf16 a[20:23], v[100:103], v[64:67], a[20:23]
    v_mfma_f32_16x16x32_bf16 a[24:27], v[104:107], v[64:67], a[24:27]
    v_mfma_f32_16x16x32_bf16 a[28:31], v[108:111], v[64:67], a[28:31]
    v_mfma_f32_16x16x32_bf16 a[32:35], v[80:83], v[68:71], a[32:35]
    v_mfma_f32_16x16x32_bf16 a[36:39], v[84:87], v[68:71], a[36:39]
    v_mfma_f32_16x16x32_bf16 a[40:43], v[88:91], v[68:71], a[40:43]
    v_mfma_f32_16x16x32_bf16 a[44:47], v[92:95], v[68:71], a[44:47]
    v_mfma_f32_16x16x32_bf16 a[48:51], v[96:99], v[68:71], a[48:51]
    v_mfma_f32_16x16x32_bf16 a[52:55], v[100:103], v[68:71], a[52:55]
    v_mfma_f32_16x16x32_bf16 a[56:59], v[104:107], v[68:71], a[56:59]
    v_mfma_f32_16x16x32_bf16 a[60:63], v[108:111], v[68:71], a[60:63]
    v_mfma_f32_16x16x32_bf16 a[64:67], v[80:83], v[72:75], a[64:67]
    v_mfma_f32_16x16x32_bf16 a[68:71], v[84:87], v[72:75], a[68:71]
    v_mfma_f32_16x16x32_bf16 a[72:75], v[88:91], v[72:75], a[72:75]
    v_mfma_f32_16x16x32_bf16 a[76:79], v[92:95], v[72:75], a[76:79]
    v_mfma_f32_16x16x32_bf16 a[80:83], v[96:99], v[72:75], a[80:83]
    v_mfma_f32_16x16x32_bf16 a[84:87], v[100:103], v[72:75], a[84:87]
    v_mfma_f32_16x16x32_bf16 a[88:91], v[104:107], v[72:75], a[88:91]
    v_mfma_f32_16x16x32_bf16 a[92:95], v[108:111], v[72:75], a[92:95]
    v_mfma_f32_16x16x32_bf16 a[96:99], v[80:83], v[76:79], a[96:99]
    v_mfma_f32_16x16x32_bf16 a[100:103], v[84:87], v[76:79], a[100:103]
    v_mfma_f32_16x16x32_bf16 a[104:107], v[88:91], v[76:79], a[104:107]
    v_mfma_f32_16x16x32_bf16 a[108:111], v[92:95], v[76:79], a[108:111]
    v_mfma_f32_16x16x32_bf16 a[112:115], v[96:99], v[76:79], a[112:115]
    v_mfma_f32_16x16x32_bf16 a[116:119], v[100:103], v[76:79], a[116:119]
    v_mfma_f32_16x16x32_bf16 a[120:123], v[104:107], v[76:79], a[120:123]
    v_mfma_f32_16x16x32_bf16 a[124:127], v[108:111], v[76:79], a[124:127]
    s_waitcnt vmcnt(12)
    s_barrier
    s_add_u32 s64, s60, 384
    s_add_u32 s65, s62, 0
    s_mov_b32 m0, s65
    s_nop 0
    buffer_load_dwordx4 v3, s[20:23], s64 offen lds
    s_add_u32 s64, s64, 8192
    s_add_u32 s65, s65, 1024
    s_mov_b32 m0, s65
    s_nop 0
    buffer_load_dwordx4 v3, s[20:23], s64 offen lds
    s_add_u32 s64, s64, 8192
    s_add_u32 s65, s65, 1024
    s_mov_b32 m0, s65
    s_nop 0
    buffer_load_dwordx4 v3, s[20:23], s64 offen lds
    s_add_u32 s64, s64, 8192
    s_add_u32 s65, s65, 1024
    s_mov_b32 m0, s65
    s_nop 0
    buffer_load_dwordx4 v3, s[20:23], s64 offen lds
    s_add_u32 s64, s61, 384
    s_add_u32 s65, s63, 0
    s_mov_b32 m0, s65
    s_nop 0
    buffer_load_dwordx4 v3, s[24:27], s64 offen lds
    s_add_u32 s64, s64, 8192
    s_add_u32 s65, s65, 1024
    s_mov_b32 m0, s65
    s_nop 0
    buffer_load_dwordx4 v3, s[24:27], s64 offen lds
    s_add_u32 s64, s64, 8192
    s_add_u32 s65, s65, 1024
    s_mov_b32 m0, s65
    s_nop 0
    buffer_load_dwordx4 v3, s[24:27], s64 offen lds
    s_add_u32 s64, s64, 8192
    s_add_u32 s65, s65, 1024
    s_mov_b32 m0, s65
    s_nop 0
    buffer_load_dwordx4 v3, s[24:27], s64 offen lds
    s_add_u32 s64, s64, 8192
    s_add_u32 s65, s65, 1024
    s_mov_b32 m0, s65
    s_nop 0
    buffer_load_dwordx4 v3, s[24:27], s64 offen lds
    s_add_u32 s64, s64, 8192
    s_add_u32 s65, s65, 1024
    s_mov_b32 m0, s65
    s_nop 0
    buffer_load_dwordx4 v3, s[24:27], s64 offen lds
    s_add_u32 s64, s64, 8192
    s_add_u32 s65, s65, 1024
    s_mov_b32 m0, s65
    s_nop 0
    buffer_load_dwordx4 v3, s[24:27], s64 offen lds
    s_add_u32 s64, s64, 8192
    s_add_u32 s65, s65, 1024
    s_mov_b32 m0, s65
    s_nop 0
    buffer_load_dwordx4 v3, s[24:27], s64 offen lds
    ds_read_b128 v[16:19], v8 offset:0
    ds_read_b128 v[20:23], v8 offset:2048
    ds_read_b128 v[24:27], v8 offset:4096
    ds_read_b128 v[28:31], v8 offset:6144
    ds_read_b128 v[32:35], v10 offset:0
    ds_read_b128 v[36:39], v10 offset:2048
    ds_read_b128 v[40:43], v10 offset:4096
    ds_read_b128 v[44:47], v10 offset:6144
    ds_read_b128 v[48:51], v10 offset:8192
    ds_read_b128 v[52:55], v10 offset:10240
    ds_read_b128 v[56:59], v10 offset:12288
    ds_read_b128 v[60:63], v10 offset:14336
    ds_read_b128 v[64:67], v9 offset:0
    ds_read_b128 v[68:71], v9 offset:2048
    ds_read_b128 v[72:75], v9 offset:4096
    ds_read_b128 v[76:79], v9 offset:6144
    ds_read_b128 v[80:83], v11 offset:0
    ds_read_b128 v[84:87], v11 offset:2048
    ds_read_b128 v[88:91], v11 offset:4096
    ds_read_b128 v[92:95], v11 offset:6144
    ds_read_b128 v[96:99], v11 offset:8192
    ds_read_b128 v[100:103], v11 offset:10240
    ds_read_b128 v[104:107], v11 offset:12288
    ds_read_b128 v[108:111], v11 offset:14336
    s_waitcnt lgkmcnt(12)
    v_mfma_f32_16x16x32_bf16 a[0:3], v[32:35], v[16:19], a[0:3]
    v_mfma_f32_16x16x32_bf16 a[4:7], v[36:39], v[16:19], a[4:7]
    v_mfma_f32_16x16x32_bf16 a[8:11], v[40:43], v[16:19], a[8:11]
    v_mfma_f32_16x16x32_bf16 a[12:15], v[44:47], v[16:19], a[12:15]
    v_mfma_f32_16x16x32_bf16 a[16:19], v[48:51], v[16:19], a[16:19]
    v_mfma_f32_16x16x32_bf16 a[20:23], v[52:55], v[16:19], a[20:23]
    v_mfma_f32_16x16x32_bf16 a[24:27], v[56:59], v[16:19], a[24:27]
    v_mfma_f32_16x16x32_bf16 a[28:31], v[60:63], v[16:19], a[28:31]
    v_mfma_f32_16x16x32_bf16 a[32:35], v[32:35], v[20:23], a[32:35]
    v_mfma_f32_16x16x32_bf16 a[36:39], v[36:39], v[20:23], a[36:39]
    v_mfma_f32_16x16x32_bf16 a[40:43], v[40:43], v[20:23], a[40:43]
    v_mfma_f32_16x16x32_bf16 a[44:47], v[44:47], v[20:23], a[44:47]
    v_mfma_f32_16x16x32_bf16 a[48:51], v[48:51], v[20:23], a[48:51]
    v_mfma_f32_16x16x32_bf16 a[52:55], v[52:55], v[20:23], a[52:55]
    v_mfma_f32_16x16x32_bf16 a[56:59], v[56:59], v[20:23], a[56:59]
    v_mfma_f32_16x16x32_bf16 a[60:63], v[60:63], v[20:23], a[60:63]
    v_mfma_f32_16x16x32_bf16 a[64:67], v[32:35], v[24:27], a[64:67]
    v_mfma_f32_16x16x32_bf16 a[68:71], v[36:39], v[24:27], a[68:71]
    v_mfma_f32_16x16x32_bf16 a[72:75], v[40:43], v[24:27], a[72:75]
    v_mfma_f32_16x16x32_bf16 a[76:79], v[44:47], v[24:27], a[76:79]
    v_mfma_f32_16x16x32_bf16 a[80:83], v[48:51], v[24:27], a[80:83]
    v_mfma_f32_16x16x32_bf16 a[84:87], v[52:55], v[24:27], a[84:87]
    v_mfma_f32_16x16x32_bf16 a[88:91], v[56:59], v[24:27], a[88:91]
    v_mfma_f32_16x16x32_bf16 a[92:95], v[60:63], v[24:27], a[92:95]
    v_mfma_f32_16x16x32_bf16 a[96:99], v[32:35], v[28:31], a[96:99]
    v_mfma_f32_16x16x32_bf16 a[100:103], v[36:39], v[28:31], a[100:103]
    v_mfma_f32_16x16x32_bf16 a[104:107], v[40:43], v[28:31], a[104:107]
    v_mfma_f32_16x16x32_bf16 a[108:111], v[44:47], v[28:31], a[108:111]
    v_mfma_f32_16x16x32_bf16 a[112:115], v[48:51], v[28:31], a[112:115]
    v_mfma_f32_16x16x32_bf16 a[116:119], v[52:55], v[28:31], a[116:119]
    v_mfma_f32_16x16x32_bf16 a[120:123], v[56:59], v[28:31], a[120:123]
    v_mfma_f32_16x16x32_bf16 a[124:127], v[60:63], v[28:31], a[124:127]
    s_waitcnt lgkmcnt(0)
    v_mfma_f32_16x16x32_bf16 a[0:3], v[80:83], v[64:67], a[0:3]
    v_mfma_f32_16x16x32_bf16 a[4:7], v[84:87], v[64:67], a[4:7]
    v_mfma_f32_16x16x32_bf16 a[8:11], v[88:91], v[64:67], a[8:11]
    v_mfma_f32_16x16x32_bf16 a[12:15], v[92:95], v[64:67], a[12:15]
    v_mfma_f32_16x16x32_bf16 a[16:19], v[96:99], v[64:67], a[16:19]
    v_mfma_f32_16x16x32_bf16 a[20:23], v[100:103], v[64:67], a[20:23]
    v_mfma_f32_16x16x32_bf16 a[24:27], v[104:107], v[64:67], a[24:27]
    v_mfma_f32_16x16x32_bf16 a[28:31], v[108:111], v[64:67], a[28:31]
    v_mfma_f32_16x16x32_bf16 a[32:35], v[80:83], v[68:71], a[32:35]
    v_mfma_f32_16x16x32_bf16 a[36:39], v[84:87], v[68:71], a[36:39]
    v_mfma_f32_16x16x32_bf16 a[40:43], v[88:91], v[68:71], a[40:43]
    v_mfma_f32_16x16x32_bf16 a[44:47], v[92:95], v[68:71], a[44:47]
    v_mfma_f32_16x16x32_bf16 a[48:51], v[96:99], v[68:71], a[48:51]
    v_mfma_f32_16x16x32_bf16 a[52:55], v[100:103], v[68:71], a[52:55]
    v_mfma_f32_16x16x32_bf16 a[56:59], v[104:107], v[68:71], a[56:59]
    v_mfma_f32_16x16x32_bf16 a[60:63], v[108:111], v[68:71], a[60:63]
    v_mfma_f32_16x16x32_bf16 a[64:67], v[80:83], v[72:75], a[64:67]
    v_mfma_f32_16x16x32_bf16 a[68:71], v[84:87], v[72:75], a[68:71]
    v_mfma_f32_16x16x32_bf16 a[72:75], v[88:91], v[72:75], a[72:75]
    v_mfma_f32_16x16x32_bf16 a[76:79], v[92:95], v[72:75], a[76:79]
    v_mfma_f32_16x16x32_bf16 a[80:83], v[96:99], v[72:75], a[80:83]
    v_mfma_f32_16x16x32_bf16 a[84:87], v[100:103], v[72:75], a[84:87]
    v_mfma_f32_16x16x32_bf16 a[88:91], v[104:107], v[72:75], a[88:91]
    v_mfma_f32_16x16x32_bf16 a[92:95], v[108:111], v[72:75], a[92:95]
    v_mfma_f32_16x16x32_bf16 a[96:99], v[80:83], v[76:79], a[96:99]
    v_mfma_f32_16x16x32_bf16 a[100:103], v[84:87], v[76:79], a[100:103]
    v_mfma_f32_16x16x32_bf16 a[104:107], v[88:91], v[76:79], a[104:107]
    v_mfma_f32_16x16x32_bf16 a[108:111], v[92:95], v[76:79], a[108:111]
    v_mfma_f32_16x16x32_bf16 a[112:115], v[96:99], v[76:79], a[112:115]
    v_mfma_f32_16x16x32_bf16 a[116:119], v[100:103], v[76:79], a[116:119]
    v_mfma_f32_16x16x32_bf16 a[120:123], v[104:107], v[76:79], a[120:123]
    v_mfma_f32_16x16x32_bf16 a[124:127], v[108:111], v[76:79], a[124:127]
    s_waitcnt vmcnt(12)
    s_barrier
    s_add_u32 s64, s60, 512
    s_add_u32 s65, s62, 49152
    s_mov_b32 m0, s65
    s_nop 0
    buffer_load_dwordx4 v3, s[20:23], s64 offen lds
    s_add_u32 s64, s64, 8192
    s_add_u32 s65, s65, 1024
    s_mov_b32 m0, s65
    s_nop 0
    buffer_load_dwordx4 v3, s[20:23], s64 offen lds
    s_add_u32 s64, s64, 8192
    s_add_u32 s65, s65, 1024
    s_mov_b32 m0, s65
    s_nop 0
    buffer_load_dwordx4 v3, s[20:23], s64 offen lds
    s_add_u32 s64, s64, 8192
    s_add_u32 s65, s65, 1024
    s_mov_b32 m0, s65
    s_nop 0
    buffer_load_dwordx4 v3, s[20:23], s64 offen lds
    s_add_u32 s64, s61, 512
    s_add_u32 s65, s63, 49152
    s_mov_b32 m0, s65
    s_nop 0
    buffer_load_dwordx4 v3, s[24:27], s64 offen lds
    s_add_u32 s64, s64, 8192
    s_add_u32 s65, s65, 1024
    s_mov_b32 m0, s65
    s_nop 0
    buffer_load_dwordx4 v3, s[24:27], s64 offen lds
    s_add_u32 s64, s64, 8192
    s_add_u32 s65, s65, 1024
    s_mov_b32 m0, s65
    s_nop 0
    buffer_load_dwordx4 v3, s[24:27], s64 offen lds
    s_add_u32 s64, s64, 8192
    s_add_u32 s65, s65, 1024
    s_mov_b32 m0, s65
    s_nop 0
    buffer_load_dwordx4 v3, s[24:27], s64 offen lds
    s_add_u32 s64, s64, 8192
    s_add_u32 s65, s65, 1024
    s_mov_b32 m0, s65
    s_nop 0
    buffer_load_dwordx4 v3, s[24:27], s64 offen lds
    s_add_u32 s64, s64, 8192
    s_add_u32 s65, s65, 1024
    s_mov_b32 m0, s65
    s_nop 0
    buffer_load_dwordx4 v3, s[24:27], s64 offen lds
    s_add_u32 s64, s64, 8192
    s_add_u32 s65, s65, 1024
    s_mov_b32 m0, s65
    s_nop 0
    buffer_load_dwordx4 v3, s[24:27], s64 offen lds
    s_add_u32 s64, s64, 8192
    s_add_u32 s65, s65, 1024
    s_mov_b32 m0, s65
    s_nop 0
    buffer_load_dwordx4 v3, s[24:27], s64 offen lds
    ds_read_b128 v[16:19], v12 offset:0
    ds_read_b128 v[20:23], v12 offset:2048
    ds_read_b128 v[24:27], v12 offset:4096
    ds_read_b128 v[28:31], v12 offset:6144
    ds_read_b128 v[32:35], v14 offset:0
    ds_read_b128 v[36:39], v14 offset:2048
    ds_read_b128 v[40:43], v14 offset:4096
    ds_read_b128 v[44:47], v14 offset:6144
    ds_read_b128 v[48:51], v14 offset:8192
    ds_read_b128 v[52:55], v14 offset:10240
    ds_read_b128 v[56:59], v14 offset:12288
    ds_read_b128 v[60:63], v14 offset:14336
    ds_read_b128 v[64:67], v13 offset:0
    ds_read_b128 v[68:71], v13 offset:2048
    ds_read_b128 v[72:75], v13 offset:4096
    ds_read_b128 v[76:79], v13 offset:6144
    ds_read_b128 v[80:83], v15 offset:0
    ds_read_b128 v[84:87], v15 offset:2048
    ds_read_b128 v[88:91], v15 offset:4096
    ds_read_b128 v[92:95], v15 offset:6144
    ds_read_b128 v[96:99], v15 offset:8192
    ds_read_b128 v[100:103], v15 offset:10240
    ds_read_b128 v[104:107], v15 offset:12288
    ds_read_b128 v[108:111], v15 offset:14336
    s_waitcnt lgkmcnt(12)
    v_mfma_f32_16x16x32_bf16 a[0:3], v[32:35], v[16:19], a[0:3]
    v_mfma_f32_16x16x32_bf16 a[4:7], v[36:39], v[16:19], a[4:7]
    v_mfma_f32_16x16x32_bf16 a[8:11], v[40:43], v[16:19], a[8:11]
    v_mfma_f32_16x16x32_bf16 a[12:15], v[44:47], v[16:19], a[12:15]
    v_mfma_f32_16x16x32_bf16 a[16:19], v[48:51], v[16:19], a[16:19]
    v_mfma_f32_16x16x32_bf16 a[20:23], v[52:55], v[16:19], a[20:23]
    v_mfma_f32_16x16x32_bf16 a[24:27], v[56:59], v[16:19], a[24:27]
    v_mfma_f32_16x16x32_bf16 a[28:31], v[60:63], v[16:19], a[28:31]
    v_mfma_f32_16x16x32_bf16 a[32:35], v[32:35], v[20:23], a[32:35]
    v_mfma_f32_16x16x32_bf16 a[36:39], v[36:39], v[20:23], a[36:39]
    v_mfma_f32_16x16x32_bf16 a[40:43], v[40:43], v[20:23], a[40:43]
    v_mfma_f32_16x16x32_bf16 a[44:47], v[44:47], v[20:23], a[44:47]
    v_mfma_f32_16x16x32_bf16 a[48:51], v[48:51], v[20:23], a[48:51]
    v_mfma_f32_16x16x32_bf16 a[52:55], v[52:55], v[20:23], a[52:55]
    v_mfma_f32_16x16x32_bf16 a[56:59], v[56:59], v[20:23], a[56:59]
    v_mfma_f32_16x16x32_bf16 a[60:63], v[60:63], v[20:23], a[60:63]
    v_mfma_f32_16x16x32_bf16 a[64:67], v[32:35], v[24:27], a[64:67]
    v_mfma_f32_16x16x32_bf16 a[68:71], v[36:39], v[24:27], a[68:71]
    v_mfma_f32_16x16x32_bf16 a[72:75], v[40:43], v[24:27], a[72:75]
    v_mfma_f32_16x16x32_bf16 a[76:79], v[44:47], v[24:27], a[76:79]
    v_mfma_f32_16x16x32_bf16 a[80:83], v[48:51], v[24:27], a[80:83]
    v_mfma_f32_16x16x32_bf16 a[84:87], v[52:55], v[24:27], a[84:87]
    v_mfma_f32_16x16x32_bf16 a[88:91], v[56:59], v[24:27], a[88:91]
    v_mfma_f32_16x16x32_bf16 a[92:95], v[60:63], v[24:27], a[92:95]
    v_mfma_f32_16x16x32_bf16 a[96:99], v[32:35], v[28:31], a[96:99]
    v_mfma_f32_16x16x32_bf16 a[100:103], v[36:39], v[28:31], a[100:103]
    v_mfma_f32_16x16x32_bf16 a[104:107], v[40:43], v[28:31], a[104:107]
    v_mfma_f32_16x16x32_bf16 a[108:111], v[44:47], v[28:31], a[108:111]
    v_mfma_f32_16x16x32_bf16 a[112:115], v[48:51], v[28:31], a[112:115]
    v_mfma_f32_16x16x32_bf16 a[116:119], v[52:55], v[28:31], a[116:119]
    v_mfma_f32_16x16x32_bf16 a[120:123], v[56:59], v[28:31], a[120:123]
    v_mfma_f32_16x16x32_bf16 a[124:127], v[60:63], v[28:31], a[124:127]
    s_waitcnt lgkmcnt(0)
    v_mfma_f32_16x16x32_bf16 a[0:3], v[80:83], v[64:67], a[0:3]
    v_mfma_f32_16x16x32_bf16 a[4:7], v[84:87], v[64:67], a[4:7]
    v_mfma_f32_16x16x32_bf16 a[8:11], v[88:91], v[64:67], a[8:11]
    v_mfma_f32_16x16x32_bf16 a[12:15], v[92:95], v[64:67], a[12:15]
    v_mfma_f32_16x16x32_bf16 a[16:19], v[96:99], v[64:67], a[16:19]
    v_mfma_f32_16x16x32_bf16 a[20:23], v[100:103], v[64:67], a[20:23]
    v_mfma_f32_16x16x32_bf16 a[24:27], v[104:107], v[64:67], a[24:27]
    v_mfma_f32_16x16x32_bf16 a[28:31], v[108:111], v[64:67], a[28:31]
    v_mfma_f32_16x16x32_bf16 a[32:35], v[80:83], v[68:71], a[32:35]
    v_mfma_f32_16x16x32_bf16 a[36:39], v[84:87], v[68:71], a[36:39]
    v_mfma_f32_16x16x32_bf16 a[40:43], v[88:91], v[68:71], a[40:43]
    v_mfma_f32_16x16x32_bf16 a[44:47], v[92:95], v[68:71], a[44:47]
    v_mfma_f32_16x16x32_bf16 a[48:51], v[96:99], v[68:71], a[48:51]
    v_mfma_f32_16x16x32_bf16 a[52:55], v[100:103], v[68:71], a[52:55]
    v_mfma_f32_16x16x32_bf16 a[56:59], v[104:107], v[68:71], a[56:59]
    v_mfma_f32_16x16x32_bf16 a[60:63], v[108:111], v[68:71], a[60:63]
    v_mfma_f32_16x16x32_bf16 a[64:67], v[80:83], v[72:75], a[64:67]
    v_mfma_f32_16x16x32_bf16 a[68:71], v[84:87], v[72:75], a[68:71]
    v_mfma_f32_16x16x32_bf16 a[72:75], v[88:91], v[72:75], a[72:75]
    v_mfma_f32_16x16x32_bf16 a[76:79], v[92:95], v[72:75], a[76:79]
    v_mfma_f32_16x16x32_bf16 a[80:83], v[96:99], v[72:75], a[80:83]
    v_mfma_f32_16x16x32_bf16 a[84:87], v[100:103], v[72:75], a[84:87]
    v_mfma_f32_16x16x32_bf16 a[88:91], v[104:107], v[72:75], a[88:91]
    v_mfma_f32_16x16x32_bf16 a[92:95], v[108:111], v[72:75], a[92:95]
    v_mfma_f32_16x16x32_bf16 a[96:99], v[80:83], v[76:79], a[96:99]
    v_mfma_f32_16x16x32_bf16 a[100:103], v[84:87], v[76:79], a[100:103]
    v_mfma_f32_16x16x32_bf16 a[104:107], v[88:91], v[76:79], a[104:107]
    v_mfma_f32_16x16x32_bf16 a[108:111], v[92:95], v[76:79], a[108:111]
    v_mfma_f32_16x16x32_bf16 a[112:115], v[96:99], v[76:79], a[112:115]
    v_mfma_f32_16x16x32_bf16 a[116:119], v[100:103], v[76:79], a[116:119]
    v_mfma_f32_16x16x32_bf16 a[120:123], v[104:107], v[76:79], a[120:123]
    v_mfma_f32_16x16x32_bf16 a[124:127], v[108:111], v[76:79], a[124:127]
    s_waitcnt vmcnt(12)
    s_barrier
    s_add_u32 s64, s60, 640
    s_add_u32 s65, s62, 98304
    s_mov_b32 m0, s65
    s_nop 0
    buffer_load_dwordx4 v3, s[20:23], s64 offen lds
    s_add_u32 s64, s64, 8192
    s_add_u32 s65, s65, 1024
    s_mov_b32 m0, s65
    s_nop 0
    buffer_load_dwordx4 v3, s[20:23], s64 offen lds
    s_add_u32 s64, s64, 8192
    s_add_u32 s65, s65, 1024
    s_mov_b32 m0, s65
    s_nop 0
    buffer_load_dwordx4 v3, s[20:23], s64 offen lds
    s_add_u32 s64, s64, 8192
    s_add_u32 s65, s65, 1024
    s_mov_b32 m0, s65
    s_nop 0
    buffer_load_dwordx4 v3, s[20:23], s64 offen lds
    s_add_u32 s64, s61, 640
    s_add_u32 s65, s63, 98304
    s_mov_b32 m0, s65
    s_nop 0
    buffer_load_dwordx4 v3, s[24:27], s64 offen lds
    s_add_u32 s64, s64, 8192
    s_add_u32 s65, s65, 1024
    s_mov_b32 m0, s65
    s_nop 0
    buffer_load_dwordx4 v3, s[24:27], s64 offen lds
    s_add_u32 s64, s64, 8192
    s_add_u32 s65, s65, 1024
    s_mov_b32 m0, s65
    s_nop 0
    buffer_load_dwordx4 v3, s[24:27], s64 offen lds
    s_add_u32 s64, s64, 8192
    s_add_u32 s65, s65, 1024
    s_mov_b32 m0, s65
    s_nop 0
    buffer_load_dwordx4 v3, s[24:27], s64 offen lds
    s_add_u32 s64, s64, 8192
    s_add_u32 s65, s65, 1024
    s_mov_b32 m0, s65
    s_nop 0
    buffer_load_dwordx4 v3, s[24:27], s64 offen lds
    s_add_u32 s64, s64, 8192
    s_add_u32 s65, s65, 1024
    s_mov_b32 m0, s65
    s_nop 0
    buffer_load_dwordx4 v3, s[24:27], s64 offen lds
    s_add_u32 s64, s64, 8192
    s_add_u32 s65, s65, 1024
    s_mov_b32 m0, s65
    s_nop 0
    buffer_load_dwordx4 v3, s[24:27], s64 offen lds
    s_add_u32 s64, s64, 8192
    s_add_u32 s65, s65, 1024
    s_mov_b32 m0, s65
    s_nop 0
    buffer_load_dwordx4 v3, s[24:27], s64 offen lds
    ds_read_b128 v[16:19], v4 offset:0
    ds_read_b128 v[20:23], v4 offset:2048
    ds_read_b128 v[24:27], v4 offset:4096
    ds_read_b128 v[28:31], v4 offset:6144
    ds_read_b128 v[32:35], v6 offset:0
    ds_read_b128 v[36:39], v6 offset:2048
    ds_read_b128 v[40:43], v6 offset:4096
    ds_read_b128 v[44:47], v6 offset:6144
    ds_read_b128 v[48:51], v6 offset:8192
    ds_read_b128 v[52:55], v6 offset:10240
    ds_read_b128 v[56:59], v6 offset:12288
    ds_read_b128 v[60:63], v6 offset:14336
    ds_read_b128 v[64:67], v5 offset:0
    ds_read_b128 v[68:71], v5 offset:2048
    ds_read_b128 v[72:75], v5 offset:4096
    ds_read_b128 v[76:79], v5 offset:6144
    ds_read_b128 v[80:83], v7 offset:0
    ds_read_b128 v[84:87], v7 offset:2048
    ds_read_b128 v[88:91], v7 offset:4096
    ds_read_b128 v[92:95], v7 offset:6144
    ds_read_b128 v[96:99], v7 offset:8192
    ds_read_b128 v[100:103], v7 offset:10240
    ds_read_b128 v[104:107], v7 offset:12288
    ds_read_b128 v[108:111], v7 offset:14336
    s_waitcnt lgkmcnt(12)
    v_mfma_f32_16x16x32_bf16 a[0:3], v[32:35], v[16:19], a[0:3]
    v_mfma_f32_16x16x32_bf16 a[4:7], v[36:39], v[16:19], a[4:7]
    v_mfma_f32_16x16x32_bf16 a[8:11], v[40:43], v[16:19], a[8:11]
    v_mfma_f32_16x16x32_bf16 a[12:15], v[44:47], v[16:19], a[12:15]
    v_mfma_f32_16x16x32_bf16 a[16:19], v[48:51], v[16:19], a[16:19]
    v_mfma_f32_16x16x32_bf16 a[20:23], v[52:55], v[16:19], a[20:23]
    v_mfma_f32_16x16x32_bf16 a[24:27], v[56:59], v[16:19], a[24:27]
    v_mfma_f32_16x16x32_bf16 a[28:31], v[60:63], v[16:19], a[28:31]
    v_mfma_f32_16x16x32_bf16 a[32:35], v[32:35], v[20:23], a[32:35]
    v_mfma_f32_16x16x32_bf16 a[36:39], v[36:39], v[20:23], a[36:39]
    v_mfma_f32_16x16x32_bf16 a[40:43], v[40:43], v[20:23], a[40:43]
    v_mfma_f32_16x16x32_bf16 a[44:47], v[44:47], v[20:23], a[44:47]
    v_mfma_f32_16x16x32_bf16 a[48:51], v[48:51], v[20:23], a[48:51]
    v_mfma_f32_16x16x32_bf16 a[52:55], v[52:55], v[20:23], a[52:55]
    v_mfma_f32_16x16x32_bf16 a[56:59], v[56:59], v[20:23], a[56:59]
    v_mfma_f32_16x16x32_bf16 a[60:63], v[60:63], v[20:23], a[60:63]
    v_mfma_f32_16x16x32_bf16 a[64:67], v[32:35], v[24:27], a[64:67]
    v_mfma_f32_16x16x32_bf16 a[68:71], v[36:39], v[24:27], a[68:71]
    v_mfma_f32_16x16x32_bf16 a[72:75], v[40:43], v[24:27], a[72:75]
    v_mfma_f32_16x16x32_bf16 a[76:79], v[44:47], v[24:27], a[76:79]
    v_mfma_f32_16x16x32_bf16 a[80:83], v[48:51], v[24:27], a[80:83]
    v_mfma_f32_16x16x32_bf16 a[84:87], v[52:55], v[24:27], a[84:87]
    v_mfma_f32_16x16x32_bf16 a[88:91], v[56:59], v[24:27], a[88:91]
    v_mfma_f32_16x16x32_bf16 a[92:95], v[60:63], v[24:27], a[92:95]
    v_mfma_f32_16x16x32_bf16 a[96:99], v[32:35], v[28:31], a[96:99]
    v_mfma_f32_16x16x32_bf16 a[100:103], v[36:39], v[28:31], a[100:103]
    v_mfma_f32_16x16x32_bf16 a[104:107], v[40:43], v[28:31], a[104:107]
    v_mfma_f32_16x16x32_bf16 a[108:111], v[44:47], v[28:31], a[108:111]
    v_mfma_f32_16x16x32_bf16 a[112:115], v[48:51], v[28:31], a[112:115]
    v_mfma_f32_16x16x32_bf16 a[116:119], v[52:55], v[28:31], a[116:119]
    v_mfma_f32_16x16x32_bf16 a[120:123], v[56:59], v[28:31], a[120:123]
    v_mfma_f32_16x16x32_bf16 a[124:127], v[60:63], v[28:31], a[124:127]
    s_waitcnt lgkmcnt(0)
    v_mfma_f32_16x16x32_bf16 a[0:3], v[80:83], v[64:67], a[0:3]
    v_mfma_f32_16x16x32_bf16 a[4:7], v[84:87], v[64:67], a[4:7]
    v_mfma_f32_16x16x32_bf16 a[8:11], v[88:91], v[64:67], a[8:11]
    v_mfma_f32_16x16x32_bf16 a[12:15], v[92:95], v[64:67], a[12:15]
    v_mfma_f32_16x16x32_bf16 a[16:19], v[96:99], v[64:67], a[16:19]
    v_mfma_f32_16x16x32_bf16 a[20:23], v[100:103], v[64:67], a[20:23]
    v_mfma_f32_16x16x32_bf16 a[24:27], v[104:107], v[64:67], a[24:27]
    v_mfma_f32_16x16x32_bf16 a[28:31], v[108:111], v[64:67], a[28:31]
    v_mfma_f32_16x16x32_bf16 a[32:35], v[80:83], v[68:71], a[32:35]
    v_mfma_f32_16x16x32_bf16 a[36:39], v[84:87], v[68:71], a[36:39]
    v_mfma_f32_16x16x32_bf16 a[40:43], v[88:91], v[68:71], a[40:43]
    v_mfma_f32_16x16x32_bf16 a[44:47], v[92:95], v[68:71], a[44:47]
    v_mfma_f32_16x16x32_bf16 a[48:51], v[96:99], v[68:71], a[48:51]
    v_mfma_f32_16x16x32_bf16 a[52:55], v[100:103], v[68:71], a[52:55]
    v_mfma_f32_16x16x32_bf16 a[56:59], v[104:107], v[68:71], a[56:59]
    v_mfma_f32_16x16x32_bf16 a[60:63], v[108:111], v[68:71], a[60:63]
    v_mfma_f32_16x16x32_bf16 a[64:67], v[80:83], v[72:75], a[64:67]
    v_mfma_f32_16x16x32_bf16 a[68:71], v[84:87], v[72:75], a[68:71]
    v_mfma_f32_16x16x32_bf16 a[72:75], v[88:91], v[72:75], a[72:75]
    v_mfma_f32_16x16x32_bf16 a[76:79], v[92:95], v[72:75], a[76:79]
    v_mfma_f32_16x16x32_bf16 a[80:83], v[96:99], v[72:75], a[80:83]
    v_mfma_f32_16x16x32_bf16 a[84:87], v[100:103], v[72:75], a[84:87]
    v_mfma_f32_16x16x32_bf16 a[88:91], v[104:107], v[72:75], a[88:91]
    v_mfma_f32_16x16x32_bf16 a[92:95], v[108:111], v[72:75], a[92:95]
    v_mfma_f32_16x16x32_bf16 a[96:99], v[80:83], v[76:79], a[96:99]
    v_mfma_f32_16x16x32_bf16 a[100:103], v[84:87], v[76:79], a[100:103]
    v_mfma_f32_16x16x32_bf16 a[104:107], v[88:91], v[76:79], a[104:107]
    v_mfma_f32_16x16x32_bf16 a[108:111], v[92:95], v[76:79], a[108:111]
    v_mfma_f32_16x16x32_bf16 a[112:115], v[96:99], v[76:79], a[112:115]
    v_mfma_f32_16x16x32_bf16 a[116:119], v[100:103], v[76:79], a[116:119]
    v_mfma_f32_16x16x32_bf16 a[120:123], v[104:107], v[76:79], a[120:123]
    v_mfma_f32_16x16x32_bf16 a[124:127], v[108:111], v[76:79], a[124:127]
    s_waitcnt vmcnt(12)
    s_barrier
    s_add_u32 s64, s60, 768
    s_add_u32 s65, s62, 0
    s_mov_b32 m0, s65
    s_nop 0
    buffer_load_dwordx4 v3, s[20:23], s64 offen lds
    s_add_u32 s64, s64, 8192
    s_add_u32 s65, s65, 1024
    s_mov_b32 m0, s65
    s_nop 0
    buffer_load_dwordx4 v3, s[20:23], s64 offen lds
    s_add_u32 s64, s64, 8192
    s_add_u32 s65, s65, 1024
    s_mov_b32 m0, s65
    s_nop 0
    buffer_load_dwordx4 v3, s[20:23], s64 offen lds
    s_add_u32 s64, s64, 8192
    s_add_u32 s65, s65, 1024
    s_mov_b32 m0, s65
    s_nop 0
    buffer_load_dwordx4 v3, s[20:23], s64 offen lds
    s_add_u32 s64, s61, 768
    s_add_u32 s65, s63, 0
    s_mov_b32 m0, s65
    s_nop 0
    buffer_load_dwordx4 v3, s[24:27], s64 offen lds
    s_add_u32 s64, s64, 8192
    s_add_u32 s65, s65, 1024
    s_mov_b32 m0, s65
    s_nop 0
    buffer_load_dwordx4 v3, s[24:27], s64 offen lds
    s_add_u32 s64, s64, 8192
    s_add_u32 s65, s65, 1024
    s_mov_b32 m0, s65
    s_nop 0
    buffer_load_dwordx4 v3, s[24:27], s64 offen lds
    s_add_u32 s64, s64, 8192
    s_add_u32 s65, s65, 1024
    s_mov_b32 m0, s65
    s_nop 0
    buffer_load_dwordx4 v3, s[24:27], s64 offen lds
    s_add_u32 s64, s64, 8192
    s_add_u32 s65, s65, 1024
    s_mov_b32 m0, s65
    s_nop 0
    buffer_load_dwordx4 v3, s[24:27], s64 offen lds
    s_add_u32 s64, s64, 8192
    s_add_u32 s65, s65, 1024
    s_mov_b32 m0, s65
    s_nop 0
    buffer_load_dwordx4 v3, s[24:27], s64 offen lds
    s_add_u32 s64, s64, 8192
    s_add_u32 s65, s65, 1024
    s_mov_b32 m0, s65
    s_nop 0
    buffer_load_dwordx4 v3, s[24:27], s64 offen lds
    s_add_u32 s64, s64, 8192
    s_add_u32 s65, s65, 1024
    s_mov_b32 m0, s65
    s_nop 0
    buffer_load_dwordx4 v3, s[24:27], s64 offen lds
    ds_read_b128 v[16:19], v8 offset:0
    ds_read_b128 v[20:23], v8 offset:2048
    ds_read_b128 v[24:27], v8 offset:4096
    ds_read_b128 v[28:31], v8 offset:6144
    ds_read_b128 v[32:35], v10 offset:0
    ds_read_b128 v[36:39], v10 offset:2048
    ds_read_b128 v[40:43], v10 offset:4096
    ds_read_b128 v[44:47], v10 offset:6144
    ds_read_b128 v[48:51], v10 offset:8192
    ds_read_b128 v[52:55], v10 offset:10240
    ds_read_b128 v[56:59], v10 offset:12288
    ds_read_b128 v[60:63], v10 offset:14336
    ds_read_b128 v[64:67], v9 offset:0
    ds_read_b128 v[68:71], v9 offset:2048
    ds_read_b128 v[72:75], v9 offset:4096
    ds_read_b128 v[76:79], v9 offset:6144
    ds_read_b128 v[80:83], v11 offset:0
    ds_read_b128 v[84:87], v11 offset:2048
    ds_read_b128 v[88:91], v11 offset:4096
    ds_read_b128 v[92:95], v11 offset:6144
    ds_read_b128 v[96:99], v11 offset:8192
    ds_read_b128 v[100:103], v11 offset:10240
    ds_read_b128 v[104:107], v11 offset:12288
    ds_read_b128 v[108:111], v11 offset:14336
    s_waitcnt lgkmcnt(12)
    v_mfma_f32_16x16x32_bf16 a[0:3], v[32:35], v[16:19], a[0:3]
    v_mfma_f32_16x16x32_bf16 a[4:7], v[36:39], v[16:19], a[4:7]
    v_mfma_f32_16x16x32_bf16 a[8:11], v[40:43], v[16:19], a[8:11]
    v_mfma_f32_16x16x32_bf16 a[12:15], v[44:47], v[16:19], a[12:15]
    v_mfma_f32_16x16x32_bf16 a[16:19], v[48:51], v[16:19], a[16:19]
    v_mfma_f32_16x16x32_bf16 a[20:23], v[52:55], v[16:19], a[20:23]
    v_mfma_f32_16x16x32_bf16 a[24:27], v[56:59], v[16:19], a[24:27]
    v_mfma_f32_16x16x32_bf16 a[28:31], v[60:63], v[16:19], a[28:31]
    v_mfma_f32_16x16x32_bf16 a[32:35], v[32:35], v[20:23], a[32:35]
    v_mfma_f32_16x16x32_bf16 a[36:39], v[36:39], v[20:23], a[36:39]
    v_mfma_f32_16x16x32_bf16 a[40:43], v[40:43], v[20:23], a[40:43]
    v_mfma_f32_16x16x32_bf16 a[44:47], v[44:47], v[20:23], a[44:47]
    v_mfma_f32_16x16x32_bf16 a[48:51], v[48:51], v[20:23], a[48:51]
    v_mfma_f32_16x16x32_bf16 a[52:55], v[52:55], v[20:23], a[52:55]
    v_mfma_f32_16x16x32_bf16 a[56:59], v[56:59], v[20:23], a[56:59]
    v_mfma_f32_16x16x32_bf16 a[60:63], v[60:63], v[20:23], a[60:63]
    v_mfma_f32_16x16x32_bf16 a[64:67], v[32:35], v[24:27], a[64:67]
    v_mfma_f32_16x16x32_bf16 a[68:71], v[36:39], v[24:27], a[68:71]
    v_mfma_f32_16x16x32_bf16 a[72:75], v[40:43], v[24:27], a[72:75]
    v_mfma_f32_16x16x32_bf16 a[76:79], v[44:47], v[24:27], a[76:79]
    v_mfma_f32_16x16x32_bf16 a[80:83], v[48:51], v[24:27], a[80:83]
    v_mfma_f32_16x16x32_bf16 a[84:87], v[52:55], v[24:27], a[84:87]
    v_mfma_f32_16x16x32_bf16 a[88:91], v[56:59], v[24:27], a[88:91]
    v_mfma_f32_16x16x32_bf16 a[92:95], v[60:63], v[24:27], a[92:95]
    v_mfma_f32_16x16x32_bf16 a[96:99], v[32:35], v[28:31], a[96:99]
    v_mfma_f32_16x16x32_bf16 a[100:103], v[36:39], v[28:31], a[100:103]
    v_mfma_f32_16x16x32_bf16 a[104:107], v[40:43], v[28:31], a[104:107]
    v_mfma_f32_16x16x32_bf16 a[108:111], v[44:47], v[28:31], a[108:111]
    v_mfma_f32_16x16x32_bf16 a[112:115], v[48:51], v[28:31], a[112:115]
    v_mfma_f32_16x16x32_bf16 a[116:119], v[52:55], v[28:31], a[116:119]
    v_mfma_f32_16x16x32_bf16 a[120:123], v[56:59], v[28:31], a[120:123]
    v_mfma_f32_16x16x32_bf16 a[124:127], v[60:63], v[28:31], a[124:127]
    s_waitcnt lgkmcnt(0)
    v_mfma_f32_16x16x32_bf16 a[0:3], v[80:83], v[64:67], a[0:3]
    v_mfma_f32_16x16x32_bf16 a[4:7], v[84:87], v[64:67], a[4:7]
    v_mfma_f32_16x16x32_bf16 a[8:11], v[88:91], v[64:67], a[8:11]
    v_mfma_f32_16x16x32_bf16 a[12:15], v[92:95], v[64:67], a[12:15]
    v_mfma_f32_16x16x32_bf16 a[16:19], v[96:99], v[64:67], a[16:19]
    v_mfma_f32_16x16x32_bf16 a[20:23], v[100:103], v[64:67], a[20:23]
    v_mfma_f32_16x16x32_bf16 a[24:27], v[104:107], v[64:67], a[24:27]
    v_mfma_f32_16x16x32_bf16 a[28:31], v[108:111], v[64:67], a[28:31]
    v_mfma_f32_16x16x32_bf16 a[32:35], v[80:83], v[68:71], a[32:35]
    v_mfma_f32_16x16x32_bf16 a[36:39], v[84:87], v[68:71], a[36:39]
    v_mfma_f32_16x16x32_bf16 a[40:43], v[88:91], v[68:71], a[40:43]
    v_mfma_f32_16x16x32_bf16 a[44:47], v[92:95], v[68:71], a[44:47]
    v_mfma_f32_16x16x32_bf16 a[48:51], v[96:99], v[68:71], a[48:51]
    v_mfma_f32_16x16x32_bf16 a[52:55], v[100:103], v[68:71], a[52:55]
    v_mfma_f32_16x16x32_bf16 a[56:59], v[104:107], v[68:71], a[56:59]
    v_mfma_f32_16x16x32_bf16 a[60:63], v[108:111], v[68:71], a[60:63]
    v_mfma_f32_16x16x32_bf16 a[64:67], v[80:83], v[72:75], a[64:67]
    v_mfma_f32_16x16x32_bf16 a[68:71], v[84:87], v[72:75], a[68:71]
    v_mfma_f32_16x16x32_bf16 a[72:75], v[88:91], v[72:75], a[72:75]
    v_mfma_f32_16x16x32_bf16 a[76:79], v[92:95], v[72:75], a[76:79]
    v_mfma_f32_16x16x32_bf16 a[80:83], v[96:99], v[72:75], a[80:83]
    v_mfma_f32_16x16x32_bf16 a[84:87], v[100:103], v[72:75], a[84:87]
    v_mfma_f32_16x16x32_bf16 a[88:91], v[104:107], v[72:75], a[88:91]
    v_mfma_f32_16x16x32_bf16 a[92:95], v[108:111], v[72:75], a[92:95]
    v_mfma_f32_16x16x32_bf16 a[96:99], v[80:83], v[76:79], a[96:99]
    v_mfma_f32_16x16x32_bf16 a[100:103], v[84:87], v[76:79], a[100:103]
    v_mfma_f32_16x16x32_bf16 a[104:107], v[88:91], v[76:79], a[104:107]
    v_mfma_f32_16x16x32_bf16 a[108:111], v[92:95], v[76:79], a[108:111]
    v_mfma_f32_16x16x32_bf16 a[112:115], v[96:99], v[76:79], a[112:115]
    v_mfma_f32_16x16x32_bf16 a[116:119], v[100:103], v[76:79], a[116:119]
    v_mfma_f32_16x16x32_bf16 a[120:123], v[104:107], v[76:79], a[120:123]
    v_mfma_f32_16x16x32_bf16 a[124:127], v[108:111], v[76:79], a[124:127]
    s_waitcnt vmcnt(12)
    s_barrier
    s_add_u32 s64, s60, 896
    s_add_u32 s65, s62, 49152
    s_mov_b32 m0, s65
    s_nop 0
    buffer_load_dwordx4 v3, s[20:23], s64 offen lds
    s_add_u32 s64, s64, 8192
    s_add_u32 s65, s65, 1024
    s_mov_b32 m0, s65
    s_nop 0
    buffer_load_dwordx4 v3, s[20:23], s64 offen lds
    s_add_u32 s64, s64, 8192
    s_add_u32 s65, s65, 1024
    s_mov_b32 m0, s65
    s_nop 0
    buffer_load_dwordx4 v3, s[20:23], s64 offen lds
    s_add_u32 s64, s64, 8192
    s_add_u32 s65, s65, 1024
    s_mov_b32 m0, s65
    s_nop 0
    buffer_load_dwordx4 v3, s[20:23], s64 offen lds
    s_add_u32 s64, s61, 896
    s_add_u32 s65, s63, 49152
    s_mov_b32 m0, s65
    s_nop 0
    buffer_load_dwordx4 v3, s[24:27], s64 offen lds
    s_add_u32 s64, s64, 8192
    s_add_u32 s65, s65, 1024
    s_mov_b32 m0, s65
    s_nop 0
    buffer_load_dwordx4 v3, s[24:27], s64 offen lds
    s_add_u32 s64, s64, 8192
    s_add_u32 s65, s65, 1024
    s_mov_b32 m0, s65
    s_nop 0
    buffer_load_dwordx4 v3, s[24:27], s64 offen lds
    s_add_u32 s64, s64, 8192
    s_add_u32 s65, s65, 1024
    s_mov_b32 m0, s65
    s_nop 0
    buffer_load_dwordx4 v3, s[24:27], s64 offen lds
    s_add_u32 s64, s64, 8192
    s_add_u32 s65, s65, 1024
    s_mov_b32 m0, s65
    s_nop 0
    buffer_load_dwordx4 v3, s[24:27], s64 offen lds
    s_add_u32 s64, s64, 8192
    s_add_u32 s65, s65, 1024
    s_mov_b32 m0, s65
    s_nop 0
    buffer_load_dwordx4 v3, s[24:27], s64 offen lds
    s_add_u32 s64, s64, 8192
    s_add_u32 s65, s65, 1024
    s_mov_b32 m0, s65
    s_nop 0
    buffer_load_dwordx4 v3, s[24:27], s64 offen lds
    s_add_u32 s64, s64, 8192
    s_add_u32 s65, s65, 1024
    s_mov_b32 m0, s65
    s_nop 0
    buffer_load_dwordx4 v3, s[24:27], s64 offen lds
    ds_read_b128 v[16:19], v12 offset:0
    ds_read_b128 v[20:23], v12 offset:2048
    ds_read_b128 v[24:27], v12 offset:4096
    ds_read_b128 v[28:31], v12 offset:6144
    ds_read_b128 v[32:35], v14 offset:0
    ds_read_b128 v[36:39], v14 offset:2048
    ds_read_b128 v[40:43], v14 offset:4096
    ds_read_b128 v[44:47], v14 offset:6144
    ds_read_b128 v[48:51], v14 offset:8192
    ds_read_b128 v[52:55], v14 offset:10240
    ds_read_b128 v[56:59], v14 offset:12288
    ds_read_b128 v[60:63], v14 offset:14336
    ds_read_b128 v[64:67], v13 offset:0
    ds_read_b128 v[68:71], v13 offset:2048
    ds_read_b128 v[72:75], v13 offset:4096
    ds_read_b128 v[76:79], v13 offset:6144
    ds_read_b128 v[80:83], v15 offset:0
    ds_read_b128 v[84:87], v15 offset:2048
    ds_read_b128 v[88:91], v15 offset:4096
    ds_read_b128 v[92:95], v15 offset:6144
    ds_read_b128 v[96:99], v15 offset:8192
    ds_read_b128 v[100:103], v15 offset:10240
    ds_read_b128 v[104:107], v15 offset:12288
    ds_read_b128 v[108:111], v15 offset:14336
    s_waitcnt lgkmcnt(12)
    v_mfma_f32_16x16x32_bf16 a[0:3], v[32:35], v[16:19], a[0:3]
    v_mfma_f32_16x16x32_bf16 a[4:7], v[36:39], v[16:19], a[4:7]
    v_mfma_f32_16x16x32_bf16 a[8:11], v[40:43], v[16:19], a[8:11]
    v_mfma_f32_16x16x32_bf16 a[12:15], v[44:47], v[16:19], a[12:15]
    v_mfma_f32_16x16x32_bf16 a[16:19], v[48:51], v[16:19], a[16:19]
    v_mfma_f32_16x16x32_bf16 a[20:23], v[52:55], v[16:19], a[20:23]
    v_mfma_f32_16x16x32_bf16 a[24:27], v[56:59], v[16:19], a[24:27]
    v_mfma_f32_16x16x32_bf16 a[28:31], v[60:63], v[16:19], a[28:31]
    v_mfma_f32_16x16x32_bf16 a[32:35], v[32:35], v[20:23], a[32:35]
    v_mfma_f32_16x16x32_bf16 a[36:39], v[36:39], v[20:23], a[36:39]
    v_mfma_f32_16x16x32_bf16 a[40:43], v[40:43], v[20:23], a[40:43]
    v_mfma_f32_16x16x32_bf16 a[44:47], v[44:47], v[20:23], a[44:47]
    v_mfma_f32_16x16x32_bf16 a[48:51], v[48:51], v[20:23], a[48:51]
    v_mfma_f32_16x16x32_bf16 a[52:55], v[52:55], v[20:23], a[52:55]
    v_mfma_f32_16x16x32_bf16 a[56:59], v[56:59], v[20:23], a[56:59]
    v_mfma_f32_16x16x32_bf16 a[60:63], v[60:63], v[20:23], a[60:63]
    v_mfma_f32_16x16x32_bf16 a[64:67], v[32:35], v[24:27], a[64:67]
    v_mfma_f32_16x16x32_bf16 a[68:71], v[36:39], v[24:27], a[68:71]
    v_mfma_f32_16x16x32_bf16 a[72:75], v[40:43], v[24:27], a[72:75]
    v_mfma_f32_16x16x32_bf16 a[76:79], v[44:47], v[24:27], a[76:79]
    v_mfma_f32_16x16x32_bf16 a[80:83], v[48:51], v[24:27], a[80:83]
    v_mfma_f32_16x16x32_bf16 a[84:87], v[52:55], v[24:27], a[84:87]
    v_mfma_f32_16x16x32_bf16 a[88:91], v[56:59], v[24:27], a[88:91]
    v_mfma_f32_16x16x32_bf16 a[92:95], v[60:63], v[24:27], a[92:95]
    v_mfma_f32_16x16x32_bf16 a[96:99], v[32:35], v[28:31], a[96:99]
    v_mfma_f32_16x16x32_bf16 a[100:103], v[36:39], v[28:31], a[100:103]
    v_mfma_f32_16x16x32_bf16 a[104:107], v[40:43], v[28:31], a[104:107]
    v_mfma_f32_16x16x32_bf16 a[108:111], v[44:47], v[28:31], a[108:111]
    v_mfma_f32_16x16x32_bf16 a[112:115], v[48:51], v[28:31], a[112:115]
    v_mfma_f32_16x16x32_bf16 a[116:119], v[52:55], v[28:31], a[116:119]
    v_mfma_f32_16x16x32_bf16 a[120:123], v[56:59], v[28:31], a[120:123]
    v_mfma_f32_16x16x32_bf16 a[124:127], v[60:63], v[28:31], a[124:127]
    s_waitcnt lgkmcnt(0)
    v_mfma_f32_16x16x32_bf16 a[0:3], v[80:83], v[64:67], a[0:3]
    v_mfma_f32_16x16x32_bf16 a[4:7], v[84:87], v[64:67], a[4:7]
    v_mfma_f32_16x16x32_bf16 a[8:11], v[88:91], v[64:67], a[8:11]
    v_mfma_f32_16x16x32_bf16 a[12:15], v[92:95], v[64:67], a[12:15]
    v_mfma_f32_16x16x32_bf16 a[16:19], v[96:99], v[64:67], a[16:19]
    v_mfma_f32_16x16x32_bf16 a[20:23], v[100:103], v[64:67], a[20:23]
    v_mfma_f32_16x16x32_bf16 a[24:27], v[104:107], v[64:67], a[24:27]
    v_mfma_f32_16x16x32_bf16 a[28:31], v[108:111], v[64:67], a[28:31]
    v_mfma_f32_16x16x32_bf16 a[32:35], v[80:83], v[68:71], a[32:35]
    v_mfma_f32_16x16x32_bf16 a[36:39], v[84:87], v[68:71], a[36:39]
    v_mfma_f32_16x16x32_bf16 a[40:43], v[88:91], v[68:71], a[40:43]
    v_mfma_f32_16x16x32_bf16 a[44:47], v[92:95], v[68:71], a[44:47]
    v_mfma_f32_16x16x32_bf16 a[48:51], v[96:99], v[68:71], a[48:51]
    v_mfma_f32_16x16x32_bf16 a[52:55], v[100:103], v[68:71], a[52:55]
    v_mfma_f32_16x16x32_bf16 a[56:59], v[104:107], v[68:71], a[56:59]
    v_mfma_f32_16x16x32_bf16 a[60:63], v[108:111], v[68:71], a[60:63]
    v_mfma_f32_16x16x32_bf16 a[64:67], v[80:83], v[72:75], a[64:67]
    v_mfma_f32_16x16x32_bf16 a[68:71], v[84:87], v[72:75], a[68:71]
    v_mfma_f32_16x16x32_bf16 a[72:75], v[88:91], v[72:75], a[72:75]
    v_mfma_f32_16x16x32_bf16 a[76:79], v[92:95], v[72:75], a[76:79]
    v_mfma_f32_16x16x32_bf16 a[80:83], v[96:99], v[72:75], a[80:83]
    v_mfma_f32_16x16x32_bf16 a[84:87], v[100:103], v[72:75], a[84:87]
    v_mfma_f32_16x16x32_bf16 a[88:91], v[104:107], v[72:75], a[88:91]
    v_mfma_f32_16x16x32_bf16 a[92:95], v[108:111], v[72:75], a[92:95]
    v_mfma_f32_16x16x32_bf16 a[96:99], v[80:83], v[76:79], a[96:99]
    v_mfma_f32_16x16x32_bf16 a[100:103], v[84:87], v[76:79], a[100:103]
    v_mfma_f32_16x16x32_bf16 a[104:107], v[88:91], v[76:79], a[104:107]
    v_mfma_f32_16x16x32_bf16 a[108:111], v[92:95], v[76:79], a[108:111]
    v_mfma_f32_16x16x32_bf16 a[112:115], v[96:99], v[76:79], a[112:115]
    v_mfma_f32_16x16x32_bf16 a[116:119], v[100:103], v[76:79], a[116:119]
    v_mfma_f32_16x16x32_bf16 a[120:123], v[104:107], v[76:79], a[120:123]
    v_mfma_f32_16x16x32_bf16 a[124:127], v[108:111], v[76:79], a[124:127]
    s_waitcnt vmcnt(12)
    s_barrier
    ds_read_b128 v[16:19], v4 offset:0
    ds_read_b128 v[20:23], v4 offset:2048
    ds_read_b128 v[24:27], v4 offset:4096
    ds_read_b128 v[28:31], v4 offset:6144
    ds_read_b128 v[32:35], v6 offset:0
    ds_read_b128 v[36:39], v6 offset:2048
    ds_read_b128 v[40:43], v6 offset:4096
    ds_read_b128 v[44:47], v6 offset:6144
    ds_read_b128 v[48:51], v6 offset:8192
    ds_read_b128 v[52:55], v6 offset:10240
    ds_read_b128 v[56:59], v6 offset:12288
    ds_read_b128 v[60:63], v6 offset:14336
    ds_read_b128 v[64:67], v5 offset:0
    ds_read_b128 v[68:71], v5 offset:2048
    ds_read_b128 v[72:75], v5 offset:4096
    ds_read_b128 v[76:79], v5 offset:6144
    ds_read_b128 v[80:83], v7 offset:0
    ds_read_b128 v[84:87], v7 offset:2048
    ds_read_b128 v[88:91], v7 offset:4096
    ds_read_b128 v[92:95], v7 offset:6144
    ds_read_b128 v[96:99], v7 offset:8192
    ds_read_b128 v[100:103], v7 offset:10240
    ds_read_b128 v[104:107], v7 offset:12288
    ds_read_b128 v[108:111], v7 offset:14336
    s_waitcnt lgkmcnt(12)
    v_mfma_f32_16x16x32_bf16 a[0:3], v[32:35], v[16:19], a[0:3]
    v_mfma_f32_16x16x32_bf16 a[4:7], v[36:39], v[16:19], a[4:7]
    v_mfma_f32_16x16x32_bf16 a[8:11], v[40:43], v[16:19], a[8:11]
    v_mfma_f32_16x16x32_bf16 a[12:15], v[44:47], v[16:19], a[12:15]
    v_mfma_f32_16x16x32_bf16 a[16:19], v[48:51], v[16:19], a[16:19]
    v_mfma_f32_16x16x32_bf16 a[20:23], v[52:55], v[16:19], a[20:23]
    v_mfma_f32_16x16x32_bf16 a[24:27], v[56:59], v[16:19], a[24:27]
    v_mfma_f32_16x16x32_bf16 a[28:31], v[60:63], v[16:19], a[28:31]
    v_mfma_f32_16x16x32_bf16 a[32:35], v[32:35], v[20:23], a[32:35]
    v_mfma_f32_16x16x32_bf16 a[36:39], v[36:39], v[20:23], a[36:39]
    v_mfma_f32_16x16x32_bf16 a[40:43], v[40:43], v[20:23], a[40:43]
    v_mfma_f32_16x16x32_bf16 a[44:47], v[44:47], v[20:23], a[44:47]
    v_mfma_f32_16x16x32_bf16 a[48:51], v[48:51], v[20:23], a[48:51]
    v_mfma_f32_16x16x32_bf16 a[52:55], v[52:55], v[20:23], a[52:55]
    v_mfma_f32_16x16x32_bf16 a[56:59], v[56:59], v[20:23], a[56:59]
    v_mfma_f32_16x16x32_bf16 a[60:63], v[60:63], v[20:23], a[60:63]
    v_mfma_f32_16x16x32_bf16 a[64:67], v[32:35], v[24:27], a[64:67]
    v_mfma_f32_16x16x32_bf16 a[68:71], v[36:39], v[24:27], a[68:71]
    v_mfma_f32_16x16x32_bf16 a[72:75], v[40:43], v[24:27], a[72:75]
    v_mfma_f32_16x16x32_bf16 a[76:79], v[44:47], v[24:27], a[76:79]
    v_mfma_f32_16x16x32_bf16 a[80:83], v[48:51], v[24:27], a[80:83]
    v_mfma_f32_16x16x32_bf16 a[84:87], v[52:55], v[24:27], a[84:87]
    v_mfma_f32_16x16x32_bf16 a[88:91], v[56:59], v[24:27], a[88:91]
    v_mfma_f32_16x16x32_bf16 a[92:95], v[60:63], v[24:27], a[92:95]
    v_mfma_f32_16x16x32_bf16 a[96:99], v[32:35], v[28:31], a[96:99]
    v_mfma_f32_16x16x32_bf16 a[100:103], v[36:39], v[28:31], a[100:103]
    v_mfma_f32_16x16x32_bf16 a[104:107], v[40:43], v[28:31], a[104:107]
    v_mfma_f32_16x16x32_bf16 a[108:111], v[44:47], v[28:31], a[108:111]
    v_mfma_f32_16x16x32_bf16 a[112:115], v[48:51], v[28:31], a[112:115]
    v_mfma_f32_16x16x32_bf16 a[116:119], v[52:55], v[28:31], a[116:119]
    v_mfma_f32_16x16x32_bf16 a[120:123], v[56:59], v[28:31], a[120:123]
    v_mfma_f32_16x16x32_bf16 a[124:127], v[60:63], v[28:31], a[124:127]
    s_waitcnt lgkmcnt(0)
    v_mfma_f32_16x16x32_bf16 a[0:3], v[80:83], v[64:67], a[0:3]
    v_mfma_f32_16x16x32_bf16 a[4:7], v[84:87], v[64:67], a[4:7]
    v_mfma_f32_16x16x32_bf16 a[8:11], v[88:91], v[64:67], a[8:11]
    v_mfma_f32_16x16x32_bf16 a[12:15], v[92:95], v[64:67], a[12:15]
    v_mfma_f32_16x16x32_bf16 a[16:19], v[96:99], v[64:67], a[16:19]
    v_mfma_f32_16x16x32_bf16 a[20:23], v[100:103], v[64:67], a[20:23]
    v_mfma_f32_16x16x32_bf16 a[24:27], v[104:107], v[64:67], a[24:27]
    v_mfma_f32_16x16x32_bf16 a[28:31], v[108:111], v[64:67], a[28:31]
    v_mfma_f32_16x16x32_bf16 a[32:35], v[80:83], v[68:71], a[32:35]
    v_mfma_f32_16x16x32_bf16 a[36:39], v[84:87], v[68:71], a[36:39]
    v_mfma_f32_16x16x32_bf16 a[40:43], v[88:91], v[68:71], a[40:43]
    v_mfma_f32_16x16x32_bf16 a[44:47], v[92:95], v[68:71], a[44:47]
    v_mfma_f32_16x16x32_bf16 a[48:51], v[96:99], v[68:71], a[48:51]
    v_mfma_f32_16x16x32_bf16 a[52:55], v[100:103], v[68:71], a[52:55]
    v_mfma_f32_16x16x32_bf16 a[56:59], v[104:107], v[68:71], a[56:59]
    v_mfma_f32_16x16x32_bf16 a[60:63], v[108:111], v[68:71], a[60:63]
    v_mfma_f32_16x16x32_bf16 a[64:67], v[80:83], v[72:75], a[64:67]
    v_mfma_f32_16x16x32_bf16 a[68:71], v[84:87], v[72:75], a[68:71]
    v_mfma_f32_16x16x32_bf16 a[72:75], v[88:91], v[72:75], a[72:75]
    v_mfma_f32_16x16x32_bf16 a[76:79], v[92:95], v[72:75], a[76:79]
    v_mfma_f32_16x16x32_bf16 a[80:83], v[96:99], v[72:75], a[80:83]
    v_mfma_f32_16x16x32_bf16 a[84:87], v[100:103], v[72:75], a[84:87]
    v_mfma_f32_16x16x32_bf16 a[88:91], v[104:107], v[72:75], a[88:91]
    v_mfma_f32_16x16x32_bf16 a[92:95], v[108:111], v[72:75], a[92:95]
    v_mfma_f32_16x16x32_bf16 a[96:99], v[80:83], v[76:79], a[96:99]
    v_mfma_f32_16x16x32_bf16 a[100:103], v[84:87], v[76:79], a[100:103]
    v_mfma_f32_16x16x32_bf16 a[104:107], v[88:91], v[76:79], a[104:107]
    v_mfma_f32_16x16x32_bf16 a[108:111], v[92:95], v[76:79], a[108:111]
    v_mfma_f32_16x16x32_bf16 a[112:115], v[96:99], v[76:79], a[112:115]
    v_mfma_f32_16x16x32_bf16 a[116:119], v[100:103], v[76:79], a[116:119]
    v_mfma_f32_16x16x32_bf16 a[120:123], v[104:107], v[76:79], a[120:123]
    v_mfma_f32_16x16x32_bf16 a[124:127], v[108:111], v[76:79], a[124:127]
    s_waitcnt vmcnt(0)
    s_barrier
    ds_read_b128 v[16:19], v8 offset:0
    ds_read_b128 v[20:23], v8 offset:2048
    ds_read_b128 v[24:27], v8 offset:4096
    ds_read_b128 v[28:31], v8 offset:6144
    ds_read_b128 v[32:35], v10 offset:0
    ds_read_b128 v[36:39], v10 offset:2048
    ds_read_b128 v[40:43], v10 offset:4096
    ds_read_b128 v[44:47], v10 offset:6144
    ds_read_b128 v[48:51], v10 offset:8192
    ds_read_b128 v[52:55], v10 offset:10240
    ds_read_b128 v[56:59], v10 offset:12288
    ds_read_b128 v[60:63], v10 offset:14336
    ds_read_b128 v[64:67], v9 offset:0
    ds_read_b128 v[68:71], v9 offset:2048
    ds_read_b128 v[72:75], v9 offset:4096
    ds_read_b128 v[76:79], v9 offset:6144
    ds_read_b128 v[80:83], v11 offset:0
    ds_read_b128 v[84:87], v11 offset:2048
    ds_read_b128 v[88:91], v11 offset:4096
    ds_read_b128 v[92:95], v11 offset:6144
    ds_read_b128 v[96:99], v11 offset:8192
    ds_read_b128 v[100:103], v11 offset:10240
    ds_read_b128 v[104:107], v11 offset:12288
    ds_read_b128 v[108:111], v11 offset:14336
    s_waitcnt lgkmcnt(12)
    v_mfma_f32_16x16x32_bf16 a[0:3], v[32:35], v[16:19], a[0:3]
    v_mfma_f32_16x16x32_bf16 a[4:7], v[36:39], v[16:19], a[4:7]
    v_mfma_f32_16x16x32_bf16 a[8:11], v[40:43], v[16:19], a[8:11]
    v_mfma_f32_16x16x32_bf16 a[12:15], v[44:47], v[16:19], a[12:15]
    v_mfma_f32_16x16x32_bf16 a[16:19], v[48:51], v[16:19], a[16:19]
    v_mfma_f32_16x16x32_bf16 a[20:23], v[52:55], v[16:19], a[20:23]
    v_mfma_f32_16x16x32_bf16 a[24:27], v[56:59], v[16:19], a[24:27]
    v_mfma_f32_16x16x32_bf16 a[28:31], v[60:63], v[16:19], a[28:31]
    v_mfma_f32_16x16x32_bf16 a[32:35], v[32:35], v[20:23], a[32:35]
    v_mfma_f32_16x16x32_bf16 a[36:39], v[36:39], v[20:23], a[36:39]
    v_mfma_f32_16x16x32_bf16 a[40:43], v[40:43], v[20:23], a[40:43]
    v_mfma_f32_16x16x32_bf16 a[44:47], v[44:47], v[20:23], a[44:47]
    v_mfma_f32_16x16x32_bf16 a[48:51], v[48:51], v[20:23], a[48:51]
    v_mfma_f32_16x16x32_bf16 a[52:55], v[52:55], v[20:23], a[52:55]
    v_mfma_f32_16x16x32_bf16 a[56:59], v[56:59], v[20:23], a[56:59]
    v_mfma_f32_16x16x32_bf16 a[60:63], v[60:63], v[20:23], a[60:63]
    v_mfma_f32_16x16x32_bf16 a[64:67], v[32:35], v[24:27], a[64:67]
    v_mfma_f32_16x16x32_bf16 a[68:71], v[36:39], v[24:27], a[68:71]
    v_mfma_f32_16x16x32_bf16 a[72:75], v[40:43], v[24:27], a[72:75]
    v_mfma_f32_16x16x32_bf16 a[76:79], v[44:47], v[24:27], a[76:79]
    v_mfma_f32_16x16x32_bf16 a[80:83], v[48:51], v[24:27], a[80:83]
    v_mfma_f32_16x16x32_bf16 a[84:87], v[52:55], v[24:27], a[84:87]
    v_mfma_f32_16x16x32_bf16 a[88:91], v[56:59], v[24:27], a[88:91]
    v_mfma_f32_16x16x32_bf16 a[92:95], v[60:63], v[24:27], a[92:95]
    v_mfma_f32_16x16x32_bf16 a[96:99], v[32:35], v[28:31], a[96:99]
    v_mfma_f32_16x16x32_bf16 a[100:103], v[36:39], v[28:31], a[100:103]
    v_mfma_f32_16x16x32_bf16 a[104:107], v[40:43], v[28:31], a[104:107]
    v_mfma_f32_16x16x32_bf16 a[108:111], v[44:47], v[28:31], a[108:111]
    v_mfma_f32_16x16x32_bf16 a[112:115], v[48:51], v[28:31], a[112:115]
    v_mfma_f32_16x16x32_bf16 a[116:119], v[52:55], v[28:31], a[116:119]
    v_mfma_f32_16x16x32_bf16 a[120:123], v[56:59], v[28:31], a[120:123]
    v_mfma_f32_16x16x32_bf16 a[124:127], v[60:63], v[28:31], a[124:127]
    s_waitcnt lgkmcnt(0)
    v_mfma_f32_16x16x32_bf16 a[0:3], v[80:83], v[64:67], a[0:3]
    v_mfma_f32_16x16x32_bf16 a[4:7], v[84:87], v[64:67], a[4:7]
    v_mfma_f32_16x16x32_bf16 a[8:11], v[88:91], v[64:67], a[8:11]
    v_mfma_f32_16x16x32_bf16 a[12:15], v[92:95], v[64:67], a[12:15]
    v_mfma_f32_16x16x32_bf16 a[16:19], v[96:99], v[64:67], a[16:19]
    v_mfma_f32_16x16x32_bf16 a[20:23], v[100:103], v[64:67], a[20:23]
    v_mfma_f32_16x16x32_bf16 a[24:27], v[104:107], v[64:67], a[24:27]
    v_mfma_f32_16x16x32_bf16 a[28:31], v[108:111], v[64:67], a[28:31]
    v_mfma_f32_16x16x32_bf16 a[32:35], v[80:83], v[68:71], a[32:35]
    v_mfma_f32_16x16x32_bf16 a[36:39], v[84:87], v[68:71], a[36:39]
    v_mfma_f32_16x16x32_bf16 a[40:43], v[88:91], v[68:71], a[40:43]
    v_mfma_f32_16x16x32_bf16 a[44:47], v[92:95], v[68:71], a[44:47]
    v_mfma_f32_16x16x32_bf16 a[48:51], v[96:99], v[68:71], a[48:51]
    v_mfma_f32_16x16x32_bf16 a[52:55], v[100:103], v[68:71], a[52:55]
    v_mfma_f32_16x16x32_bf16 a[56:59], v[104:107], v[68:71], a[56:59]
    v_mfma_f32_16x16x32_bf16 a[60:63], v[108:111], v[68:71], a[60:63]
    v_mfma_f32_16x16x32_bf16 a[64:67], v[80:83], v[72:75], a[64:67]
    v_mfma_f32_16x16x32_bf16 a[68:71], v[84:87], v[72:75], a[68:71]
    v_mfma_f32_16x16x32_bf16 a[72:75], v[88:91], v[72:75], a[72:75]
    v_mfma_f32_16x16x32_bf16 a[76:79], v[92:95], v[72:75], a[76:79]
    v_mfma_f32_16x16x32_bf16 a[80:83], v[96:99], v[72:75], a[80:83]
    v_mfma_f32_16x16x32_bf16 a[84:87], v[100:103], v[72:75], a[84:87]
    v_mfma_f32_16x16x32_bf16 a[88:91], v[104:107], v[72:75], a[88:91]
    v_mfma_f32_16x16x32_bf16 a[92:95], v[108:111], v[72:75], a[92:95]
    v_mfma_f32_16x16x32_bf16 a[96:99], v[80:83], v[76:79], a[96:99]
    v_mfma_f32_16x16x32_bf16 a[100:103], v[84:87], v[76:79], a[100:103]
    v_mfma_f32_16x16x32_bf16 a[104:107], v[88:91], v[76:79], a[104:107]
    v_mfma_f32_16x16x32_bf16 a[108:111], v[92:95], v[76:79], a[108:111]
    v_mfma_f32_16x16x32_bf16 a[112:115], v[96:99], v[76:79], a[112:115]
    v_mfma_f32_16x16x32_bf16 a[116:119], v[100:103], v[76:79], a[116:119]
    v_mfma_f32_16x16x32_bf16 a[120:123], v[104:107], v[76:79], a[120:123]
    v_mfma_f32_16x16x32_bf16 a[124:127], v[108:111], v[76:79], a[124:127]
    s_nop 7
    s_nop 7
    s_lshl_b32 s64, s57, 7
    s_lshr_b32 s65, s59, 1
    s_lshl_b32 s65, s65, 6
    s_add_u32 s64, s64, s65
    s_mul_i32 s64, s64, 3584
    s_lshl_b32 s65, s58, 8
    s_add_u32 s64, s64, s65
    s_and_b32 s65, s59, 1
    s_lshl_b32 s65, s65, 7
    s_add_u32 s64, s64, s65
    v_and_b32 v16, 15, v1
    v_lshrrev_b32 v17, 4, v1
    v_mul_u32_u24 v112, 3584, v16
    v_lshl_add_u32 v112, v17, 3, v112
    v_add_u32 v112, s64, v112

    v_accvgpr_read_b32 v114, a0
    v_accvgpr_read_b32 v118, a16
    v_accvgpr_read_b32 v115, a1
    v_accvgpr_read_b32 v119, a17
    v_accvgpr_read_b32 v116, a2
    v_accvgpr_read_b32 v120, a18
    v_accvgpr_read_b32 v117, a3
    v_accvgpr_read_b32 v121, a19
    v_cvt_pk_bf16_f32 v114, v114, v114
    v_lshlrev_b32 v114, 16, v114
    v_cvt_pk_bf16_f32 v118, v118, v118
    v_lshlrev_b32 v118, 16, v118
    v_mul_f32 v114, v114, v118
    v_cvt_pk_bf16_f32 v115, v115, v115
    v_lshlrev_b32 v115, 16, v115
    v_cvt_pk_bf16_f32 v119, v119, v119
    v_lshlrev_b32 v119, 16, v119
    v_mul_f32 v115, v115, v119
    v_cvt_pk_bf16_f32 v116, v116, v116
    v_lshlrev_b32 v116, 16, v116
    v_cvt_pk_bf16_f32 v120, v120, v120
    v_lshlrev_b32 v120, 16, v120
    v_mul_f32 v116, v116, v120
    v_cvt_pk_bf16_f32 v117, v117, v117
    v_lshlrev_b32 v117, 16, v117
    v_cvt_pk_bf16_f32 v121, v121, v121
    v_lshlrev_b32 v121, 16, v121
    v_mul_f32 v117, v117, v121
    v_cvt_pk_bf16_f32 v122, v114, v115
    v_cvt_pk_bf16_f32 v123, v116, v117
    v_add_u32 v113, 0, v112
    buffer_store_dwordx2 v[122:123], v113, s[28:31], 0 offen offset:0
    s_nop 1
    v_accvgpr_read_b32 v114, a4
    v_accvgpr_read_b32 v118, a20
    v_accvgpr_read_b32 v115, a5
    v_accvgpr_read_b32 v119, a21
    v_accvgpr_read_b32 v116, a6
    v_accvgpr_read_b32 v120, a22
    v_accvgpr_read_b32 v117, a7
    v_accvgpr_read_b32 v121, a23
    v_cvt_pk_bf16_f32 v114, v114, v114
    v_lshlrev_b32 v114, 16, v114
    v_cvt_pk_bf16_f32 v118, v118, v118
    v_lshlrev_b32 v118, 16, v118
    v_mul_f32 v114, v114, v118
    v_cvt_pk_bf16_f32 v115, v115, v115
    v_lshlrev_b32 v115, 16, v115
    v_cvt_pk_bf16_f32 v119, v119, v119
    v_lshlrev_b32 v119, 16, v119
    v_mul_f32 v115, v115, v119
    v_cvt_pk_bf16_f32 v116, v116, v116
    v_lshlrev_b32 v116, 16, v116
    v_cvt_pk_bf16_f32 v120, v120, v120
    v_lshlrev_b32 v120, 16, v120
    v_mul_f32 v116, v116, v120
    v_cvt_pk_bf16_f32 v117, v117, v117
    v_lshlrev_b32 v117, 16, v117
    v_cvt_pk_bf16_f32 v121, v121, v121
    v_lshlrev_b32 v121, 16, v121
    v_mul_f32 v117, v117, v121
    v_cvt_pk_bf16_f32 v122, v114, v115
    v_cvt_pk_bf16_f32 v123, v116, v117
    v_add_u32 v113, 0, v112
    buffer_store_dwordx2 v[122:123], v113, s[28:31], 0 offen offset:32
    s_nop 1
    v_accvgpr_read_b32 v114, a8
    v_accvgpr_read_b32 v118, a24
    v_accvgpr_read_b32 v115, a9
    v_accvgpr_read_b32 v119, a25
    v_accvgpr_read_b32 v116, a10
    v_accvgpr_read_b32 v120, a26
    v_accvgpr_read_b32 v117, a11
    v_accvgpr_read_b32 v121, a27
    v_cvt_pk_bf16_f32 v114, v114, v114
    v_lshlrev_b32 v114, 16, v114
    v_cvt_pk_bf16_f32 v118, v118, v118
    v_lshlrev_b32 v118, 16, v118
    v_mul_f32 v114, v114, v118
    v_cvt_pk_bf16_f32 v115, v115, v115
    v_lshlrev_b32 v115, 16, v115
    v_cvt_pk_bf16_f32 v119, v119, v119
    v_lshlrev_b32 v119, 16, v119
    v_mul_f32 v115, v115, v119
    v_cvt_pk_bf16_f32 v116, v116, v116
    v_lshlrev_b32 v116, 16, v116
    v_cvt_pk_bf16_f32 v120, v120, v120
    v_lshlrev_b32 v120, 16, v120
    v_mul_f32 v116, v116, v120
    v_cvt_pk_bf16_f32 v117, v117, v117
    v_lshlrev_b32 v117, 16, v117
    v_cvt_pk_bf16_f32 v121, v121, v121
    v_lshlrev_b32 v121, 16, v121
    v_mul_f32 v117, v117, v121
    v_cvt_pk_bf16_f32 v122, v114, v115
    v_cvt_pk_bf16_f32 v123, v116, v117
    v_add_u32 v113, 0, v112
    buffer_store_dwordx2 v[122:123], v113, s[28:31], 0 offen offset:64
    s_nop 1
    v_accvgpr_read_b32 v114, a12
    v_accvgpr_read_b32 v118, a28
    v_accvgpr_read_b32 v115, a13
    v_accvgpr_read_b32 v119, a29
    v_accvgpr_read_b32 v116, a14
    v_accvgpr_read_b32 v120, a30
    v_accvgpr_read_b32 v117, a15
    v_accvgpr_read_b32 v121, a31
    v_cvt_pk_bf16_f32 v114, v114, v114
    v_lshlrev_b32 v114, 16, v114
    v_cvt_pk_bf16_f32 v118, v118, v118
    v_lshlrev_b32 v118, 16, v118
    v_mul_f32 v114, v114, v118
    v_cvt_pk_bf16_f32 v115, v115, v115
    v_lshlrev_b32 v115, 16, v115
    v_cvt_pk_bf16_f32 v119, v119, v119
    v_lshlrev_b32 v119, 16, v119
    v_mul_f32 v115, v115, v119
    v_cvt_pk_bf16_f32 v116, v116, v116
    v_lshlrev_b32 v116, 16, v116
    v_cvt_pk_bf16_f32 v120, v120, v120
    v_lshlrev_b32 v120, 16, v120
    v_mul_f32 v116, v116, v120
    v_cvt_pk_bf16_f32 v117, v117, v117
    v_lshlrev_b32 v117, 16, v117
    v_cvt_pk_bf16_f32 v121, v121, v121
    v_lshlrev_b32 v121, 16, v121
    v_mul_f32 v117, v117, v121
    v_cvt_pk_bf16_f32 v122, v114, v115
    v_cvt_pk_bf16_f32 v123, v116, v117
    v_add_u32 v113, 0, v112
    buffer_store_dwordx2 v[122:123], v113, s[28:31], 0 offen offset:96
    s_nop 1
    v_accvgpr_read_b32 v114, a32
    v_accvgpr_read_b32 v118, a48
    v_accvgpr_read_b32 v115, a33
    v_accvgpr_read_b32 v119, a49
    v_accvgpr_read_b32 v116, a34
    v_accvgpr_read_b32 v120, a50
    v_accvgpr_read_b32 v117, a35
    v_accvgpr_read_b32 v121, a51
    v_cvt_pk_bf16_f32 v114, v114, v114
    v_lshlrev_b32 v114, 16, v114
    v_cvt_pk_bf16_f32 v118, v118, v118
    v_lshlrev_b32 v118, 16, v118
    v_mul_f32 v114, v114, v118
    v_cvt_pk_bf16_f32 v115, v115, v115
    v_lshlrev_b32 v115, 16, v115
    v_cvt_pk_bf16_f32 v119, v119, v119
    v_lshlrev_b32 v119, 16, v119
    v_mul_f32 v115, v115, v119
    v_cvt_pk_bf16_f32 v116, v116, v116
    v_lshlrev_b32 v116, 16, v116
    v_cvt_pk_bf16_f32 v120, v120, v120
    v_lshlrev_b32 v120, 16, v120
    v_mul_f32 v116, v116, v120
    v_cvt_pk_bf16_f32 v117, v117, v117
    v_lshlrev_b32 v117, 16, v117
    v_cvt_pk_bf16_f32 v121, v121, v121
    v_lshlrev_b32 v121, 16, v121
    v_mul_f32 v117, v117, v121
    v_cvt_pk_bf16_f32 v122, v114, v115
    v_cvt_pk_bf16_f32 v123, v116, v117
    v_add_u32 v113, 57344, v112
    buffer_store_dwordx2 v[122:123], v113, s[28:31], 0 offen offset:0
    s_nop 1
    v_accvgpr_read_b32 v114, a36
    v_accvgpr_read_b32 v118, a52
    v_accvgpr_read_b32 v115, a37
    v_accvgpr_read_b32 v119, a53
    v_accvgpr_read_b32 v116, a38
    v_accvgpr_read_b32 v120, a54
    v_accvgpr_read_b32 v117, a39
    v_accvgpr_read_b32 v121, a55
    v_cvt_pk_bf16_f32 v114, v114, v114
    v_lshlrev_b32 v114, 16, v114
    v_cvt_pk_bf16_f32 v118, v118, v118
    v_lshlrev_b32 v118, 16, v118
    v_mul_f32 v114, v114, v118
    v_cvt_pk_bf16_f32 v115, v115, v115
    v_lshlrev_b32 v115, 16, v115
    v_cvt_pk_bf16_f32 v119, v119, v119
    v_lshlrev_b32 v119, 16, v119
    v_mul_f32 v115, v115, v119
    v_cvt_pk_bf16_f32 v116, v116, v116
    v_lshlrev_b32 v116, 16, v116
    v_cvt_pk_bf16_f32 v120, v120, v120
    v_lshlrev_b32 v120, 16, v120
    v_mul_f32 v116, v116, v120
    v_cvt_pk_bf16_f32 v117, v117, v117
    v_lshlrev_b32 v117, 16, v117
    v_cvt_pk_bf16_f32 v121, v121, v121
    v_lshlrev_b32 v121, 16, v121
    v_mul_f32 v117, v117, v121
    v_cvt_pk_bf16_f32 v122, v114, v115
    v_cvt_pk_bf16_f32 v123, v116, v117
    v_add_u32 v113, 57344, v112
    buffer_store_dwordx2 v[122:123], v113, s[28:31], 0 offen offset:32
    s_nop 1
    v_accvgpr_read_b32 v114, a40
    v_accvgpr_read_b32 v118, a56
    v_accvgpr_read_b32 v115, a41
    v_accvgpr_read_b32 v119, a57
    v_accvgpr_read_b32 v116, a42
    v_accvgpr_read_b32 v120, a58
    v_accvgpr_read_b32 v117, a43
    v_accvgpr_read_b32 v121, a59
    v_cvt_pk_bf16_f32 v114, v114, v114
    v_lshlrev_b32 v114, 16, v114
    v_cvt_pk_bf16_f32 v118, v118, v118
    v_lshlrev_b32 v118, 16, v118
    v_mul_f32 v114, v114, v118
    v_cvt_pk_bf16_f32 v115, v115, v115
    v_lshlrev_b32 v115, 16, v115
    v_cvt_pk_bf16_f32 v119, v119, v119
    v_lshlrev_b32 v119, 16, v119
    v_mul_f32 v115, v115, v119
    v_cvt_pk_bf16_f32 v116, v116, v116
    v_lshlrev_b32 v116, 16, v116
    v_cvt_pk_bf16_f32 v120, v120, v120
    v_lshlrev_b32 v120, 16, v120
    v_mul_f32 v116, v116, v120
    v_cvt_pk_bf16_f32 v117, v117, v117
    v_lshlrev_b32 v117, 16, v117
    v_cvt_pk_bf16_f32 v121, v121, v121
    v_lshlrev_b32 v121, 16, v121
    v_mul_f32 v117, v117, v121
    v_cvt_pk_bf16_f32 v122, v114, v115
    v_cvt_pk_bf16_f32 v123, v116, v117
    v_add_u32 v113, 57344, v112
    buffer_store_dwordx2 v[122:123], v113, s[28:31], 0 offen offset:64
    s_nop 1
    v_accvgpr_read_b32 v114, a44
    v_accvgpr_read_b32 v118, a60
    v_accvgpr_read_b32 v115, a45
    v_accvgpr_read_b32 v119, a61
    v_accvgpr_read_b32 v116, a46
    v_accvgpr_read_b32 v120, a62
    v_accvgpr_read_b32 v117, a47
    v_accvgpr_read_b32 v121, a63
    v_cvt_pk_bf16_f32 v114, v114, v114
    v_lshlrev_b32 v114, 16, v114
    v_cvt_pk_bf16_f32 v118, v118, v118
    v_lshlrev_b32 v118, 16, v118
    v_mul_f32 v114, v114, v118
    v_cvt_pk_bf16_f32 v115, v115, v115
    v_lshlrev_b32 v115, 16, v115
    v_cvt_pk_bf16_f32 v119, v119, v119
    v_lshlrev_b32 v119, 16, v119
    v_mul_f32 v115, v115, v119
    v_cvt_pk_bf16_f32 v116, v116, v116
    v_lshlrev_b32 v116, 16, v116
    v_cvt_pk_bf16_f32 v120, v120, v120
    v_lshlrev_b32 v120, 16, v120
    v_mul_f32 v116, v116, v120
    v_cvt_pk_bf16_f32 v117, v117, v117
    v_lshlrev_b32 v117, 16, v117
    v_cvt_pk_bf16_f32 v121, v121, v121
    v_lshlrev_b32 v121, 16, v121
    v_mul_f32 v117, v117, v121
    v_cvt_pk_bf16_f32 v122, v114, v115
    v_cvt_pk_bf16_f32 v123, v116, v117
    v_add_u32 v113, 57344, v112
    buffer_store_dwordx2 v[122:123], v113, s[28:31], 0 offen offset:96
    s_nop 1
    v_accvgpr_read_b32 v114, a64
    v_accvgpr_read_b32 v118, a80
    v_accvgpr_read_b32 v115, a65
    v_accvgpr_read_b32 v119, a81
    v_accvgpr_read_b32 v116, a66
    v_accvgpr_read_b32 v120, a82
    v_accvgpr_read_b32 v117, a67
    v_accvgpr_read_b32 v121, a83
    v_cvt_pk_bf16_f32 v114, v114, v114
    v_lshlrev_b32 v114, 16, v114
    v_cvt_pk_bf16_f32 v118, v118, v118
    v_lshlrev_b32 v118, 16, v118
    v_mul_f32 v114, v114, v118
    v_cvt_pk_bf16_f32 v115, v115, v115
    v_lshlrev_b32 v115, 16, v115
    v_cvt_pk_bf16_f32 v119, v119, v119
    v_lshlrev_b32 v119, 16, v119
    v_mul_f32 v115, v115, v119
    v_cvt_pk_bf16_f32 v116, v116, v116
    v_lshlrev_b32 v116, 16, v116
    v_cvt_pk_bf16_f32 v120, v120, v120
    v_lshlrev_b32 v120, 16, v120
    v_mul_f32 v116, v116, v120
    v_cvt_pk_bf16_f32 v117, v117, v117
    v_lshlrev_b32 v117, 16, v117
    v_cvt_pk_bf16_f32 v121, v121, v121
    v_lshlrev_b32 v121, 16, v121
    v_mul_f32 v117, v117, v121
    v_cvt_pk_bf16_f32 v122, v114, v115
    v_cvt_pk_bf16_f32 v123, v116, v117
    v_add_u32 v113, 114688, v112
    buffer_store_dwordx2 v[122:123], v113, s[28:31], 0 offen offset:0
    s_nop 1
    v_accvgpr_read_b32 v114, a68
    v_accvgpr_read_b32 v118, a84
    v_accvgpr_read_b32 v115, a69
    v_accvgpr_read_b32 v119, a85
    v_accvgpr_read_b32 v116, a70
    v_accvgpr_read_b32 v120, a86
    v_accvgpr_read_b32 v117, a71
    v_accvgpr_read_b32 v121, a87
    v_cvt_pk_bf16_f32 v114, v114, v114
    v_lshlrev_b32 v114, 16, v114
    v_cvt_pk_bf16_f32 v118, v118, v118
    v_lshlrev_b32 v118, 16, v118
    v_mul_f32 v114, v114, v118
    v_cvt_pk_bf16_f32 v115, v115, v115
    v_lshlrev_b32 v115, 16, v115
    v_cvt_pk_bf16_f32 v119, v119, v119
    v_lshlrev_b32 v119, 16, v119
    v_mul_f32 v115, v115, v119
    v_cvt_pk_bf16_f32 v116, v116, v116
    v_lshlrev_b32 v116, 16, v116
    v_cvt_pk_bf16_f32 v120, v120, v120
    v_lshlrev_b32 v120, 16, v120
    v_mul_f32 v116, v116, v120
    v_cvt_pk_bf16_f32 v117, v117, v117
    v_lshlrev_b32 v117, 16, v117
    v_cvt_pk_bf16_f32 v121, v121, v121
    v_lshlrev_b32 v121, 16, v121
    v_mul_f32 v117, v117, v121
    v_cvt_pk_bf16_f32 v122, v114, v115
    v_cvt_pk_bf16_f32 v123, v116, v117
    v_add_u32 v113, 114688, v112
    buffer_store_dwordx2 v[122:123], v113, s[28:31], 0 offen offset:32
    s_nop 1
    v_accvgpr_read_b32 v114, a72
    v_accvgpr_read_b32 v118, a88
    v_accvgpr_read_b32 v115, a73
    v_accvgpr_read_b32 v119, a89
    v_accvgpr_read_b32 v116, a74
    v_accvgpr_read_b32 v120, a90
    v_accvgpr_read_b32 v117, a75
    v_accvgpr_read_b32 v121, a91
    v_cvt_pk_bf16_f32 v114, v114, v114
    v_lshlrev_b32 v114, 16, v114
    v_cvt_pk_bf16_f32 v118, v118, v118
    v_lshlrev_b32 v118, 16, v118
    v_mul_f32 v114, v114, v118
    v_cvt_pk_bf16_f32 v115, v115, v115
    v_lshlrev_b32 v115, 16, v115
    v_cvt_pk_bf16_f32 v119, v119, v119
    v_lshlrev_b32 v119, 16, v119
    v_mul_f32 v115, v115, v119
    v_cvt_pk_bf16_f32 v116, v116, v116
    v_lshlrev_b32 v116, 16, v116
    v_cvt_pk_bf16_f32 v120, v120, v120
    v_lshlrev_b32 v120, 16, v120
    v_mul_f32 v116, v116, v120
    v_cvt_pk_bf16_f32 v117, v117, v117
    v_lshlrev_b32 v117, 16, v117
    v_cvt_pk_bf16_f32 v121, v121, v121
    v_lshlrev_b32 v121, 16, v121
    v_mul_f32 v117, v117, v121
    v_cvt_pk_bf16_f32 v122, v114, v115
    v_cvt_pk_bf16_f32 v123, v116, v117
    v_add_u32 v113, 114688, v112
    buffer_store_dwordx2 v[122:123], v113, s[28:31], 0 offen offset:64
    s_nop 1
    v_accvgpr_read_b32 v114, a76
    v_accvgpr_read_b32 v118, a92
    v_accvgpr_read_b32 v115, a77
    v_accvgpr_read_b32 v119, a93
    v_accvgpr_read_b32 v116, a78
    v_accvgpr_read_b32 v120, a94
    v_accvgpr_read_b32 v117, a79
    v_accvgpr_read_b32 v121, a95
    v_cvt_pk_bf16_f32 v114, v114, v114
    v_lshlrev_b32 v114, 16, v114
    v_cvt_pk_bf16_f32 v118, v118, v118
    v_lshlrev_b32 v118, 16, v118
    v_mul_f32 v114, v114, v118
    v_cvt_pk_bf16_f32 v115, v115, v115
    v_lshlrev_b32 v115, 16, v115
    v_cvt_pk_bf16_f32 v119, v119, v119
    v_lshlrev_b32 v119, 16, v119
    v_mul_f32 v115, v115, v119
    v_cvt_pk_bf16_f32 v116, v116, v116
    v_lshlrev_b32 v116, 16, v116
    v_cvt_pk_bf16_f32 v120, v120, v120
    v_lshlrev_b32 v120, 16, v120
    v_mul_f32 v116, v116, v120
    v_cvt_pk_bf16_f32 v117, v117, v117
    v_lshlrev_b32 v117, 16, v117
    v_cvt_pk_bf16_f32 v121, v121, v121
    v_lshlrev_b32 v121, 16, v121
    v_mul_f32 v117, v117, v121
    v_cvt_pk_bf16_f32 v122, v114, v115
    v_cvt_pk_bf16_f32 v123, v116, v117
    v_add_u32 v113, 114688, v112
    buffer_store_dwordx2 v[122:123], v113, s[28:31], 0 offen offset:96
    s_nop 1
    v_accvgpr_read_b32 v114, a96
    v_accvgpr_read_b32 v118, a112
    v_accvgpr_read_b32 v115, a97
    v_accvgpr_read_b32 v119, a113
    v_accvgpr_read_b32 v116, a98
    v_accvgpr_read_b32 v120, a114
    v_accvgpr_read_b32 v117, a99
    v_accvgpr_read_b32 v121, a115
    v_cvt_pk_bf16_f32 v114, v114, v114
    v_lshlrev_b32 v114, 16, v114
    v_cvt_pk_bf16_f32 v118, v118, v118
    v_lshlrev_b32 v118, 16, v118
    v_mul_f32 v114, v114, v118
    v_cvt_pk_bf16_f32 v115, v115, v115
    v_lshlrev_b32 v115, 16, v115
    v_cvt_pk_bf16_f32 v119, v119, v119
    v_lshlrev_b32 v119, 16, v119
    v_mul_f32 v115, v115, v119
    v_cvt_pk_bf16_f32 v116, v116, v116
    v_lshlrev_b32 v116, 16, v116
    v_cvt_pk_bf16_f32 v120, v120, v120
    v_lshlrev_b32 v120, 16, v120
    v_mul_f32 v116, v116, v120
    v_cvt_pk_bf16_f32 v117, v117, v117
    v_lshlrev_b32 v117, 16, v117
    v_cvt_pk_bf16_f32 v121, v121, v121
    v_lshlrev_b32 v121, 16, v121
    v_mul_f32 v117, v117, v121
    v_cvt_pk_bf16_f32 v122, v114, v115
    v_cvt_pk_bf16_f32 v123, v116, v117
    v_add_u32 v113, 172032, v112
    buffer_store_dwordx2 v[122:123], v113, s[28:31], 0 offen offset:0
    s_nop 1
    v_accvgpr_read_b32 v114, a100
    v_accvgpr_read_b32 v118, a116
    v_accvgpr_read_b32 v115, a101
    v_accvgpr_read_b32 v119, a117
    v_accvgpr_read_b32 v116, a102
    v_accvgpr_read_b32 v120, a118
    v_accvgpr_read_b32 v117, a103
    v_accvgpr_read_b32 v121, a119
    v_cvt_pk_bf16_f32 v114, v114, v114
    v_lshlrev_b32 v114, 16, v114
    v_cvt_pk_bf16_f32 v118, v118, v118
    v_lshlrev_b32 v118, 16, v118
    v_mul_f32 v114, v114, v118
    v_cvt_pk_bf16_f32 v115, v115, v115
    v_lshlrev_b32 v115, 16, v115
    v_cvt_pk_bf16_f32 v119, v119, v119
    v_lshlrev_b32 v119, 16, v119
    v_mul_f32 v115, v115, v119
    v_cvt_pk_bf16_f32 v116, v116, v116
    v_lshlrev_b32 v116, 16, v116
    v_cvt_pk_bf16_f32 v120, v120, v120
    v_lshlrev_b32 v120, 16, v120
    v_mul_f32 v116, v116, v120
    v_cvt_pk_bf16_f32 v117, v117, v117
    v_lshlrev_b32 v117, 16, v117
    v_cvt_pk_bf16_f32 v121, v121, v121
    v_lshlrev_b32 v121, 16, v121
    v_mul_f32 v117, v117, v121
    v_cvt_pk_bf16_f32 v122, v114, v115
    v_cvt_pk_bf16_f32 v123, v116, v117
    v_add_u32 v113, 172032, v112
    buffer_store_dwordx2 v[122:123], v113, s[28:31], 0 offen offset:32
    s_nop 1
    v_accvgpr_read_b32 v114, a104
    v_accvgpr_read_b32 v118, a120
    v_accvgpr_read_b32 v115, a105
    v_accvgpr_read_b32 v119, a121
    v_accvgpr_read_b32 v116, a106
    v_accvgpr_read_b32 v120, a122
    v_accvgpr_read_b32 v117, a107
    v_accvgpr_read_b32 v121, a123
    v_cvt_pk_bf16_f32 v114, v114, v114
    v_lshlrev_b32 v114, 16, v114
    v_cvt_pk_bf16_f32 v118, v118, v118
    v_lshlrev_b32 v118, 16, v118
    v_mul_f32 v114, v114, v118
    v_cvt_pk_bf16_f32 v115, v115, v115
    v_lshlrev_b32 v115, 16, v115
    v_cvt_pk_bf16_f32 v119, v119, v119
    v_lshlrev_b32 v119, 16, v119
    v_mul_f32 v115, v115, v119
    v_cvt_pk_bf16_f32 v116, v116, v116
    v_lshlrev_b32 v116, 16, v116
    v_cvt_pk_bf16_f32 v120, v120, v120
    v_lshlrev_b32 v120, 16, v120
    v_mul_f32 v116, v116, v120
    v_cvt_pk_bf16_f32 v117, v117, v117
    v_lshlrev_b32 v117, 16, v117
    v_cvt_pk_bf16_f32 v121, v121, v121
    v_lshlrev_b32 v121, 16, v121
    v_mul_f32 v117, v117, v121
    v_cvt_pk_bf16_f32 v122, v114, v115
    v_cvt_pk_bf16_f32 v123, v116, v117
    v_add_u32 v113, 172032, v112
    buffer_store_dwordx2 v[122:123], v113, s[28:31], 0 offen offset:64
    s_nop 1
    v_accvgpr_read_b32 v114, a108
    v_accvgpr_read_b32 v118, a124
    v_accvgpr_read_b32 v115, a109
    v_accvgpr_read_b32 v119, a125
    v_accvgpr_read_b32 v116, a110
    v_accvgpr_read_b32 v120, a126
    v_accvgpr_read_b32 v117, a111
    v_accvgpr_read_b32 v121, a127
    v_cvt_pk_bf16_f32 v114, v114, v114
    v_lshlrev_b32 v114, 16, v114
    v_cvt_pk_bf16_f32 v118, v118, v118
    v_lshlrev_b32 v118, 16, v118
    v_mul_f32 v114, v114, v118
    v_cvt_pk_bf16_f32 v115, v115, v115
    v_lshlrev_b32 v115, 16, v115
    v_cvt_pk_bf16_f32 v119, v119, v119
    v_lshlrev_b32 v119, 16, v119
    v_mul_f32 v115, v115, v119
    v_cvt_pk_bf16_f32 v116, v116, v116
    v_lshlrev_b32 v116, 16, v116
    v_cvt_pk_bf16_f32 v120, v120, v120
    v_lshlrev_b32 v120, 16, v120
    v_mul_f32 v116, v116, v120
    v_cvt_pk_bf16_f32 v117, v117, v117
    v_lshlrev_b32 v117, 16, v117
    v_cvt_pk_bf16_f32 v121, v121, v121
    v_lshlrev_b32 v121, 16, v121
    v_mul_f32 v117, v117, v121
    v_cvt_pk_bf16_f32 v122, v114, v115
    v_cvt_pk_bf16_f32 v123, v116, v117
    v_add_u32 v113, 172032, v112
    buffer_store_dwordx2 v[122:123], v113, s[28:31], 0 offen offset:96
    s_nop 1
    s_endpgm
K1_SCAN:
    s_load_dwordx2 s[6:7], s[0:1], 8
    s_load_dwordx2 s[8:9], s[0:1], 16
    s_load_dwordx2 s[14:15], s[0:1], 56
    s_load_dwordx2 s[16:17], s[0:1], 120
    s_lshr_b32 s56, s2, 1
    s_and_b32 s57, s2, 1
    s_lshl_b32 s57, s57, 8
    v_add_u32 v1, s57, v0
    s_waitcnt lgkmcnt(0)

    s_add_u32 s36, s16, 0x800000
    s_addc_u32 s37, s17, 0
    s_and_b32 s37, s37, 0xffff
    s_mov_b32 s38, 0x800000
    s_mov_b32 s39, 0x20000
    s_add_u32 s40, s16, 0x1000000
    s_addc_u32 s41, s17, 0
    s_and_b32 s41, s41, 0xffff
    s_mov_b32 s42, 0x40000
    s_mov_b32 s43, 0x20000
    s_add_u32 s24, s16, 0x1100000
    s_addc_u32 s25, s17, 0
    s_and_b32 s25, s25, 0xffff
    s_mov_b32 s26, 0x400000
    s_mov_b32 s27, 0x20000
    s_mov_b32 s44, s6
    s_and_b32 s45, s7, 0xffff
    s_mov_b32 s46, 0x400
    s_mov_b32 s47, 0x20000
    s_mov_b32 s48, s8
    s_and_b32 s49, s9, 0xffff
    s_mov_b32 s50, 0x400
    s_mov_b32 s51, 0x20000
    s_mov_b32 s52, s14
    s_and_b32 s53, s15, 0xffff
    s_mov_b32 s54, 0x400
    s_mov_b32 s55, 0x20000
    v_lshlrev_b32 v2, 1, v1
    v_lshlrev_b32 v3, 2, v1
    buffer_load_ushort v4, v2, s[44:47], 0 offen
    buffer_load_ushort v5, v2, s[48:51], 0 offen
    buffer_load_ushort v6, v2, s[52:55], 0 offen

    s_mov_b32 s58, 0
    buffer_load_dword v64, v3, s[40:43], s58 offen
    buffer_load_dword v65, v3, s[40:43], s58 offen offset:2048
    s_mov_b32 s58, 4096
    buffer_load_dword v66, v3, s[40:43], s58 offen
    buffer_load_dword v67, v3, s[40:43], s58 offen offset:2048
    s_mov_b32 s58, 8192
    buffer_load_dword v68, v3, s[40:43], s58 offen
    buffer_load_dword v69, v3, s[40:43], s58 offen offset:2048
    s_mov_b32 s58, 12288
    buffer_load_dword v70, v3, s[40:43], s58 offen
    buffer_load_dword v71, v3, s[40:43], s58 offen offset:2048
    s_mov_b32 s58, 16384
    buffer_load_dword v72, v3, s[40:43], s58 offen
    buffer_load_dword v73, v3, s[40:43], s58 offen offset:2048
    s_mov_b32 s58, 20480
    buffer_load_dword v74, v3, s[40:43], s58 offen
    buffer_load_dword v75, v3, s[40:43], s58 offen offset:2048
    s_mov_b32 s58, 24576
    buffer_load_dword v76, v3, s[40:43], s58 offen
    buffer_load_dword v77, v3, s[40:43], s58 offen offset:2048
    s_mov_b32 s58, 28672
    buffer_load_dword v78, v3, s[40:43], s58 offen
    buffer_load_dword v79, v3, s[40:43], s58 offen offset:2048
    s_mov_b32 s58, 32768
    buffer_load_dword v80, v3, s[40:43], s58 offen
    buffer_load_dword v81, v3, s[40:43], s58 offen offset:2048
    s_mov_b32 s58, 36864
    buffer_load_dword v82, v3, s[40:43], s58 offen
    buffer_load_dword v83, v3, s[40:43], s58 offen offset:2048
    s_mov_b32 s58, 40960
    buffer_load_dword v84, v3, s[40:43], s58 offen
    buffer_load_dword v85, v3, s[40:43], s58 offen offset:2048
    s_mov_b32 s58, 45056
    buffer_load_dword v86, v3, s[40:43], s58 offen
    buffer_load_dword v87, v3, s[40:43], s58 offen offset:2048
    s_mov_b32 s58, 49152
    buffer_load_dword v88, v3, s[40:43], s58 offen
    buffer_load_dword v89, v3, s[40:43], s58 offen offset:2048
    s_mov_b32 s58, 53248
    buffer_load_dword v90, v3, s[40:43], s58 offen
    buffer_load_dword v91, v3, s[40:43], s58 offen offset:2048
    s_mov_b32 s58, 57344
    buffer_load_dword v92, v3, s[40:43], s58 offen
    buffer_load_dword v93, v3, s[40:43], s58 offen offset:2048
    s_mov_b32 s58, 61440
    buffer_load_dword v94, v3, s[40:43], s58 offen
    buffer_load_dword v95, v3, s[40:43], s58 offen offset:2048
    s_mov_b32 s58, 65536
    buffer_load_dword v96, v3, s[40:43], s58 offen
    buffer_load_dword v97, v3, s[40:43], s58 offen offset:2048
    s_mov_b32 s58, 69632
    buffer_load_dword v98, v3, s[40:43], s58 offen
    buffer_load_dword v99, v3, s[40:43], s58 offen offset:2048
    s_mov_b32 s58, 73728
    buffer_load_dword v100, v3, s[40:43], s58 offen
    buffer_load_dword v101, v3, s[40:43], s58 offen offset:2048
    s_mov_b32 s58, 77824
    buffer_load_dword v102, v3, s[40:43], s58 offen
    buffer_load_dword v103, v3, s[40:43], s58 offen offset:2048
    s_mov_b32 s58, 81920
    buffer_load_dword v104, v3, s[40:43], s58 offen
    buffer_load_dword v105, v3, s[40:43], s58 offen offset:2048
    s_mov_b32 s58, 86016
    buffer_load_dword v106, v3, s[40:43], s58 offen
    buffer_load_dword v107, v3, s[40:43], s58 offen offset:2048
    s_mov_b32 s58, 90112
    buffer_load_dword v108, v3, s[40:43], s58 offen
    buffer_load_dword v109, v3, s[40:43], s58 offen offset:2048
    s_mov_b32 s58, 94208
    buffer_load_dword v110, v3, s[40:43], s58 offen
    buffer_load_dword v111, v3, s[40:43], s58 offen offset:2048
    s_mov_b32 s58, 98304
    buffer_load_dword v112, v3, s[40:43], s58 offen
    buffer_load_dword v113, v3, s[40:43], s58 offen offset:2048
    s_mov_b32 s58, 102400
    buffer_load_dword v114, v3, s[40:43], s58 offen
    buffer_load_dword v115, v3, s[40:43], s58 offen offset:2048
    s_mov_b32 s58, 106496
    buffer_load_dword v116, v3, s[40:43], s58 offen
    buffer_load_dword v117, v3, s[40:43], s58 offen offset:2048
    s_mov_b32 s58, 110592
    buffer_load_dword v118, v3, s[40:43], s58 offen
    buffer_load_dword v119, v3, s[40:43], s58 offen offset:2048
    s_mov_b32 s58, 114688
    buffer_load_dword v120, v3, s[40:43], s58 offen
    buffer_load_dword v121, v3, s[40:43], s58 offen offset:2048
    s_mov_b32 s58, 118784
    buffer_load_dword v122, v3, s[40:43], s58 offen
    buffer_load_dword v123, v3, s[40:43], s58 offen offset:2048
    s_mov_b32 s58, 122880
    buffer_load_dword v124, v3, s[40:43], s58 offen
    buffer_load_dword v125, v3, s[40:43], s58 offen offset:2048
    s_mov_b32 s58, 126976
    buffer_load_dword v126, v3, s[40:43], s58 offen
    buffer_load_dword v127, v3, s[40:43], s58 offen offset:2048
    s_mov_b32 s58, 131072
    buffer_load_dword v128, v3, s[40:43], s58 offen
    buffer_load_dword v129, v3, s[40:43], s58 offen offset:2048
    s_mov_b32 s58, 135168
    buffer_load_dword v130, v3, s[40:43], s58 offen
    buffer_load_dword v131, v3, s[40:43], s58 offen offset:2048
    s_mov_b32 s58, 139264
    buffer_load_dword v132, v3, s[40:43], s58 offen
    buffer_load_dword v133, v3, s[40:43], s58 offen offset:2048
    s_mov_b32 s58, 143360
    buffer_load_dword v134, v3, s[40:43], s58 offen
    buffer_load_dword v135, v3, s[40:43], s58 offen offset:2048
    s_mov_b32 s58, 147456
    buffer_load_dword v136, v3, s[40:43], s58 offen
    buffer_load_dword v137, v3, s[40:43], s58 offen offset:2048
    s_mov_b32 s58, 151552
    buffer_load_dword v138, v3, s[40:43], s58 offen
    buffer_load_dword v139, v3, s[40:43], s58 offen offset:2048
    s_mov_b32 s58, 155648
    buffer_load_dword v140, v3, s[40:43], s58 offen
    buffer_load_dword v141, v3, s[40:43], s58 offen offset:2048
    s_mov_b32 s58, 159744
    buffer_load_dword v142, v3, s[40:43], s58 offen
    buffer_load_dword v143, v3, s[40:43], s58 offen offset:2048
    s_mov_b32 s58, 163840
    buffer_load_dword v144, v3, s[40:43], s58 offen
    buffer_load_dword v145, v3, s[40:43], s58 offen offset:2048
    s_mov_b32 s58, 167936
    buffer_load_dword v146, v3, s[40:43], s58 offen
    buffer_load_dword v147, v3, s[40:43], s58 offen offset:2048
    s_mov_b32 s58, 172032
    buffer_load_dword v148, v3, s[40:43], s58 offen
    buffer_load_dword v149, v3, s[40:43], s58 offen offset:2048
    s_mov_b32 s58, 176128
    buffer_load_dword v150, v3, s[40:43], s58 offen
    buffer_load_dword v151, v3, s[40:43], s58 offen offset:2048
    s_mov_b32 s58, 180224
    buffer_load_dword v152, v3, s[40:43], s58 offen
    buffer_load_dword v153, v3, s[40:43], s58 offen offset:2048
    s_mov_b32 s58, 184320
    buffer_load_dword v154, v3, s[40:43], s58 offen
    buffer_load_dword v155, v3, s[40:43], s58 offen offset:2048
    s_mov_b32 s58, 188416
    buffer_load_dword v156, v3, s[40:43], s58 offen
    buffer_load_dword v157, v3, s[40:43], s58 offen offset:2048
    s_mov_b32 s58, 192512
    buffer_load_dword v158, v3, s[40:43], s58 offen
    buffer_load_dword v159, v3, s[40:43], s58 offen offset:2048
    s_mov_b32 s58, 196608
    buffer_load_dword v160, v3, s[40:43], s58 offen
    buffer_load_dword v161, v3, s[40:43], s58 offen offset:2048
    s_mov_b32 s58, 200704
    buffer_load_dword v162, v3, s[40:43], s58 offen
    buffer_load_dword v163, v3, s[40:43], s58 offen offset:2048
    s_mov_b32 s58, 204800
    buffer_load_dword v164, v3, s[40:43], s58 offen
    buffer_load_dword v165, v3, s[40:43], s58 offen offset:2048
    s_mov_b32 s58, 208896
    buffer_load_dword v166, v3, s[40:43], s58 offen
    buffer_load_dword v167, v3, s[40:43], s58 offen offset:2048
    s_mov_b32 s58, 212992
    buffer_load_dword v168, v3, s[40:43], s58 offen
    buffer_load_dword v169, v3, s[40:43], s58 offen offset:2048
    s_mov_b32 s58, 217088
    buffer_load_dword v170, v3, s[40:43], s58 offen
    buffer_load_dword v171, v3, s[40:43], s58 offen offset:2048
    s_mov_b32 s58, 221184
    buffer_load_dword v172, v3, s[40:43], s58 offen
    buffer_load_dword v173, v3, s[40:43], s58 offen offset:2048
    s_mov_b32 s58, 225280
    buffer_load_dword v174, v3, s[40:43], s58 offen
    buffer_load_dword v175, v3, s[40:43], s58 offen offset:2048
    s_mov_b32 s58, 229376
    buffer_load_dword v176, v3, s[40:43], s58 offen
    buffer_load_dword v177, v3, s[40:43], s58 offen offset:2048
    s_mov_b32 s58, 233472
    buffer_load_dword v178, v3, s[40:43], s58 offen
    buffer_load_dword v179, v3, s[40:43], s58 offen offset:2048
    s_mov_b32 s58, 237568
    buffer_load_dword v180, v3, s[40:43], s58 offen
    buffer_load_dword v181, v3, s[40:43], s58 offen offset:2048
    s_mov_b32 s58, 241664
    buffer_load_dword v182, v3, s[40:43], s58 offen
    buffer_load_dword v183, v3, s[40:43], s58 offen offset:2048
    s_waitcnt vmcnt(60)
    s_waitcnt vmcnt(0)
    v_lshlrev_b32 v4, 16, v4
    v_lshlrev_b32 v5, 16, v5
    v_lshlrev_b32 v6, 16, v6
    v_mul_f32 v12, 0x3fb8aa3b, v6
    v_exp_f32 v12, v12
    s_nop 0
    v_cvt_pk_bf16_f32 v12, v12, v12
    v_lshlrev_b32 v12, 16, v12
    v_mul_f32 v13, v12, v4
    v_mul_f32 v14, v12, v5
    v_mul_f32 v13, 0x3fb8aa3b, v13
    v_exp_f32 v13, v13
    v_mul_f32 v14, 0x3e22f983, v14
    v_cos_f32 v15, v14
    v_sin_f32 v16, v14
    s_nop 0
    v_mul_f32 v8, v13, v15
    v_mul_f32 v9, v13, v16
    v_mul_f32 v12, v4, v4
    v_fma_f32 v12, v5, v5, v12
    v_rcp_f32 v12, v12
    v_add_f32 v13, -1.0, v8
    v_mul_f32 v14, v13, v4
    v_fma_f32 v14, v9, v5, v14
    v_mul_f32 v15, v9, v4
    v_fma_f32 v15, -v13, v5, v15
    v_mul_f32 v10, v14, v12
    v_mul_f32 v11, v15, v12
    v_mov_b32 v20, v8
    v_mov_b32 v21, v9
    v_mul_f32 v18, v21, v21
    v_fma_f32 v18, v20, v20, -v18
    v_mul_f32 v23, v21, v20
    v_fma_f32 v23, v20, v21, v23
    v_mov_b32 v22, v18
    v_mov_b32 v20, v22
    v_mov_b32 v21, v23
    v_mul_f32 v18, v21, v21
    v_fma_f32 v18, v20, v20, -v18
    v_mul_f32 v23, v21, v20
    v_fma_f32 v23, v20, v21, v23
    v_mov_b32 v22, v18
    v_mov_b32 v20, v22
    v_mov_b32 v21, v23
    v_mul_f32 v18, v21, v21
    v_fma_f32 v18, v20, v20, -v18
    v_mul_f32 v23, v21, v20
    v_fma_f32 v23, v20, v21, v23
    v_mov_b32 v22, v18
    v_mov_b32 v20, v22
    v_mov_b32 v21, v23
    v_mul_f32 v18, v21, v21
    v_fma_f32 v18, v20, v20, -v18
    v_mul_f32 v23, v21, v20
    v_fma_f32 v23, v20, v21, v23
    v_mov_b32 v22, v18
    v_mov_b32 v20, v22
    v_mov_b32 v21, v23
    v_mul_f32 v18, v21, v21
    v_fma_f32 v18, v20, v20, -v18
    v_mul_f32 v23, v21, v20
    v_fma_f32 v23, v20, v21, v23
    v_mov_b32 v22, v18
    v_mov_b32 v20, v22
    v_mov_b32 v21, v23
    v_mov_b32 v24, 0
    v_mov_b32 v25, 0
    s_lshl_b32 s58, s56, 2

    s_cmp_le_u32 s58, 0
    s_cbranch_scc1 K1_SCAN_MAIN
    v_mul_f32 v18, v25, v21
    v_fma_f32 v18, v24, v20, -v18
    v_mul_f32 v19, v25, v20
    v_fma_f32 v19, v24, v21, v19
    v_add_f32 v24, v18, v64
    v_add_f32 v25, v19, v65

    s_cmp_le_u32 s58, 1
    s_cbranch_scc1 K1_SCAN_MAIN
    v_mul_f32 v18, v25, v21
    v_fma_f32 v18, v24, v20, -v18
    v_mul_f32 v19, v25, v20
    v_fma_f32 v19, v24, v21, v19
    v_add_f32 v24, v18, v66
    v_add_f32 v25, v19, v67

    s_cmp_le_u32 s58, 2
    s_cbranch_scc1 K1_SCAN_MAIN
    v_mul_f32 v18, v25, v21
    v_fma_f32 v18, v24, v20, -v18
    v_mul_f32 v19, v25, v20
    v_fma_f32 v19, v24, v21, v19
    v_add_f32 v24, v18, v68
    v_add_f32 v25, v19, v69

    s_cmp_le_u32 s58, 3
    s_cbranch_scc1 K1_SCAN_MAIN
    v_mul_f32 v18, v25, v21
    v_fma_f32 v18, v24, v20, -v18
    v_mul_f32 v19, v25, v20
    v_fma_f32 v19, v24, v21, v19
    v_add_f32 v24, v18, v70
    v_add_f32 v25, v19, v71

    s_cmp_le_u32 s58, 4
    s_cbranch_scc1 K1_SCAN_MAIN
    v_mul_f32 v18, v25, v21
    v_fma_f32 v18, v24, v20, -v18
    v_mul_f32 v19, v25, v20
    v_fma_f32 v19, v24, v21, v19
    v_add_f32 v24, v18, v72
    v_add_f32 v25, v19, v73

    s_cmp_le_u32 s58, 5
    s_cbranch_scc1 K1_SCAN_MAIN
    v_mul_f32 v18, v25, v21
    v_fma_f32 v18, v24, v20, -v18
    v_mul_f32 v19, v25, v20
    v_fma_f32 v19, v24, v21, v19
    v_add_f32 v24, v18, v74
    v_add_f32 v25, v19, v75

    s_cmp_le_u32 s58, 6
    s_cbranch_scc1 K1_SCAN_MAIN
    v_mul_f32 v18, v25, v21
    v_fma_f32 v18, v24, v20, -v18
    v_mul_f32 v19, v25, v20
    v_fma_f32 v19, v24, v21, v19
    v_add_f32 v24, v18, v76
    v_add_f32 v25, v19, v77

    s_cmp_le_u32 s58, 7
    s_cbranch_scc1 K1_SCAN_MAIN
    v_mul_f32 v18, v25, v21
    v_fma_f32 v18, v24, v20, -v18
    v_mul_f32 v19, v25, v20
    v_fma_f32 v19, v24, v21, v19
    v_add_f32 v24, v18, v78
    v_add_f32 v25, v19, v79

    s_cmp_le_u32 s58, 8
    s_cbranch_scc1 K1_SCAN_MAIN
    v_mul_f32 v18, v25, v21
    v_fma_f32 v18, v24, v20, -v18
    v_mul_f32 v19, v25, v20
    v_fma_f32 v19, v24, v21, v19
    v_add_f32 v24, v18, v80
    v_add_f32 v25, v19, v81

    s_cmp_le_u32 s58, 9
    s_cbranch_scc1 K1_SCAN_MAIN
    v_mul_f32 v18, v25, v21
    v_fma_f32 v18, v24, v20, -v18
    v_mul_f32 v19, v25, v20
    v_fma_f32 v19, v24, v21, v19
    v_add_f32 v24, v18, v82
    v_add_f32 v25, v19, v83

    s_cmp_le_u32 s58, 10
    s_cbranch_scc1 K1_SCAN_MAIN
    v_mul_f32 v18, v25, v21
    v_fma_f32 v18, v24, v20, -v18
    v_mul_f32 v19, v25, v20
    v_fma_f32 v19, v24, v21, v19
    v_add_f32 v24, v18, v84
    v_add_f32 v25, v19, v85

    s_cmp_le_u32 s58, 11
    s_cbranch_scc1 K1_SCAN_MAIN
    v_mul_f32 v18, v25, v21
    v_fma_f32 v18, v24, v20, -v18
    v_mul_f32 v19, v25, v20
    v_fma_f32 v19, v24, v21, v19
    v_add_f32 v24, v18, v86
    v_add_f32 v25, v19, v87

    s_cmp_le_u32 s58, 12
    s_cbranch_scc1 K1_SCAN_MAIN
    v_mul_f32 v18, v25, v21
    v_fma_f32 v18, v24, v20, -v18
    v_mul_f32 v19, v25, v20
    v_fma_f32 v19, v24, v21, v19
    v_add_f32 v24, v18, v88
    v_add_f32 v25, v19, v89

    s_cmp_le_u32 s58, 13
    s_cbranch_scc1 K1_SCAN_MAIN
    v_mul_f32 v18, v25, v21
    v_fma_f32 v18, v24, v20, -v18
    v_mul_f32 v19, v25, v20
    v_fma_f32 v19, v24, v21, v19
    v_add_f32 v24, v18, v90
    v_add_f32 v25, v19, v91

    s_cmp_le_u32 s58, 14
    s_cbranch_scc1 K1_SCAN_MAIN
    v_mul_f32 v18, v25, v21
    v_fma_f32 v18, v24, v20, -v18
    v_mul_f32 v19, v25, v20
    v_fma_f32 v19, v24, v21, v19
    v_add_f32 v24, v18, v92
    v_add_f32 v25, v19, v93

    s_cmp_le_u32 s58, 15
    s_cbranch_scc1 K1_SCAN_MAIN
    v_mul_f32 v18, v25, v21
    v_fma_f32 v18, v24, v20, -v18
    v_mul_f32 v19, v25, v20
    v_fma_f32 v19, v24, v21, v19
    v_add_f32 v24, v18, v94
    v_add_f32 v25, v19, v95

    s_cmp_le_u32 s58, 16
    s_cbranch_scc1 K1_SCAN_MAIN
    v_mul_f32 v18, v25, v21
    v_fma_f32 v18, v24, v20, -v18
    v_mul_f32 v19, v25, v20
    v_fma_f32 v19, v24, v21, v19
    v_add_f32 v24, v18, v96
    v_add_f32 v25, v19, v97

    s_cmp_le_u32 s58, 17
    s_cbranch_scc1 K1_SCAN_MAIN
    v_mul_f32 v18, v25, v21
    v_fma_f32 v18, v24, v20, -v18
    v_mul_f32 v19, v25, v20
    v_fma_f32 v19, v24, v21, v19
    v_add_f32 v24, v18, v98
    v_add_f32 v25, v19, v99

    s_cmp_le_u32 s58, 18
    s_cbranch_scc1 K1_SCAN_MAIN
    v_mul_f32 v18, v25, v21
    v_fma_f32 v18, v24, v20, -v18
    v_mul_f32 v19, v25, v20
    v_fma_f32 v19, v24, v21, v19
    v_add_f32 v24, v18, v100
    v_add_f32 v25, v19, v101

    s_cmp_le_u32 s58, 19
    s_cbranch_scc1 K1_SCAN_MAIN
    v_mul_f32 v18, v25, v21
    v_fma_f32 v18, v24, v20, -v18
    v_mul_f32 v19, v25, v20
    v_fma_f32 v19, v24, v21, v19
    v_add_f32 v24, v18, v102
    v_add_f32 v25, v19, v103

    s_cmp_le_u32 s58, 20
    s_cbranch_scc1 K1_SCAN_MAIN
    v_mul_f32 v18, v25, v21
    v_fma_f32 v18, v24, v20, -v18
    v_mul_f32 v19, v25, v20
    v_fma_f32 v19, v24, v21, v19
    v_add_f32 v24, v18, v104
    v_add_f32 v25, v19, v105

    s_cmp_le_u32 s58, 21
    s_cbranch_scc1 K1_SCAN_MAIN
    v_mul_f32 v18, v25, v21
    v_fma_f32 v18, v24, v20, -v18
    v_mul_f32 v19, v25, v20
    v_fma_f32 v19, v24, v21, v19
    v_add_f32 v24, v18, v106
    v_add_f32 v25, v19, v107

    s_cmp_le_u32 s58, 22
    s_cbranch_scc1 K1_SCAN_MAIN
    v_mul_f32 v18, v25, v21
    v_fma_f32 v18, v24, v20, -v18
    v_mul_f32 v19, v25, v20
    v_fma_f32 v19, v24, v21, v19
    v_add_f32 v24, v18, v108
    v_add_f32 v25, v19, v109

    s_cmp_le_u32 s58, 23
    s_cbranch_scc1 K1_SCAN_MAIN
    v_mul_f32 v18, v25, v21
    v_fma_f32 v18, v24, v20, -v18
    v_mul_f32 v19, v25, v20
    v_fma_f32 v19, v24, v21, v19
    v_add_f32 v24, v18, v110
    v_add_f32 v25, v19, v111

    s_cmp_le_u32 s58, 24
    s_cbranch_scc1 K1_SCAN_MAIN
    v_mul_f32 v18, v25, v21
    v_fma_f32 v18, v24, v20, -v18
    v_mul_f32 v19, v25, v20
    v_fma_f32 v19, v24, v21, v19
    v_add_f32 v24, v18, v112
    v_add_f32 v25, v19, v113

    s_cmp_le_u32 s58, 25
    s_cbranch_scc1 K1_SCAN_MAIN
    v_mul_f32 v18, v25, v21
    v_fma_f32 v18, v24, v20, -v18
    v_mul_f32 v19, v25, v20
    v_fma_f32 v19, v24, v21, v19
    v_add_f32 v24, v18, v114
    v_add_f32 v25, v19, v115

    s_cmp_le_u32 s58, 26
    s_cbranch_scc1 K1_SCAN_MAIN
    v_mul_f32 v18, v25, v21
    v_fma_f32 v18, v24, v20, -v18
    v_mul_f32 v19, v25, v20
    v_fma_f32 v19, v24, v21, v19
    v_add_f32 v24, v18, v116
    v_add_f32 v25, v19, v117

    s_cmp_le_u32 s58, 27
    s_cbranch_scc1 K1_SCAN_MAIN
    v_mul_f32 v18, v25, v21
    v_fma_f32 v18, v24, v20, -v18
    v_mul_f32 v19, v25, v20
    v_fma_f32 v19, v24, v21, v19
    v_add_f32 v24, v18, v118
    v_add_f32 v25, v19, v119

    s_cmp_le_u32 s58, 28
    s_cbranch_scc1 K1_SCAN_MAIN
    v_mul_f32 v18, v25, v21
    v_fma_f32 v18, v24, v20, -v18
    v_mul_f32 v19, v25, v20
    v_fma_f32 v19, v24, v21, v19
    v_add_f32 v24, v18, v120
    v_add_f32 v25, v19, v121

    s_cmp_le_u32 s58, 29
    s_cbranch_scc1 K1_SCAN_MAIN
    v_mul_f32 v18, v25, v21
    v_fma_f32 v18, v24, v20, -v18
    v_mul_f32 v19, v25, v20
    v_fma_f32 v19, v24, v21, v19
    v_add_f32 v24, v18, v122
    v_add_f32 v25, v19, v123

    s_cmp_le_u32 s58, 30
    s_cbranch_scc1 K1_SCAN_MAIN
    v_mul_f32 v18, v25, v21
    v_fma_f32 v18, v24, v20, -v18
    v_mul_f32 v19, v25, v20
    v_fma_f32 v19, v24, v21, v19
    v_add_f32 v24, v18, v124
    v_add_f32 v25, v19, v125

    s_cmp_le_u32 s58, 31
    s_cbranch_scc1 K1_SCAN_MAIN
    v_mul_f32 v18, v25, v21
    v_fma_f32 v18, v24, v20, -v18
    v_mul_f32 v19, v25, v20
    v_fma_f32 v19, v24, v21, v19
    v_add_f32 v24, v18, v126
    v_add_f32 v25, v19, v127

    s_cmp_le_u32 s58, 32
    s_cbranch_scc1 K1_SCAN_MAIN
    v_mul_f32 v18, v25, v21
    v_fma_f32 v18, v24, v20, -v18
    v_mul_f32 v19, v25, v20
    v_fma_f32 v19, v24, v21, v19
    v_add_f32 v24, v18, v128
    v_add_f32 v25, v19, v129

    s_cmp_le_u32 s58, 33
    s_cbranch_scc1 K1_SCAN_MAIN
    v_mul_f32 v18, v25, v21
    v_fma_f32 v18, v24, v20, -v18
    v_mul_f32 v19, v25, v20
    v_fma_f32 v19, v24, v21, v19
    v_add_f32 v24, v18, v130
    v_add_f32 v25, v19, v131

    s_cmp_le_u32 s58, 34
    s_cbranch_scc1 K1_SCAN_MAIN
    v_mul_f32 v18, v25, v21
    v_fma_f32 v18, v24, v20, -v18
    v_mul_f32 v19, v25, v20
    v_fma_f32 v19, v24, v21, v19
    v_add_f32 v24, v18, v132
    v_add_f32 v25, v19, v133

    s_cmp_le_u32 s58, 35
    s_cbranch_scc1 K1_SCAN_MAIN
    v_mul_f32 v18, v25, v21
    v_fma_f32 v18, v24, v20, -v18
    v_mul_f32 v19, v25, v20
    v_fma_f32 v19, v24, v21, v19
    v_add_f32 v24, v18, v134
    v_add_f32 v25, v19, v135

    s_cmp_le_u32 s58, 36
    s_cbranch_scc1 K1_SCAN_MAIN
    v_mul_f32 v18, v25, v21
    v_fma_f32 v18, v24, v20, -v18
    v_mul_f32 v19, v25, v20
    v_fma_f32 v19, v24, v21, v19
    v_add_f32 v24, v18, v136
    v_add_f32 v25, v19, v137

    s_cmp_le_u32 s58, 37
    s_cbranch_scc1 K1_SCAN_MAIN
    v_mul_f32 v18, v25, v21
    v_fma_f32 v18, v24, v20, -v18
    v_mul_f32 v19, v25, v20
    v_fma_f32 v19, v24, v21, v19
    v_add_f32 v24, v18, v138
    v_add_f32 v25, v19, v139

    s_cmp_le_u32 s58, 38
    s_cbranch_scc1 K1_SCAN_MAIN
    v_mul_f32 v18, v25, v21
    v_fma_f32 v18, v24, v20, -v18
    v_mul_f32 v19, v25, v20
    v_fma_f32 v19, v24, v21, v19
    v_add_f32 v24, v18, v140
    v_add_f32 v25, v19, v141

    s_cmp_le_u32 s58, 39
    s_cbranch_scc1 K1_SCAN_MAIN
    v_mul_f32 v18, v25, v21
    v_fma_f32 v18, v24, v20, -v18
    v_mul_f32 v19, v25, v20
    v_fma_f32 v19, v24, v21, v19
    v_add_f32 v24, v18, v142
    v_add_f32 v25, v19, v143

    s_cmp_le_u32 s58, 40
    s_cbranch_scc1 K1_SCAN_MAIN
    v_mul_f32 v18, v25, v21
    v_fma_f32 v18, v24, v20, -v18
    v_mul_f32 v19, v25, v20
    v_fma_f32 v19, v24, v21, v19
    v_add_f32 v24, v18, v144
    v_add_f32 v25, v19, v145

    s_cmp_le_u32 s58, 41
    s_cbranch_scc1 K1_SCAN_MAIN
    v_mul_f32 v18, v25, v21
    v_fma_f32 v18, v24, v20, -v18
    v_mul_f32 v19, v25, v20
    v_fma_f32 v19, v24, v21, v19
    v_add_f32 v24, v18, v146
    v_add_f32 v25, v19, v147

    s_cmp_le_u32 s58, 42
    s_cbranch_scc1 K1_SCAN_MAIN
    v_mul_f32 v18, v25, v21
    v_fma_f32 v18, v24, v20, -v18
    v_mul_f32 v19, v25, v20
    v_fma_f32 v19, v24, v21, v19
    v_add_f32 v24, v18, v148
    v_add_f32 v25, v19, v149

    s_cmp_le_u32 s58, 43
    s_cbranch_scc1 K1_SCAN_MAIN
    v_mul_f32 v18, v25, v21
    v_fma_f32 v18, v24, v20, -v18
    v_mul_f32 v19, v25, v20
    v_fma_f32 v19, v24, v21, v19
    v_add_f32 v24, v18, v150
    v_add_f32 v25, v19, v151

    s_cmp_le_u32 s58, 44
    s_cbranch_scc1 K1_SCAN_MAIN
    v_mul_f32 v18, v25, v21
    v_fma_f32 v18, v24, v20, -v18
    v_mul_f32 v19, v25, v20
    v_fma_f32 v19, v24, v21, v19
    v_add_f32 v24, v18, v152
    v_add_f32 v25, v19, v153

    s_cmp_le_u32 s58, 45
    s_cbranch_scc1 K1_SCAN_MAIN
    v_mul_f32 v18, v25, v21
    v_fma_f32 v18, v24, v20, -v18
    v_mul_f32 v19, v25, v20
    v_fma_f32 v19, v24, v21, v19
    v_add_f32 v24, v18, v154
    v_add_f32 v25, v19, v155

    s_cmp_le_u32 s58, 46
    s_cbranch_scc1 K1_SCAN_MAIN
    v_mul_f32 v18, v25, v21
    v_fma_f32 v18, v24, v20, -v18
    v_mul_f32 v19, v25, v20
    v_fma_f32 v19, v24, v21, v19
    v_add_f32 v24, v18, v156
    v_add_f32 v25, v19, v157

    s_cmp_le_u32 s58, 47
    s_cbranch_scc1 K1_SCAN_MAIN
    v_mul_f32 v18, v25, v21
    v_fma_f32 v18, v24, v20, -v18
    v_mul_f32 v19, v25, v20
    v_fma_f32 v19, v24, v21, v19
    v_add_f32 v24, v18, v158
    v_add_f32 v25, v19, v159

    s_cmp_le_u32 s58, 48
    s_cbranch_scc1 K1_SCAN_MAIN
    v_mul_f32 v18, v25, v21
    v_fma_f32 v18, v24, v20, -v18
    v_mul_f32 v19, v25, v20
    v_fma_f32 v19, v24, v21, v19
    v_add_f32 v24, v18, v160
    v_add_f32 v25, v19, v161

    s_cmp_le_u32 s58, 49
    s_cbranch_scc1 K1_SCAN_MAIN
    v_mul_f32 v18, v25, v21
    v_fma_f32 v18, v24, v20, -v18
    v_mul_f32 v19, v25, v20
    v_fma_f32 v19, v24, v21, v19
    v_add_f32 v24, v18, v162
    v_add_f32 v25, v19, v163

    s_cmp_le_u32 s58, 50
    s_cbranch_scc1 K1_SCAN_MAIN
    v_mul_f32 v18, v25, v21
    v_fma_f32 v18, v24, v20, -v18
    v_mul_f32 v19, v25, v20
    v_fma_f32 v19, v24, v21, v19
    v_add_f32 v24, v18, v164
    v_add_f32 v25, v19, v165

    s_cmp_le_u32 s58, 51
    s_cbranch_scc1 K1_SCAN_MAIN
    v_mul_f32 v18, v25, v21
    v_fma_f32 v18, v24, v20, -v18
    v_mul_f32 v19, v25, v20
    v_fma_f32 v19, v24, v21, v19
    v_add_f32 v24, v18, v166
    v_add_f32 v25, v19, v167

    s_cmp_le_u32 s58, 52
    s_cbranch_scc1 K1_SCAN_MAIN
    v_mul_f32 v18, v25, v21
    v_fma_f32 v18, v24, v20, -v18
    v_mul_f32 v19, v25, v20
    v_fma_f32 v19, v24, v21, v19
    v_add_f32 v24, v18, v168
    v_add_f32 v25, v19, v169

    s_cmp_le_u32 s58, 53
    s_cbranch_scc1 K1_SCAN_MAIN
    v_mul_f32 v18, v25, v21
    v_fma_f32 v18, v24, v20, -v18
    v_mul_f32 v19, v25, v20
    v_fma_f32 v19, v24, v21, v19
    v_add_f32 v24, v18, v170
    v_add_f32 v25, v19, v171

    s_cmp_le_u32 s58, 54
    s_cbranch_scc1 K1_SCAN_MAIN
    v_mul_f32 v18, v25, v21
    v_fma_f32 v18, v24, v20, -v18
    v_mul_f32 v19, v25, v20
    v_fma_f32 v19, v24, v21, v19
    v_add_f32 v24, v18, v172
    v_add_f32 v25, v19, v173

    s_cmp_le_u32 s58, 55
    s_cbranch_scc1 K1_SCAN_MAIN
    v_mul_f32 v18, v25, v21
    v_fma_f32 v18, v24, v20, -v18
    v_mul_f32 v19, v25, v20
    v_fma_f32 v19, v24, v21, v19
    v_add_f32 v24, v18, v174
    v_add_f32 v25, v19, v175

    s_cmp_le_u32 s58, 56
    s_cbranch_scc1 K1_SCAN_MAIN
    v_mul_f32 v18, v25, v21
    v_fma_f32 v18, v24, v20, -v18
    v_mul_f32 v19, v25, v20
    v_fma_f32 v19, v24, v21, v19
    v_add_f32 v24, v18, v176
    v_add_f32 v25, v19, v177

    s_cmp_le_u32 s58, 57
    s_cbranch_scc1 K1_SCAN_MAIN
    v_mul_f32 v18, v25, v21
    v_fma_f32 v18, v24, v20, -v18
    v_mul_f32 v19, v25, v20
    v_fma_f32 v19, v24, v21, v19
    v_add_f32 v24, v18, v178
    v_add_f32 v25, v19, v179

    s_cmp_le_u32 s58, 58
    s_cbranch_scc1 K1_SCAN_MAIN
    v_mul_f32 v18, v25, v21
    v_fma_f32 v18, v24, v20, -v18
    v_mul_f32 v19, v25, v20
    v_fma_f32 v19, v24, v21, v19
    v_add_f32 v24, v18, v180
    v_add_f32 v25, v19, v181

    s_cmp_le_u32 s58, 59
    s_cbranch_scc1 K1_SCAN_MAIN
    v_mul_f32 v18, v25, v21
    v_fma_f32 v18, v24, v20, -v18
    v_mul_f32 v19, v25, v20
    v_fma_f32 v19, v24, v21, v19
    v_add_f32 v24, v18, v182
    v_add_f32 v25, v19, v183

K1_SCAN_MAIN:
    s_lshl_b32 s59, s56, 19
    s_lshl_b32 s60, s56, 18

    buffer_load_dword v32, v3, s[36:39], s59 offen
    buffer_load_dword v33, v3, s[36:39], s59 offen offset:2048
    s_add_u32 s59, s59, 4096
    buffer_load_dword v34, v3, s[36:39], s59 offen
    buffer_load_dword v35, v3, s[36:39], s59 offen offset:2048
    s_add_u32 s59, s59, 4096
    buffer_load_dword v36, v3, s[36:39], s59 offen
    buffer_load_dword v37, v3, s[36:39], s59 offen offset:2048
    s_add_u32 s59, s59, 4096
    buffer_load_dword v38, v3, s[36:39], s59 offen
    buffer_load_dword v39, v3, s[36:39], s59 offen offset:2048
    s_add_u32 s59, s59, 4096
    buffer_load_dword v40, v3, s[36:39], s59 offen
    buffer_load_dword v41, v3, s[36:39], s59 offen offset:2048
    s_add_u32 s59, s59, 4096
    buffer_load_dword v42, v3, s[36:39], s59 offen
    buffer_load_dword v43, v3, s[36:39], s59 offen offset:2048
    s_add_u32 s59, s59, 4096
    buffer_load_dword v44, v3, s[36:39], s59 offen
    buffer_load_dword v45, v3, s[36:39], s59 offen offset:2048
    s_add_u32 s59, s59, 4096
    buffer_load_dword v46, v3, s[36:39], s59 offen
    buffer_load_dword v47, v3, s[36:39], s59 offen offset:2048
    s_add_u32 s59, s59, 4096
    buffer_load_dword v48, v3, s[36:39], s59 offen
    buffer_load_dword v49, v3, s[36:39], s59 offen offset:2048
    s_add_u32 s59, s59, 4096
    buffer_load_dword v50, v3, s[36:39], s59 offen
    buffer_load_dword v51, v3, s[36:39], s59 offen offset:2048
    s_add_u32 s59, s59, 4096
    buffer_load_dword v52, v3, s[36:39], s59 offen
    buffer_load_dword v53, v3, s[36:39], s59 offen offset:2048
    s_add_u32 s59, s59, 4096
    buffer_load_dword v54, v3, s[36:39], s59 offen
    buffer_load_dword v55, v3, s[36:39], s59 offen offset:2048
    s_add_u32 s59, s59, 4096
    buffer_load_dword v56, v3, s[36:39], s59 offen
    buffer_load_dword v57, v3, s[36:39], s59 offen offset:2048
    s_add_u32 s59, s59, 4096
    buffer_load_dword v58, v3, s[36:39], s59 offen
    buffer_load_dword v59, v3, s[36:39], s59 offen offset:2048
    s_add_u32 s59, s59, 4096
    buffer_load_dword v60, v3, s[36:39], s59 offen
    buffer_load_dword v61, v3, s[36:39], s59 offen offset:2048
    s_add_u32 s59, s59, 4096
    buffer_load_dword v62, v3, s[36:39], s59 offen
    buffer_load_dword v63, v3, s[36:39], s59 offen offset:2048
    s_add_u32 s59, s59, 4096
    buffer_load_dword v64, v3, s[36:39], s59 offen
    buffer_load_dword v65, v3, s[36:39], s59 offen offset:2048
    s_add_u32 s59, s59, 4096
    buffer_load_dword v66, v3, s[36:39], s59 offen
    buffer_load_dword v67, v3, s[36:39], s59 offen offset:2048
    s_add_u32 s59, s59, 4096
    buffer_load_dword v68, v3, s[36:39], s59 offen
    buffer_load_dword v69, v3, s[36:39], s59 offen offset:2048
    s_add_u32 s59, s59, 4096
    buffer_load_dword v70, v3, s[36:39], s59 offen
    buffer_load_dword v71, v3, s[36:39], s59 offen offset:2048
    s_add_u32 s59, s59, 4096
    buffer_load_dword v72, v3, s[36:39], s59 offen
    buffer_load_dword v73, v3, s[36:39], s59 offen offset:2048
    s_add_u32 s59, s59, 4096
    buffer_load_dword v74, v3, s[36:39], s59 offen
    buffer_load_dword v75, v3, s[36:39], s59 offen offset:2048
    s_add_u32 s59, s59, 4096
    buffer_load_dword v76, v3, s[36:39], s59 offen
    buffer_load_dword v77, v3, s[36:39], s59 offen offset:2048
    s_add_u32 s59, s59, 4096
    buffer_load_dword v78, v3, s[36:39], s59 offen
    buffer_load_dword v79, v3, s[36:39], s59 offen offset:2048
    s_add_u32 s59, s59, 4096
    s_waitcnt vmcnt(32)
    v_mul_f32 v18, v25, v9
    v_fma_f32 v18, v24, v8, -v18
    v_mul_f32 v19, v25, v8
    v_fma_f32 v19, v24, v9, v19
    v_add_f32 v24, v18, v32
    v_add_f32 v25, v19, v33
    v_cvt_pk_bf16_f32 v26, v24, v24
    v_cvt_pk_bf16_f32 v27, -v25, -v25
    buffer_store_short v26, v2, s[24:27], s60 offen
    buffer_store_short v27, v2, s[24:27], s60 offen offset:1024
    s_add_u32 s60, s60, 2048

    v_mul_f32 v18, v25, v9
    v_fma_f32 v18, v24, v8, -v18
    v_mul_f32 v19, v25, v8
    v_fma_f32 v19, v24, v9, v19
    v_add_f32 v24, v18, v34
    v_add_f32 v25, v19, v35
    v_cvt_pk_bf16_f32 v26, v24, v24
    v_cvt_pk_bf16_f32 v27, -v25, -v25
    buffer_store_short v26, v2, s[24:27], s60 offen
    buffer_store_short v27, v2, s[24:27], s60 offen offset:1024
    s_add_u32 s60, s60, 2048

    v_mul_f32 v18, v25, v9
    v_fma_f32 v18, v24, v8, -v18
    v_mul_f32 v19, v25, v8
    v_fma_f32 v19, v24, v9, v19
    v_add_f32 v24, v18, v36
    v_add_f32 v25, v19, v37
    v_cvt_pk_bf16_f32 v26, v24, v24
    v_cvt_pk_bf16_f32 v27, -v25, -v25
    buffer_store_short v26, v2, s[24:27], s60 offen
    buffer_store_short v27, v2, s[24:27], s60 offen offset:1024
    s_add_u32 s60, s60, 2048

    v_mul_f32 v18, v25, v9
    v_fma_f32 v18, v24, v8, -v18
    v_mul_f32 v19, v25, v8
    v_fma_f32 v19, v24, v9, v19
    v_add_f32 v24, v18, v38
    v_add_f32 v25, v19, v39
    v_cvt_pk_bf16_f32 v26, v24, v24
    v_cvt_pk_bf16_f32 v27, -v25, -v25
    buffer_store_short v26, v2, s[24:27], s60 offen
    buffer_store_short v27, v2, s[24:27], s60 offen offset:1024
    s_add_u32 s60, s60, 2048

    v_mul_f32 v18, v25, v9
    v_fma_f32 v18, v24, v8, -v18
    v_mul_f32 v19, v25, v8
    v_fma_f32 v19, v24, v9, v19
    v_add_f32 v24, v18, v40
    v_add_f32 v25, v19, v41
    v_cvt_pk_bf16_f32 v26, v24, v24
    v_cvt_pk_bf16_f32 v27, -v25, -v25
    buffer_store_short v26, v2, s[24:27], s60 offen
    buffer_store_short v27, v2, s[24:27], s60 offen offset:1024
    s_add_u32 s60, s60, 2048

    v_mul_f32 v18, v25, v9
    v_fma_f32 v18, v24, v8, -v18
    v_mul_f32 v19, v25, v8
    v_fma_f32 v19, v24, v9, v19
    v_add_f32 v24, v18, v42
    v_add_f32 v25, v19, v43
    v_cvt_pk_bf16_f32 v26, v24, v24
    v_cvt_pk_bf16_f32 v27, -v25, -v25
    buffer_store_short v26, v2, s[24:27], s60 offen
    buffer_store_short v27, v2, s[24:27], s60 offen offset:1024
    s_add_u32 s60, s60, 2048

    v_mul_f32 v18, v25, v9
    v_fma_f32 v18, v24, v8, -v18
    v_mul_f32 v19, v25, v8
    v_fma_f32 v19, v24, v9, v19
    v_add_f32 v24, v18, v44
    v_add_f32 v25, v19, v45
    v_cvt_pk_bf16_f32 v26, v24, v24
    v_cvt_pk_bf16_f32 v27, -v25, -v25
    buffer_store_short v26, v2, s[24:27], s60 offen
    buffer_store_short v27, v2, s[24:27], s60 offen offset:1024
    s_add_u32 s60, s60, 2048

    v_mul_f32 v18, v25, v9
    v_fma_f32 v18, v24, v8, -v18
    v_mul_f32 v19, v25, v8
    v_fma_f32 v19, v24, v9, v19
    v_add_f32 v24, v18, v46
    v_add_f32 v25, v19, v47
    v_cvt_pk_bf16_f32 v26, v24, v24
    v_cvt_pk_bf16_f32 v27, -v25, -v25
    buffer_store_short v26, v2, s[24:27], s60 offen
    buffer_store_short v27, v2, s[24:27], s60 offen offset:1024
    s_add_u32 s60, s60, 2048

    buffer_load_dword v32, v3, s[36:39], s59 offen
    buffer_load_dword v33, v3, s[36:39], s59 offen offset:2048
    s_add_u32 s59, s59, 4096
    buffer_load_dword v34, v3, s[36:39], s59 offen
    buffer_load_dword v35, v3, s[36:39], s59 offen offset:2048
    s_add_u32 s59, s59, 4096
    buffer_load_dword v36, v3, s[36:39], s59 offen
    buffer_load_dword v37, v3, s[36:39], s59 offen offset:2048
    s_add_u32 s59, s59, 4096
    buffer_load_dword v38, v3, s[36:39], s59 offen
    buffer_load_dword v39, v3, s[36:39], s59 offen offset:2048
    s_add_u32 s59, s59, 4096
    buffer_load_dword v40, v3, s[36:39], s59 offen
    buffer_load_dword v41, v3, s[36:39], s59 offen offset:2048
    s_add_u32 s59, s59, 4096
    buffer_load_dword v42, v3, s[36:39], s59 offen
    buffer_load_dword v43, v3, s[36:39], s59 offen offset:2048
    s_add_u32 s59, s59, 4096
    buffer_load_dword v44, v3, s[36:39], s59 offen
    buffer_load_dword v45, v3, s[36:39], s59 offen offset:2048
    s_add_u32 s59, s59, 4096
    buffer_load_dword v46, v3, s[36:39], s59 offen
    buffer_load_dword v47, v3, s[36:39], s59 offen offset:2048
    s_add_u32 s59, s59, 4096
    s_waitcnt vmcnt(48)
    v_mul_f32 v18, v25, v9
    v_fma_f32 v18, v24, v8, -v18
    v_mul_f32 v19, v25, v8
    v_fma_f32 v19, v24, v9, v19
    v_add_f32 v24, v18, v48
    v_add_f32 v25, v19, v49
    v_cvt_pk_bf16_f32 v26, v24, v24
    v_cvt_pk_bf16_f32 v27, -v25, -v25
    buffer_store_short v26, v2, s[24:27], s60 offen
    buffer_store_short v27, v2, s[24:27], s60 offen offset:1024
    s_add_u32 s60, s60, 2048

    v_mul_f32 v18, v25, v9
    v_fma_f32 v18, v24, v8, -v18
    v_mul_f32 v19, v25, v8
    v_fma_f32 v19, v24, v9, v19
    v_add_f32 v24, v18, v50
    v_add_f32 v25, v19, v51
    v_cvt_pk_bf16_f32 v26, v24, v24
    v_cvt_pk_bf16_f32 v27, -v25, -v25
    buffer_store_short v26, v2, s[24:27], s60 offen
    buffer_store_short v27, v2, s[24:27], s60 offen offset:1024
    s_add_u32 s60, s60, 2048

    v_mul_f32 v18, v25, v9
    v_fma_f32 v18, v24, v8, -v18
    v_mul_f32 v19, v25, v8
    v_fma_f32 v19, v24, v9, v19
    v_add_f32 v24, v18, v52
    v_add_f32 v25, v19, v53
    v_cvt_pk_bf16_f32 v26, v24, v24
    v_cvt_pk_bf16_f32 v27, -v25, -v25
    buffer_store_short v26, v2, s[24:27], s60 offen
    buffer_store_short v27, v2, s[24:27], s60 offen offset:1024
    s_add_u32 s60, s60, 2048

    v_mul_f32 v18, v25, v9
    v_fma_f32 v18, v24, v8, -v18
    v_mul_f32 v19, v25, v8
    v_fma_f32 v19, v24, v9, v19
    v_add_f32 v24, v18, v54
    v_add_f32 v25, v19, v55
    v_cvt_pk_bf16_f32 v26, v24, v24
    v_cvt_pk_bf16_f32 v27, -v25, -v25
    buffer_store_short v26, v2, s[24:27], s60 offen
    buffer_store_short v27, v2, s[24:27], s60 offen offset:1024
    s_add_u32 s60, s60, 2048

    v_mul_f32 v18, v25, v9
    v_fma_f32 v18, v24, v8, -v18
    v_mul_f32 v19, v25, v8
    v_fma_f32 v19, v24, v9, v19
    v_add_f32 v24, v18, v56
    v_add_f32 v25, v19, v57
    v_cvt_pk_bf16_f32 v26, v24, v24
    v_cvt_pk_bf16_f32 v27, -v25, -v25
    buffer_store_short v26, v2, s[24:27], s60 offen
    buffer_store_short v27, v2, s[24:27], s60 offen offset:1024
    s_add_u32 s60, s60, 2048

    v_mul_f32 v18, v25, v9
    v_fma_f32 v18, v24, v8, -v18
    v_mul_f32 v19, v25, v8
    v_fma_f32 v19, v24, v9, v19
    v_add_f32 v24, v18, v58
    v_add_f32 v25, v19, v59
    v_cvt_pk_bf16_f32 v26, v24, v24
    v_cvt_pk_bf16_f32 v27, -v25, -v25
    buffer_store_short v26, v2, s[24:27], s60 offen
    buffer_store_short v27, v2, s[24:27], s60 offen offset:1024
    s_add_u32 s60, s60, 2048

    v_mul_f32 v18, v25, v9
    v_fma_f32 v18, v24, v8, -v18
    v_mul_f32 v19, v25, v8
    v_fma_f32 v19, v24, v9, v19
    v_add_f32 v24, v18, v60
    v_add_f32 v25, v19, v61
    v_cvt_pk_bf16_f32 v26, v24, v24
    v_cvt_pk_bf16_f32 v27, -v25, -v25
    buffer_store_short v26, v2, s[24:27], s60 offen
    buffer_store_short v27, v2, s[24:27], s60 offen offset:1024
    s_add_u32 s60, s60, 2048

    v_mul_f32 v18, v25, v9
    v_fma_f32 v18, v24, v8, -v18
    v_mul_f32 v19, v25, v8
    v_fma_f32 v19, v24, v9, v19
    v_add_f32 v24, v18, v62
    v_add_f32 v25, v19, v63
    v_cvt_pk_bf16_f32 v26, v24, v24
    v_cvt_pk_bf16_f32 v27, -v25, -v25
    buffer_store_short v26, v2, s[24:27], s60 offen
    buffer_store_short v27, v2, s[24:27], s60 offen offset:1024
    s_add_u32 s60, s60, 2048

    buffer_load_dword v48, v3, s[36:39], s59 offen
    buffer_load_dword v49, v3, s[36:39], s59 offen offset:2048
    s_add_u32 s59, s59, 4096
    buffer_load_dword v50, v3, s[36:39], s59 offen
    buffer_load_dword v51, v3, s[36:39], s59 offen offset:2048
    s_add_u32 s59, s59, 4096
    buffer_load_dword v52, v3, s[36:39], s59 offen
    buffer_load_dword v53, v3, s[36:39], s59 offen offset:2048
    s_add_u32 s59, s59, 4096
    buffer_load_dword v54, v3, s[36:39], s59 offen
    buffer_load_dword v55, v3, s[36:39], s59 offen offset:2048
    s_add_u32 s59, s59, 4096
    buffer_load_dword v56, v3, s[36:39], s59 offen
    buffer_load_dword v57, v3, s[36:39], s59 offen offset:2048
    s_add_u32 s59, s59, 4096
    buffer_load_dword v58, v3, s[36:39], s59 offen
    buffer_load_dword v59, v3, s[36:39], s59 offen offset:2048
    s_add_u32 s59, s59, 4096
    buffer_load_dword v60, v3, s[36:39], s59 offen
    buffer_load_dword v61, v3, s[36:39], s59 offen offset:2048
    s_add_u32 s59, s59, 4096
    buffer_load_dword v62, v3, s[36:39], s59 offen
    buffer_load_dword v63, v3, s[36:39], s59 offen offset:2048
    s_add_u32 s59, s59, 4096
    s_waitcnt vmcnt(48)
    v_mul_f32 v18, v25, v9
    v_fma_f32 v18, v24, v8, -v18
    v_mul_f32 v19, v25, v8
    v_fma_f32 v19, v24, v9, v19
    v_add_f32 v24, v18, v64
    v_add_f32 v25, v19, v65
    v_cvt_pk_bf16_f32 v26, v24, v24
    v_cvt_pk_bf16_f32 v27, -v25, -v25
    buffer_store_short v26, v2, s[24:27], s60 offen
    buffer_store_short v27, v2, s[24:27], s60 offen offset:1024
    s_add_u32 s60, s60, 2048

    v_mul_f32 v18, v25, v9
    v_fma_f32 v18, v24, v8, -v18
    v_mul_f32 v19, v25, v8
    v_fma_f32 v19, v24, v9, v19
    v_add_f32 v24, v18, v66
    v_add_f32 v25, v19, v67
    v_cvt_pk_bf16_f32 v26, v24, v24
    v_cvt_pk_bf16_f32 v27, -v25, -v25
    buffer_store_short v26, v2, s[24:27], s60 offen
    buffer_store_short v27, v2, s[24:27], s60 offen offset:1024
    s_add_u32 s60, s60, 2048

    v_mul_f32 v18, v25, v9
    v_fma_f32 v18, v24, v8, -v18
    v_mul_f32 v19, v25, v8
    v_fma_f32 v19, v24, v9, v19
    v_add_f32 v24, v18, v68
    v_add_f32 v25, v19, v69
    v_cvt_pk_bf16_f32 v26, v24, v24
    v_cvt_pk_bf16_f32 v27, -v25, -v25
    buffer_store_short v26, v2, s[24:27], s60 offen
    buffer_store_short v27, v2, s[24:27], s60 offen offset:1024
    s_add_u32 s60, s60, 2048

    v_mul_f32 v18, v25, v9
    v_fma_f32 v18, v24, v8, -v18
    v_mul_f32 v19, v25, v8
    v_fma_f32 v19, v24, v9, v19
    v_add_f32 v24, v18, v70
    v_add_f32 v25, v19, v71
    v_cvt_pk_bf16_f32 v26, v24, v24
    v_cvt_pk_bf16_f32 v27, -v25, -v25
    buffer_store_short v26, v2, s[24:27], s60 offen
    buffer_store_short v27, v2, s[24:27], s60 offen offset:1024
    s_add_u32 s60, s60, 2048

    v_mul_f32 v18, v25, v9
    v_fma_f32 v18, v24, v8, -v18
    v_mul_f32 v19, v25, v8
    v_fma_f32 v19, v24, v9, v19
    v_add_f32 v24, v18, v72
    v_add_f32 v25, v19, v73
    v_cvt_pk_bf16_f32 v26, v24, v24
    v_cvt_pk_bf16_f32 v27, -v25, -v25
    buffer_store_short v26, v2, s[24:27], s60 offen
    buffer_store_short v27, v2, s[24:27], s60 offen offset:1024
    s_add_u32 s60, s60, 2048

    v_mul_f32 v18, v25, v9
    v_fma_f32 v18, v24, v8, -v18
    v_mul_f32 v19, v25, v8
    v_fma_f32 v19, v24, v9, v19
    v_add_f32 v24, v18, v74
    v_add_f32 v25, v19, v75
    v_cvt_pk_bf16_f32 v26, v24, v24
    v_cvt_pk_bf16_f32 v27, -v25, -v25
    buffer_store_short v26, v2, s[24:27], s60 offen
    buffer_store_short v27, v2, s[24:27], s60 offen offset:1024
    s_add_u32 s60, s60, 2048

    v_mul_f32 v18, v25, v9
    v_fma_f32 v18, v24, v8, -v18
    v_mul_f32 v19, v25, v8
    v_fma_f32 v19, v24, v9, v19
    v_add_f32 v24, v18, v76
    v_add_f32 v25, v19, v77
    v_cvt_pk_bf16_f32 v26, v24, v24
    v_cvt_pk_bf16_f32 v27, -v25, -v25
    buffer_store_short v26, v2, s[24:27], s60 offen
    buffer_store_short v27, v2, s[24:27], s60 offen offset:1024
    s_add_u32 s60, s60, 2048

    v_mul_f32 v18, v25, v9
    v_fma_f32 v18, v24, v8, -v18
    v_mul_f32 v19, v25, v8
    v_fma_f32 v19, v24, v9, v19
    v_add_f32 v24, v18, v78
    v_add_f32 v25, v19, v79
    v_cvt_pk_bf16_f32 v26, v24, v24
    v_cvt_pk_bf16_f32 v27, -v25, -v25
    buffer_store_short v26, v2, s[24:27], s60 offen
    buffer_store_short v27, v2, s[24:27], s60 offen offset:1024
    s_add_u32 s60, s60, 2048

    buffer_load_dword v64, v3, s[36:39], s59 offen
    buffer_load_dword v65, v3, s[36:39], s59 offen offset:2048
    s_add_u32 s59, s59, 4096
    buffer_load_dword v66, v3, s[36:39], s59 offen
    buffer_load_dword v67, v3, s[36:39], s59 offen offset:2048
    s_add_u32 s59, s59, 4096
    buffer_load_dword v68, v3, s[36:39], s59 offen
    buffer_load_dword v69, v3, s[36:39], s59 offen offset:2048
    s_add_u32 s59, s59, 4096
    buffer_load_dword v70, v3, s[36:39], s59 offen
    buffer_load_dword v71, v3, s[36:39], s59 offen offset:2048
    s_add_u32 s59, s59, 4096
    buffer_load_dword v72, v3, s[36:39], s59 offen
    buffer_load_dword v73, v3, s[36:39], s59 offen offset:2048
    s_add_u32 s59, s59, 4096
    buffer_load_dword v74, v3, s[36:39], s59 offen
    buffer_load_dword v75, v3, s[36:39], s59 offen offset:2048
    s_add_u32 s59, s59, 4096
    buffer_load_dword v76, v3, s[36:39], s59 offen
    buffer_load_dword v77, v3, s[36:39], s59 offen offset:2048
    s_add_u32 s59, s59, 4096
    buffer_load_dword v78, v3, s[36:39], s59 offen
    buffer_load_dword v79, v3, s[36:39], s59 offen offset:2048
    s_add_u32 s59, s59, 4096
    s_waitcnt vmcnt(48)
    v_mul_f32 v18, v25, v9
    v_fma_f32 v18, v24, v8, -v18
    v_mul_f32 v19, v25, v8
    v_fma_f32 v19, v24, v9, v19
    v_add_f32 v24, v18, v32
    v_add_f32 v25, v19, v33
    v_cvt_pk_bf16_f32 v26, v24, v24
    v_cvt_pk_bf16_f32 v27, -v25, -v25
    buffer_store_short v26, v2, s[24:27], s60 offen
    buffer_store_short v27, v2, s[24:27], s60 offen offset:1024
    s_add_u32 s60, s60, 2048

    v_mul_f32 v18, v25, v9
    v_fma_f32 v18, v24, v8, -v18
    v_mul_f32 v19, v25, v8
    v_fma_f32 v19, v24, v9, v19
    v_add_f32 v24, v18, v34
    v_add_f32 v25, v19, v35
    v_cvt_pk_bf16_f32 v26, v24, v24
    v_cvt_pk_bf16_f32 v27, -v25, -v25
    buffer_store_short v26, v2, s[24:27], s60 offen
    buffer_store_short v27, v2, s[24:27], s60 offen offset:1024
    s_add_u32 s60, s60, 2048

    v_mul_f32 v18, v25, v9
    v_fma_f32 v18, v24, v8, -v18
    v_mul_f32 v19, v25, v8
    v_fma_f32 v19, v24, v9, v19
    v_add_f32 v24, v18, v36
    v_add_f32 v25, v19, v37
    v_cvt_pk_bf16_f32 v26, v24, v24
    v_cvt_pk_bf16_f32 v27, -v25, -v25
    buffer_store_short v26, v2, s[24:27], s60 offen
    buffer_store_short v27, v2, s[24:27], s60 offen offset:1024
    s_add_u32 s60, s60, 2048

    v_mul_f32 v18, v25, v9
    v_fma_f32 v18, v24, v8, -v18
    v_mul_f32 v19, v25, v8
    v_fma_f32 v19, v24, v9, v19
    v_add_f32 v24, v18, v38
    v_add_f32 v25, v19, v39
    v_cvt_pk_bf16_f32 v26, v24, v24
    v_cvt_pk_bf16_f32 v27, -v25, -v25
    buffer_store_short v26, v2, s[24:27], s60 offen
    buffer_store_short v27, v2, s[24:27], s60 offen offset:1024
    s_add_u32 s60, s60, 2048

    v_mul_f32 v18, v25, v9
    v_fma_f32 v18, v24, v8, -v18
    v_mul_f32 v19, v25, v8
    v_fma_f32 v19, v24, v9, v19
    v_add_f32 v24, v18, v40
    v_add_f32 v25, v19, v41
    v_cvt_pk_bf16_f32 v26, v24, v24
    v_cvt_pk_bf16_f32 v27, -v25, -v25
    buffer_store_short v26, v2, s[24:27], s60 offen
    buffer_store_short v27, v2, s[24:27], s60 offen offset:1024
    s_add_u32 s60, s60, 2048

    v_mul_f32 v18, v25, v9
    v_fma_f32 v18, v24, v8, -v18
    v_mul_f32 v19, v25, v8
    v_fma_f32 v19, v24, v9, v19
    v_add_f32 v24, v18, v42
    v_add_f32 v25, v19, v43
    v_cvt_pk_bf16_f32 v26, v24, v24
    v_cvt_pk_bf16_f32 v27, -v25, -v25
    buffer_store_short v26, v2, s[24:27], s60 offen
    buffer_store_short v27, v2, s[24:27], s60 offen offset:1024
    s_add_u32 s60, s60, 2048

    v_mul_f32 v18, v25, v9
    v_fma_f32 v18, v24, v8, -v18
    v_mul_f32 v19, v25, v8
    v_fma_f32 v19, v24, v9, v19
    v_add_f32 v24, v18, v44
    v_add_f32 v25, v19, v45
    v_cvt_pk_bf16_f32 v26, v24, v24
    v_cvt_pk_bf16_f32 v27, -v25, -v25
    buffer_store_short v26, v2, s[24:27], s60 offen
    buffer_store_short v27, v2, s[24:27], s60 offen offset:1024
    s_add_u32 s60, s60, 2048

    v_mul_f32 v18, v25, v9
    v_fma_f32 v18, v24, v8, -v18
    v_mul_f32 v19, v25, v8
    v_fma_f32 v19, v24, v9, v19
    v_add_f32 v24, v18, v46
    v_add_f32 v25, v19, v47
    v_cvt_pk_bf16_f32 v26, v24, v24
    v_cvt_pk_bf16_f32 v27, -v25, -v25
    buffer_store_short v26, v2, s[24:27], s60 offen
    buffer_store_short v27, v2, s[24:27], s60 offen offset:1024
    s_add_u32 s60, s60, 2048

    buffer_load_dword v32, v3, s[36:39], s59 offen
    buffer_load_dword v33, v3, s[36:39], s59 offen offset:2048
    s_add_u32 s59, s59, 4096
    buffer_load_dword v34, v3, s[36:39], s59 offen
    buffer_load_dword v35, v3, s[36:39], s59 offen offset:2048
    s_add_u32 s59, s59, 4096
    buffer_load_dword v36, v3, s[36:39], s59 offen
    buffer_load_dword v37, v3, s[36:39], s59 offen offset:2048
    s_add_u32 s59, s59, 4096
    buffer_load_dword v38, v3, s[36:39], s59 offen
    buffer_load_dword v39, v3, s[36:39], s59 offen offset:2048
    s_add_u32 s59, s59, 4096
    buffer_load_dword v40, v3, s[36:39], s59 offen
    buffer_load_dword v41, v3, s[36:39], s59 offen offset:2048
    s_add_u32 s59, s59, 4096
    buffer_load_dword v42, v3, s[36:39], s59 offen
    buffer_load_dword v43, v3, s[36:39], s59 offen offset:2048
    s_add_u32 s59, s59, 4096
    buffer_load_dword v44, v3, s[36:39], s59 offen
    buffer_load_dword v45, v3, s[36:39], s59 offen offset:2048
    s_add_u32 s59, s59, 4096
    buffer_load_dword v46, v3, s[36:39], s59 offen
    buffer_load_dword v47, v3, s[36:39], s59 offen offset:2048
    s_add_u32 s59, s59, 4096
    s_waitcnt vmcnt(48)
    v_mul_f32 v18, v25, v9
    v_fma_f32 v18, v24, v8, -v18
    v_mul_f32 v19, v25, v8
    v_fma_f32 v19, v24, v9, v19
    v_add_f32 v24, v18, v48
    v_add_f32 v25, v19, v49
    v_cvt_pk_bf16_f32 v26, v24, v24
    v_cvt_pk_bf16_f32 v27, -v25, -v25
    buffer_store_short v26, v2, s[24:27], s60 offen
    buffer_store_short v27, v2, s[24:27], s60 offen offset:1024
    s_add_u32 s60, s60, 2048

    v_mul_f32 v18, v25, v9
    v_fma_f32 v18, v24, v8, -v18
    v_mul_f32 v19, v25, v8
    v_fma_f32 v19, v24, v9, v19
    v_add_f32 v24, v18, v50
    v_add_f32 v25, v19, v51
    v_cvt_pk_bf16_f32 v26, v24, v24
    v_cvt_pk_bf16_f32 v27, -v25, -v25
    buffer_store_short v26, v2, s[24:27], s60 offen
    buffer_store_short v27, v2, s[24:27], s60 offen offset:1024
    s_add_u32 s60, s60, 2048

    v_mul_f32 v18, v25, v9
    v_fma_f32 v18, v24, v8, -v18
    v_mul_f32 v19, v25, v8
    v_fma_f32 v19, v24, v9, v19
    v_add_f32 v24, v18, v52
    v_add_f32 v25, v19, v53
    v_cvt_pk_bf16_f32 v26, v24, v24
    v_cvt_pk_bf16_f32 v27, -v25, -v25
    buffer_store_short v26, v2, s[24:27], s60 offen
    buffer_store_short v27, v2, s[24:27], s60 offen offset:1024
    s_add_u32 s60, s60, 2048

    v_mul_f32 v18, v25, v9
    v_fma_f32 v18, v24, v8, -v18
    v_mul_f32 v19, v25, v8
    v_fma_f32 v19, v24, v9, v19
    v_add_f32 v24, v18, v54
    v_add_f32 v25, v19, v55
    v_cvt_pk_bf16_f32 v26, v24, v24
    v_cvt_pk_bf16_f32 v27, -v25, -v25
    buffer_store_short v26, v2, s[24:27], s60 offen
    buffer_store_short v27, v2, s[24:27], s60 offen offset:1024
    s_add_u32 s60, s60, 2048

    v_mul_f32 v18, v25, v9
    v_fma_f32 v18, v24, v8, -v18
    v_mul_f32 v19, v25, v8
    v_fma_f32 v19, v24, v9, v19
    v_add_f32 v24, v18, v56
    v_add_f32 v25, v19, v57
    v_cvt_pk_bf16_f32 v26, v24, v24
    v_cvt_pk_bf16_f32 v27, -v25, -v25
    buffer_store_short v26, v2, s[24:27], s60 offen
    buffer_store_short v27, v2, s[24:27], s60 offen offset:1024
    s_add_u32 s60, s60, 2048

    v_mul_f32 v18, v25, v9
    v_fma_f32 v18, v24, v8, -v18
    v_mul_f32 v19, v25, v8
    v_fma_f32 v19, v24, v9, v19
    v_add_f32 v24, v18, v58
    v_add_f32 v25, v19, v59
    v_cvt_pk_bf16_f32 v26, v24, v24
    v_cvt_pk_bf16_f32 v27, -v25, -v25
    buffer_store_short v26, v2, s[24:27], s60 offen
    buffer_store_short v27, v2, s[24:27], s60 offen offset:1024
    s_add_u32 s60, s60, 2048

    v_mul_f32 v18, v25, v9
    v_fma_f32 v18, v24, v8, -v18
    v_mul_f32 v19, v25, v8
    v_fma_f32 v19, v24, v9, v19
    v_add_f32 v24, v18, v60
    v_add_f32 v25, v19, v61
    v_cvt_pk_bf16_f32 v26, v24, v24
    v_cvt_pk_bf16_f32 v27, -v25, -v25
    buffer_store_short v26, v2, s[24:27], s60 offen
    buffer_store_short v27, v2, s[24:27], s60 offen offset:1024
    s_add_u32 s60, s60, 2048

    v_mul_f32 v18, v25, v9
    v_fma_f32 v18, v24, v8, -v18
    v_mul_f32 v19, v25, v8
    v_fma_f32 v19, v24, v9, v19
    v_add_f32 v24, v18, v62
    v_add_f32 v25, v19, v63
    v_cvt_pk_bf16_f32 v26, v24, v24
    v_cvt_pk_bf16_f32 v27, -v25, -v25
    buffer_store_short v26, v2, s[24:27], s60 offen
    buffer_store_short v27, v2, s[24:27], s60 offen offset:1024
    s_add_u32 s60, s60, 2048

    buffer_load_dword v48, v3, s[36:39], s59 offen
    buffer_load_dword v49, v3, s[36:39], s59 offen offset:2048
    s_add_u32 s59, s59, 4096
    buffer_load_dword v50, v3, s[36:39], s59 offen
    buffer_load_dword v51, v3, s[36:39], s59 offen offset:2048
    s_add_u32 s59, s59, 4096
    buffer_load_dword v52, v3, s[36:39], s59 offen
    buffer_load_dword v53, v3, s[36:39], s59 offen offset:2048
    s_add_u32 s59, s59, 4096
    buffer_load_dword v54, v3, s[36:39], s59 offen
    buffer_load_dword v55, v3, s[36:39], s59 offen offset:2048
    s_add_u32 s59, s59, 4096
    buffer_load_dword v56, v3, s[36:39], s59 offen
    buffer_load_dword v57, v3, s[36:39], s59 offen offset:2048
    s_add_u32 s59, s59, 4096
    buffer_load_dword v58, v3, s[36:39], s59 offen
    buffer_load_dword v59, v3, s[36:39], s59 offen offset:2048
    s_add_u32 s59, s59, 4096
    buffer_load_dword v60, v3, s[36:39], s59 offen
    buffer_load_dword v61, v3, s[36:39], s59 offen offset:2048
    s_add_u32 s59, s59, 4096
    buffer_load_dword v62, v3, s[36:39], s59 offen
    buffer_load_dword v63, v3, s[36:39], s59 offen offset:2048
    s_add_u32 s59, s59, 4096
    s_waitcnt vmcnt(48)
    v_mul_f32 v18, v25, v9
    v_fma_f32 v18, v24, v8, -v18
    v_mul_f32 v19, v25, v8
    v_fma_f32 v19, v24, v9, v19
    v_add_f32 v24, v18, v64
    v_add_f32 v25, v19, v65
    v_cvt_pk_bf16_f32 v26, v24, v24
    v_cvt_pk_bf16_f32 v27, -v25, -v25
    buffer_store_short v26, v2, s[24:27], s60 offen
    buffer_store_short v27, v2, s[24:27], s60 offen offset:1024
    s_add_u32 s60, s60, 2048

    v_mul_f32 v18, v25, v9
    v_fma_f32 v18, v24, v8, -v18
    v_mul_f32 v19, v25, v8
    v_fma_f32 v19, v24, v9, v19
    v_add_f32 v24, v18, v66
    v_add_f32 v25, v19, v67
    v_cvt_pk_bf16_f32 v26, v24, v24
    v_cvt_pk_bf16_f32 v27, -v25, -v25
    buffer_store_short v26, v2, s[24:27], s60 offen
    buffer_store_short v27, v2, s[24:27], s60 offen offset:1024
    s_add_u32 s60, s60, 2048

    v_mul_f32 v18, v25, v9
    v_fma_f32 v18, v24, v8, -v18
    v_mul_f32 v19, v25, v8
    v_fma_f32 v19, v24, v9, v19
    v_add_f32 v24, v18, v68
    v_add_f32 v25, v19, v69
    v_cvt_pk_bf16_f32 v26, v24, v24
    v_cvt_pk_bf16_f32 v27, -v25, -v25
    buffer_store_short v26, v2, s[24:27], s60 offen
    buffer_store_short v27, v2, s[24:27], s60 offen offset:1024
    s_add_u32 s60, s60, 2048

    v_mul_f32 v18, v25, v9
    v_fma_f32 v18, v24, v8, -v18
    v_mul_f32 v19, v25, v8
    v_fma_f32 v19, v24, v9, v19
    v_add_f32 v24, v18, v70
    v_add_f32 v25, v19, v71
    v_cvt_pk_bf16_f32 v26, v24, v24
    v_cvt_pk_bf16_f32 v27, -v25, -v25
    buffer_store_short v26, v2, s[24:27], s60 offen
    buffer_store_short v27, v2, s[24:27], s60 offen offset:1024
    s_add_u32 s60, s60, 2048

    v_mul_f32 v18, v25, v9
    v_fma_f32 v18, v24, v8, -v18
    v_mul_f32 v19, v25, v8
    v_fma_f32 v19, v24, v9, v19
    v_add_f32 v24, v18, v72
    v_add_f32 v25, v19, v73
    v_cvt_pk_bf16_f32 v26, v24, v24
    v_cvt_pk_bf16_f32 v27, -v25, -v25
    buffer_store_short v26, v2, s[24:27], s60 offen
    buffer_store_short v27, v2, s[24:27], s60 offen offset:1024
    s_add_u32 s60, s60, 2048

    v_mul_f32 v18, v25, v9
    v_fma_f32 v18, v24, v8, -v18
    v_mul_f32 v19, v25, v8
    v_fma_f32 v19, v24, v9, v19
    v_add_f32 v24, v18, v74
    v_add_f32 v25, v19, v75
    v_cvt_pk_bf16_f32 v26, v24, v24
    v_cvt_pk_bf16_f32 v27, -v25, -v25
    buffer_store_short v26, v2, s[24:27], s60 offen
    buffer_store_short v27, v2, s[24:27], s60 offen offset:1024
    s_add_u32 s60, s60, 2048

    v_mul_f32 v18, v25, v9
    v_fma_f32 v18, v24, v8, -v18
    v_mul_f32 v19, v25, v8
    v_fma_f32 v19, v24, v9, v19
    v_add_f32 v24, v18, v76
    v_add_f32 v25, v19, v77
    v_cvt_pk_bf16_f32 v26, v24, v24
    v_cvt_pk_bf16_f32 v27, -v25, -v25
    buffer_store_short v26, v2, s[24:27], s60 offen
    buffer_store_short v27, v2, s[24:27], s60 offen offset:1024
    s_add_u32 s60, s60, 2048

    v_mul_f32 v18, v25, v9
    v_fma_f32 v18, v24, v8, -v18
    v_mul_f32 v19, v25, v8
    v_fma_f32 v19, v24, v9, v19
    v_add_f32 v24, v18, v78
    v_add_f32 v25, v19, v79
    v_cvt_pk_bf16_f32 v26, v24, v24
    v_cvt_pk_bf16_f32 v27, -v25, -v25
    buffer_store_short v26, v2, s[24:27], s60 offen
    buffer_store_short v27, v2, s[24:27], s60 offen offset:1024
    s_add_u32 s60, s60, 2048

    buffer_load_dword v64, v3, s[36:39], s59 offen
    buffer_load_dword v65, v3, s[36:39], s59 offen offset:2048
    s_add_u32 s59, s59, 4096
    buffer_load_dword v66, v3, s[36:39], s59 offen
    buffer_load_dword v67, v3, s[36:39], s59 offen offset:2048
    s_add_u32 s59, s59, 4096
    buffer_load_dword v68, v3, s[36:39], s59 offen
    buffer_load_dword v69, v3, s[36:39], s59 offen offset:2048
    s_add_u32 s59, s59, 4096
    buffer_load_dword v70, v3, s[36:39], s59 offen
    buffer_load_dword v71, v3, s[36:39], s59 offen offset:2048
    s_add_u32 s59, s59, 4096
    buffer_load_dword v72, v3, s[36:39], s59 offen
    buffer_load_dword v73, v3, s[36:39], s59 offen offset:2048
    s_add_u32 s59, s59, 4096
    buffer_load_dword v74, v3, s[36:39], s59 offen
    buffer_load_dword v75, v3, s[36:39], s59 offen offset:2048
    s_add_u32 s59, s59, 4096
    buffer_load_dword v76, v3, s[36:39], s59 offen
    buffer_load_dword v77, v3, s[36:39], s59 offen offset:2048
    s_add_u32 s59, s59, 4096
    buffer_load_dword v78, v3, s[36:39], s59 offen
    buffer_load_dword v79, v3, s[36:39], s59 offen offset:2048
    s_add_u32 s59, s59, 4096
    s_waitcnt vmcnt(48)
    v_mul_f32 v18, v25, v9
    v_fma_f32 v18, v24, v8, -v18
    v_mul_f32 v19, v25, v8
    v_fma_f32 v19, v24, v9, v19
    v_add_f32 v24, v18, v32
    v_add_f32 v25, v19, v33
    v_cvt_pk_bf16_f32 v26, v24, v24
    v_cvt_pk_bf16_f32 v27, -v25, -v25
    buffer_store_short v26, v2, s[24:27], s60 offen
    buffer_store_short v27, v2, s[24:27], s60 offen offset:1024
    s_add_u32 s60, s60, 2048

    v_mul_f32 v18, v25, v9
    v_fma_f32 v18, v24, v8, -v18
    v_mul_f32 v19, v25, v8
    v_fma_f32 v19, v24, v9, v19
    v_add_f32 v24, v18, v34
    v_add_f32 v25, v19, v35
    v_cvt_pk_bf16_f32 v26, v24, v24
    v_cvt_pk_bf16_f32 v27, -v25, -v25
    buffer_store_short v26, v2, s[24:27], s60 offen
    buffer_store_short v27, v2, s[24:27], s60 offen offset:1024
    s_add_u32 s60, s60, 2048

    v_mul_f32 v18, v25, v9
    v_fma_f32 v18, v24, v8, -v18
    v_mul_f32 v19, v25, v8
    v_fma_f32 v19, v24, v9, v19
    v_add_f32 v24, v18, v36
    v_add_f32 v25, v19, v37
    v_cvt_pk_bf16_f32 v26, v24, v24
    v_cvt_pk_bf16_f32 v27, -v25, -v25
    buffer_store_short v26, v2, s[24:27], s60 offen
    buffer_store_short v27, v2, s[24:27], s60 offen offset:1024
    s_add_u32 s60, s60, 2048

    v_mul_f32 v18, v25, v9
    v_fma_f32 v18, v24, v8, -v18
    v_mul_f32 v19, v25, v8
    v_fma_f32 v19, v24, v9, v19
    v_add_f32 v24, v18, v38
    v_add_f32 v25, v19, v39
    v_cvt_pk_bf16_f32 v26, v24, v24
    v_cvt_pk_bf16_f32 v27, -v25, -v25
    buffer_store_short v26, v2, s[24:27], s60 offen
    buffer_store_short v27, v2, s[24:27], s60 offen offset:1024
    s_add_u32 s60, s60, 2048

    v_mul_f32 v18, v25, v9
    v_fma_f32 v18, v24, v8, -v18
    v_mul_f32 v19, v25, v8
    v_fma_f32 v19, v24, v9, v19
    v_add_f32 v24, v18, v40
    v_add_f32 v25, v19, v41
    v_cvt_pk_bf16_f32 v26, v24, v24
    v_cvt_pk_bf16_f32 v27, -v25, -v25
    buffer_store_short v26, v2, s[24:27], s60 offen
    buffer_store_short v27, v2, s[24:27], s60 offen offset:1024
    s_add_u32 s60, s60, 2048

    v_mul_f32 v18, v25, v9
    v_fma_f32 v18, v24, v8, -v18
    v_mul_f32 v19, v25, v8
    v_fma_f32 v19, v24, v9, v19
    v_add_f32 v24, v18, v42
    v_add_f32 v25, v19, v43
    v_cvt_pk_bf16_f32 v26, v24, v24
    v_cvt_pk_bf16_f32 v27, -v25, -v25
    buffer_store_short v26, v2, s[24:27], s60 offen
    buffer_store_short v27, v2, s[24:27], s60 offen offset:1024
    s_add_u32 s60, s60, 2048

    v_mul_f32 v18, v25, v9
    v_fma_f32 v18, v24, v8, -v18
    v_mul_f32 v19, v25, v8
    v_fma_f32 v19, v24, v9, v19
    v_add_f32 v24, v18, v44
    v_add_f32 v25, v19, v45
    v_cvt_pk_bf16_f32 v26, v24, v24
    v_cvt_pk_bf16_f32 v27, -v25, -v25
    buffer_store_short v26, v2, s[24:27], s60 offen
    buffer_store_short v27, v2, s[24:27], s60 offen offset:1024
    s_add_u32 s60, s60, 2048

    v_mul_f32 v18, v25, v9
    v_fma_f32 v18, v24, v8, -v18
    v_mul_f32 v19, v25, v8
    v_fma_f32 v19, v24, v9, v19
    v_add_f32 v24, v18, v46
    v_add_f32 v25, v19, v47
    v_cvt_pk_bf16_f32 v26, v24, v24
    v_cvt_pk_bf16_f32 v27, -v25, -v25
    buffer_store_short v26, v2, s[24:27], s60 offen
    buffer_store_short v27, v2, s[24:27], s60 offen offset:1024
    s_add_u32 s60, s60, 2048

    buffer_load_dword v32, v3, s[36:39], s59 offen
    buffer_load_dword v33, v3, s[36:39], s59 offen offset:2048
    s_add_u32 s59, s59, 4096
    buffer_load_dword v34, v3, s[36:39], s59 offen
    buffer_load_dword v35, v3, s[36:39], s59 offen offset:2048
    s_add_u32 s59, s59, 4096
    buffer_load_dword v36, v3, s[36:39], s59 offen
    buffer_load_dword v37, v3, s[36:39], s59 offen offset:2048
    s_add_u32 s59, s59, 4096
    buffer_load_dword v38, v3, s[36:39], s59 offen
    buffer_load_dword v39, v3, s[36:39], s59 offen offset:2048
    s_add_u32 s59, s59, 4096
    buffer_load_dword v40, v3, s[36:39], s59 offen
    buffer_load_dword v41, v3, s[36:39], s59 offen offset:2048
    s_add_u32 s59, s59, 4096
    buffer_load_dword v42, v3, s[36:39], s59 offen
    buffer_load_dword v43, v3, s[36:39], s59 offen offset:2048
    s_add_u32 s59, s59, 4096
    buffer_load_dword v44, v3, s[36:39], s59 offen
    buffer_load_dword v45, v3, s[36:39], s59 offen offset:2048
    s_add_u32 s59, s59, 4096
    buffer_load_dword v46, v3, s[36:39], s59 offen
    buffer_load_dword v47, v3, s[36:39], s59 offen offset:2048
    s_add_u32 s59, s59, 4096
    s_waitcnt vmcnt(48)
    v_mul_f32 v18, v25, v9
    v_fma_f32 v18, v24, v8, -v18
    v_mul_f32 v19, v25, v8
    v_fma_f32 v19, v24, v9, v19
    v_add_f32 v24, v18, v48
    v_add_f32 v25, v19, v49
    v_cvt_pk_bf16_f32 v26, v24, v24
    v_cvt_pk_bf16_f32 v27, -v25, -v25
    buffer_store_short v26, v2, s[24:27], s60 offen
    buffer_store_short v27, v2, s[24:27], s60 offen offset:1024
    s_add_u32 s60, s60, 2048

    v_mul_f32 v18, v25, v9
    v_fma_f32 v18, v24, v8, -v18
    v_mul_f32 v19, v25, v8
    v_fma_f32 v19, v24, v9, v19
    v_add_f32 v24, v18, v50
    v_add_f32 v25, v19, v51
    v_cvt_pk_bf16_f32 v26, v24, v24
    v_cvt_pk_bf16_f32 v27, -v25, -v25
    buffer_store_short v26, v2, s[24:27], s60 offen
    buffer_store_short v27, v2, s[24:27], s60 offen offset:1024
    s_add_u32 s60, s60, 2048

    v_mul_f32 v18, v25, v9
    v_fma_f32 v18, v24, v8, -v18
    v_mul_f32 v19, v25, v8
    v_fma_f32 v19, v24, v9, v19
    v_add_f32 v24, v18, v52
    v_add_f32 v25, v19, v53
    v_cvt_pk_bf16_f32 v26, v24, v24
    v_cvt_pk_bf16_f32 v27, -v25, -v25
    buffer_store_short v26, v2, s[24:27], s60 offen
    buffer_store_short v27, v2, s[24:27], s60 offen offset:1024
    s_add_u32 s60, s60, 2048

    v_mul_f32 v18, v25, v9
    v_fma_f32 v18, v24, v8, -v18
    v_mul_f32 v19, v25, v8
    v_fma_f32 v19, v24, v9, v19
    v_add_f32 v24, v18, v54
    v_add_f32 v25, v19, v55
    v_cvt_pk_bf16_f32 v26, v24, v24
    v_cvt_pk_bf16_f32 v27, -v25, -v25
    buffer_store_short v26, v2, s[24:27], s60 offen
    buffer_store_short v27, v2, s[24:27], s60 offen offset:1024
    s_add_u32 s60, s60, 2048

    v_mul_f32 v18, v25, v9
    v_fma_f32 v18, v24, v8, -v18
    v_mul_f32 v19, v25, v8
    v_fma_f32 v19, v24, v9, v19
    v_add_f32 v24, v18, v56
    v_add_f32 v25, v19, v57
    v_cvt_pk_bf16_f32 v26, v24, v24
    v_cvt_pk_bf16_f32 v27, -v25, -v25
    buffer_store_short v26, v2, s[24:27], s60 offen
    buffer_store_short v27, v2, s[24:27], s60 offen offset:1024
    s_add_u32 s60, s60, 2048

    v_mul_f32 v18, v25, v9
    v_fma_f32 v18, v24, v8, -v18
    v_mul_f32 v19, v25, v8
    v_fma_f32 v19, v24, v9, v19
    v_add_f32 v24, v18, v58
    v_add_f32 v25, v19, v59
    v_cvt_pk_bf16_f32 v26, v24, v24
    v_cvt_pk_bf16_f32 v27, -v25, -v25
    buffer_store_short v26, v2, s[24:27], s60 offen
    buffer_store_short v27, v2, s[24:27], s60 offen offset:1024
    s_add_u32 s60, s60, 2048

    v_mul_f32 v18, v25, v9
    v_fma_f32 v18, v24, v8, -v18
    v_mul_f32 v19, v25, v8
    v_fma_f32 v19, v24, v9, v19
    v_add_f32 v24, v18, v60
    v_add_f32 v25, v19, v61
    v_cvt_pk_bf16_f32 v26, v24, v24
    v_cvt_pk_bf16_f32 v27, -v25, -v25
    buffer_store_short v26, v2, s[24:27], s60 offen
    buffer_store_short v27, v2, s[24:27], s60 offen offset:1024
    s_add_u32 s60, s60, 2048

    v_mul_f32 v18, v25, v9
    v_fma_f32 v18, v24, v8, -v18
    v_mul_f32 v19, v25, v8
    v_fma_f32 v19, v24, v9, v19
    v_add_f32 v24, v18, v62
    v_add_f32 v25, v19, v63
    v_cvt_pk_bf16_f32 v26, v24, v24
    v_cvt_pk_bf16_f32 v27, -v25, -v25
    buffer_store_short v26, v2, s[24:27], s60 offen
    buffer_store_short v27, v2, s[24:27], s60 offen offset:1024
    s_add_u32 s60, s60, 2048

    buffer_load_dword v48, v3, s[36:39], s59 offen
    buffer_load_dword v49, v3, s[36:39], s59 offen offset:2048
    s_add_u32 s59, s59, 4096
    buffer_load_dword v50, v3, s[36:39], s59 offen
    buffer_load_dword v51, v3, s[36:39], s59 offen offset:2048
    s_add_u32 s59, s59, 4096
    buffer_load_dword v52, v3, s[36:39], s59 offen
    buffer_load_dword v53, v3, s[36:39], s59 offen offset:2048
    s_add_u32 s59, s59, 4096
    buffer_load_dword v54, v3, s[36:39], s59 offen
    buffer_load_dword v55, v3, s[36:39], s59 offen offset:2048
    s_add_u32 s59, s59, 4096
    buffer_load_dword v56, v3, s[36:39], s59 offen
    buffer_load_dword v57, v3, s[36:39], s59 offen offset:2048
    s_add_u32 s59, s59, 4096
    buffer_load_dword v58, v3, s[36:39], s59 offen
    buffer_load_dword v59, v3, s[36:39], s59 offen offset:2048
    s_add_u32 s59, s59, 4096
    buffer_load_dword v60, v3, s[36:39], s59 offen
    buffer_load_dword v61, v3, s[36:39], s59 offen offset:2048
    s_add_u32 s59, s59, 4096
    buffer_load_dword v62, v3, s[36:39], s59 offen
    buffer_load_dword v63, v3, s[36:39], s59 offen offset:2048
    s_add_u32 s59, s59, 4096
    s_waitcnt vmcnt(48)
    v_mul_f32 v18, v25, v9
    v_fma_f32 v18, v24, v8, -v18
    v_mul_f32 v19, v25, v8
    v_fma_f32 v19, v24, v9, v19
    v_add_f32 v24, v18, v64
    v_add_f32 v25, v19, v65
    v_cvt_pk_bf16_f32 v26, v24, v24
    v_cvt_pk_bf16_f32 v27, -v25, -v25
    buffer_store_short v26, v2, s[24:27], s60 offen
    buffer_store_short v27, v2, s[24:27], s60 offen offset:1024
    s_add_u32 s60, s60, 2048

    v_mul_f32 v18, v25, v9
    v_fma_f32 v18, v24, v8, -v18
    v_mul_f32 v19, v25, v8
    v_fma_f32 v19, v24, v9, v19
    v_add_f32 v24, v18, v66
    v_add_f32 v25, v19, v67
    v_cvt_pk_bf16_f32 v26, v24, v24
    v_cvt_pk_bf16_f32 v27, -v25, -v25
    buffer_store_short v26, v2, s[24:27], s60 offen
    buffer_store_short v27, v2, s[24:27], s60 offen offset:1024
    s_add_u32 s60, s60, 2048

    v_mul_f32 v18, v25, v9
    v_fma_f32 v18, v24, v8, -v18
    v_mul_f32 v19, v25, v8
    v_fma_f32 v19, v24, v9, v19
    v_add_f32 v24, v18, v68
    v_add_f32 v25, v19, v69
    v_cvt_pk_bf16_f32 v26, v24, v24
    v_cvt_pk_bf16_f32 v27, -v25, -v25
    buffer_store_short v26, v2, s[24:27], s60 offen
    buffer_store_short v27, v2, s[24:27], s60 offen offset:1024
    s_add_u32 s60, s60, 2048

    v_mul_f32 v18, v25, v9
    v_fma_f32 v18, v24, v8, -v18
    v_mul_f32 v19, v25, v8
    v_fma_f32 v19, v24, v9, v19
    v_add_f32 v24, v18, v70
    v_add_f32 v25, v19, v71
    v_cvt_pk_bf16_f32 v26, v24, v24
    v_cvt_pk_bf16_f32 v27, -v25, -v25
    buffer_store_short v26, v2, s[24:27], s60 offen
    buffer_store_short v27, v2, s[24:27], s60 offen offset:1024
    s_add_u32 s60, s60, 2048

    v_mul_f32 v18, v25, v9
    v_fma_f32 v18, v24, v8, -v18
    v_mul_f32 v19, v25, v8
    v_fma_f32 v19, v24, v9, v19
    v_add_f32 v24, v18, v72
    v_add_f32 v25, v19, v73
    v_cvt_pk_bf16_f32 v26, v24, v24
    v_cvt_pk_bf16_f32 v27, -v25, -v25
    buffer_store_short v26, v2, s[24:27], s60 offen
    buffer_store_short v27, v2, s[24:27], s60 offen offset:1024
    s_add_u32 s60, s60, 2048

    v_mul_f32 v18, v25, v9
    v_fma_f32 v18, v24, v8, -v18
    v_mul_f32 v19, v25, v8
    v_fma_f32 v19, v24, v9, v19
    v_add_f32 v24, v18, v74
    v_add_f32 v25, v19, v75
    v_cvt_pk_bf16_f32 v26, v24, v24
    v_cvt_pk_bf16_f32 v27, -v25, -v25
    buffer_store_short v26, v2, s[24:27], s60 offen
    buffer_store_short v27, v2, s[24:27], s60 offen offset:1024
    s_add_u32 s60, s60, 2048

    v_mul_f32 v18, v25, v9
    v_fma_f32 v18, v24, v8, -v18
    v_mul_f32 v19, v25, v8
    v_fma_f32 v19, v24, v9, v19
    v_add_f32 v24, v18, v76
    v_add_f32 v25, v19, v77
    v_cvt_pk_bf16_f32 v26, v24, v24
    v_cvt_pk_bf16_f32 v27, -v25, -v25
    buffer_store_short v26, v2, s[24:27], s60 offen
    buffer_store_short v27, v2, s[24:27], s60 offen offset:1024
    s_add_u32 s60, s60, 2048

    v_mul_f32 v18, v25, v9
    v_fma_f32 v18, v24, v8, -v18
    v_mul_f32 v19, v25, v8
    v_fma_f32 v19, v24, v9, v19
    v_add_f32 v24, v18, v78
    v_add_f32 v25, v19, v79
    v_cvt_pk_bf16_f32 v26, v24, v24
    v_cvt_pk_bf16_f32 v27, -v25, -v25
    buffer_store_short v26, v2, s[24:27], s60 offen
    buffer_store_short v27, v2, s[24:27], s60 offen offset:1024
    s_add_u32 s60, s60, 2048

    buffer_load_dword v64, v3, s[36:39], s59 offen
    buffer_load_dword v65, v3, s[36:39], s59 offen offset:2048
    s_add_u32 s59, s59, 4096
    buffer_load_dword v66, v3, s[36:39], s59 offen
    buffer_load_dword v67, v3, s[36:39], s59 offen offset:2048
    s_add_u32 s59, s59, 4096
    buffer_load_dword v68, v3, s[36:39], s59 offen
    buffer_load_dword v69, v3, s[36:39], s59 offen offset:2048
    s_add_u32 s59, s59, 4096
    buffer_load_dword v70, v3, s[36:39], s59 offen
    buffer_load_dword v71, v3, s[36:39], s59 offen offset:2048
    s_add_u32 s59, s59, 4096
    buffer_load_dword v72, v3, s[36:39], s59 offen
    buffer_load_dword v73, v3, s[36:39], s59 offen offset:2048
    s_add_u32 s59, s59, 4096
    buffer_load_dword v74, v3, s[36:39], s59 offen
    buffer_load_dword v75, v3, s[36:39], s59 offen offset:2048
    s_add_u32 s59, s59, 4096
    buffer_load_dword v76, v3, s[36:39], s59 offen
    buffer_load_dword v77, v3, s[36:39], s59 offen offset:2048
    s_add_u32 s59, s59, 4096
    buffer_load_dword v78, v3, s[36:39], s59 offen
    buffer_load_dword v79, v3, s[36:39], s59 offen offset:2048
    s_add_u32 s59, s59, 4096
    s_waitcnt vmcnt(48)
    v_mul_f32 v18, v25, v9
    v_fma_f32 v18, v24, v8, -v18
    v_mul_f32 v19, v25, v8
    v_fma_f32 v19, v24, v9, v19
    v_add_f32 v24, v18, v32
    v_add_f32 v25, v19, v33
    v_cvt_pk_bf16_f32 v26, v24, v24
    v_cvt_pk_bf16_f32 v27, -v25, -v25
    buffer_store_short v26, v2, s[24:27], s60 offen
    buffer_store_short v27, v2, s[24:27], s60 offen offset:1024
    s_add_u32 s60, s60, 2048

    v_mul_f32 v18, v25, v9
    v_fma_f32 v18, v24, v8, -v18
    v_mul_f32 v19, v25, v8
    v_fma_f32 v19, v24, v9, v19
    v_add_f32 v24, v18, v34
    v_add_f32 v25, v19, v35
    v_cvt_pk_bf16_f32 v26, v24, v24
    v_cvt_pk_bf16_f32 v27, -v25, -v25
    buffer_store_short v26, v2, s[24:27], s60 offen
    buffer_store_short v27, v2, s[24:27], s60 offen offset:1024
    s_add_u32 s60, s60, 2048

    v_mul_f32 v18, v25, v9
    v_fma_f32 v18, v24, v8, -v18
    v_mul_f32 v19, v25, v8
    v_fma_f32 v19, v24, v9, v19
    v_add_f32 v24, v18, v36
    v_add_f32 v25, v19, v37
    v_cvt_pk_bf16_f32 v26, v24, v24
    v_cvt_pk_bf16_f32 v27, -v25, -v25
    buffer_store_short v26, v2, s[24:27], s60 offen
    buffer_store_short v27, v2, s[24:27], s60 offen offset:1024
    s_add_u32 s60, s60, 2048

    v_mul_f32 v18, v25, v9
    v_fma_f32 v18, v24, v8, -v18
    v_mul_f32 v19, v25, v8
    v_fma_f32 v19, v24, v9, v19
    v_add_f32 v24, v18, v38
    v_add_f32 v25, v19, v39
    v_cvt_pk_bf16_f32 v26, v24, v24
    v_cvt_pk_bf16_f32 v27, -v25, -v25
    buffer_store_short v26, v2, s[24:27], s60 offen
    buffer_store_short v27, v2, s[24:27], s60 offen offset:1024
    s_add_u32 s60, s60, 2048

    v_mul_f32 v18, v25, v9
    v_fma_f32 v18, v24, v8, -v18
    v_mul_f32 v19, v25, v8
    v_fma_f32 v19, v24, v9, v19
    v_add_f32 v24, v18, v40
    v_add_f32 v25, v19, v41
    v_cvt_pk_bf16_f32 v26, v24, v24
    v_cvt_pk_bf16_f32 v27, -v25, -v25
    buffer_store_short v26, v2, s[24:27], s60 offen
    buffer_store_short v27, v2, s[24:27], s60 offen offset:1024
    s_add_u32 s60, s60, 2048

    v_mul_f32 v18, v25, v9
    v_fma_f32 v18, v24, v8, -v18
    v_mul_f32 v19, v25, v8
    v_fma_f32 v19, v24, v9, v19
    v_add_f32 v24, v18, v42
    v_add_f32 v25, v19, v43
    v_cvt_pk_bf16_f32 v26, v24, v24
    v_cvt_pk_bf16_f32 v27, -v25, -v25
    buffer_store_short v26, v2, s[24:27], s60 offen
    buffer_store_short v27, v2, s[24:27], s60 offen offset:1024
    s_add_u32 s60, s60, 2048

    v_mul_f32 v18, v25, v9
    v_fma_f32 v18, v24, v8, -v18
    v_mul_f32 v19, v25, v8
    v_fma_f32 v19, v24, v9, v19
    v_add_f32 v24, v18, v44
    v_add_f32 v25, v19, v45
    v_cvt_pk_bf16_f32 v26, v24, v24
    v_cvt_pk_bf16_f32 v27, -v25, -v25
    buffer_store_short v26, v2, s[24:27], s60 offen
    buffer_store_short v27, v2, s[24:27], s60 offen offset:1024
    s_add_u32 s60, s60, 2048

    v_mul_f32 v18, v25, v9
    v_fma_f32 v18, v24, v8, -v18
    v_mul_f32 v19, v25, v8
    v_fma_f32 v19, v24, v9, v19
    v_add_f32 v24, v18, v46
    v_add_f32 v25, v19, v47
    v_cvt_pk_bf16_f32 v26, v24, v24
    v_cvt_pk_bf16_f32 v27, -v25, -v25
    buffer_store_short v26, v2, s[24:27], s60 offen
    buffer_store_short v27, v2, s[24:27], s60 offen offset:1024
    s_add_u32 s60, s60, 2048

    buffer_load_dword v32, v3, s[36:39], s59 offen
    buffer_load_dword v33, v3, s[36:39], s59 offen offset:2048
    s_add_u32 s59, s59, 4096
    buffer_load_dword v34, v3, s[36:39], s59 offen
    buffer_load_dword v35, v3, s[36:39], s59 offen offset:2048
    s_add_u32 s59, s59, 4096
    buffer_load_dword v36, v3, s[36:39], s59 offen
    buffer_load_dword v37, v3, s[36:39], s59 offen offset:2048
    s_add_u32 s59, s59, 4096
    buffer_load_dword v38, v3, s[36:39], s59 offen
    buffer_load_dword v39, v3, s[36:39], s59 offen offset:2048
    s_add_u32 s59, s59, 4096
    buffer_load_dword v40, v3, s[36:39], s59 offen
    buffer_load_dword v41, v3, s[36:39], s59 offen offset:2048
    s_add_u32 s59, s59, 4096
    buffer_load_dword v42, v3, s[36:39], s59 offen
    buffer_load_dword v43, v3, s[36:39], s59 offen offset:2048
    s_add_u32 s59, s59, 4096
    buffer_load_dword v44, v3, s[36:39], s59 offen
    buffer_load_dword v45, v3, s[36:39], s59 offen offset:2048
    s_add_u32 s59, s59, 4096
    buffer_load_dword v46, v3, s[36:39], s59 offen
    buffer_load_dword v47, v3, s[36:39], s59 offen offset:2048
    s_add_u32 s59, s59, 4096
    s_waitcnt vmcnt(48)
    v_mul_f32 v18, v25, v9
    v_fma_f32 v18, v24, v8, -v18
    v_mul_f32 v19, v25, v8
    v_fma_f32 v19, v24, v9, v19
    v_add_f32 v24, v18, v48
    v_add_f32 v25, v19, v49
    v_cvt_pk_bf16_f32 v26, v24, v24
    v_cvt_pk_bf16_f32 v27, -v25, -v25
    buffer_store_short v26, v2, s[24:27], s60 offen
    buffer_store_short v27, v2, s[24:27], s60 offen offset:1024
    s_add_u32 s60, s60, 2048

    v_mul_f32 v18, v25, v9
    v_fma_f32 v18, v24, v8, -v18
    v_mul_f32 v19, v25, v8
    v_fma_f32 v19, v24, v9, v19
    v_add_f32 v24, v18, v50
    v_add_f32 v25, v19, v51
    v_cvt_pk_bf16_f32 v26, v24, v24
    v_cvt_pk_bf16_f32 v27, -v25, -v25
    buffer_store_short v26, v2, s[24:27], s60 offen
    buffer_store_short v27, v2, s[24:27], s60 offen offset:1024
    s_add_u32 s60, s60, 2048

    v_mul_f32 v18, v25, v9
    v_fma_f32 v18, v24, v8, -v18
    v_mul_f32 v19, v25, v8
    v_fma_f32 v19, v24, v9, v19
    v_add_f32 v24, v18, v52
    v_add_f32 v25, v19, v53
    v_cvt_pk_bf16_f32 v26, v24, v24
    v_cvt_pk_bf16_f32 v27, -v25, -v25
    buffer_store_short v26, v2, s[24:27], s60 offen
    buffer_store_short v27, v2, s[24:27], s60 offen offset:1024
    s_add_u32 s60, s60, 2048

    v_mul_f32 v18, v25, v9
    v_fma_f32 v18, v24, v8, -v18
    v_mul_f32 v19, v25, v8
    v_fma_f32 v19, v24, v9, v19
    v_add_f32 v24, v18, v54
    v_add_f32 v25, v19, v55
    v_cvt_pk_bf16_f32 v26, v24, v24
    v_cvt_pk_bf16_f32 v27, -v25, -v25
    buffer_store_short v26, v2, s[24:27], s60 offen
    buffer_store_short v27, v2, s[24:27], s60 offen offset:1024
    s_add_u32 s60, s60, 2048

    v_mul_f32 v18, v25, v9
    v_fma_f32 v18, v24, v8, -v18
    v_mul_f32 v19, v25, v8
    v_fma_f32 v19, v24, v9, v19
    v_add_f32 v24, v18, v56
    v_add_f32 v25, v19, v57
    v_cvt_pk_bf16_f32 v26, v24, v24
    v_cvt_pk_bf16_f32 v27, -v25, -v25
    buffer_store_short v26, v2, s[24:27], s60 offen
    buffer_store_short v27, v2, s[24:27], s60 offen offset:1024
    s_add_u32 s60, s60, 2048

    v_mul_f32 v18, v25, v9
    v_fma_f32 v18, v24, v8, -v18
    v_mul_f32 v19, v25, v8
    v_fma_f32 v19, v24, v9, v19
    v_add_f32 v24, v18, v58
    v_add_f32 v25, v19, v59
    v_cvt_pk_bf16_f32 v26, v24, v24
    v_cvt_pk_bf16_f32 v27, -v25, -v25
    buffer_store_short v26, v2, s[24:27], s60 offen
    buffer_store_short v27, v2, s[24:27], s60 offen offset:1024
    s_add_u32 s60, s60, 2048

    v_mul_f32 v18, v25, v9
    v_fma_f32 v18, v24, v8, -v18
    v_mul_f32 v19, v25, v8
    v_fma_f32 v19, v24, v9, v19
    v_add_f32 v24, v18, v60
    v_add_f32 v25, v19, v61
    v_cvt_pk_bf16_f32 v26, v24, v24
    v_cvt_pk_bf16_f32 v27, -v25, -v25
    buffer_store_short v26, v2, s[24:27], s60 offen
    buffer_store_short v27, v2, s[24:27], s60 offen offset:1024
    s_add_u32 s60, s60, 2048

    v_mul_f32 v18, v25, v9
    v_fma_f32 v18, v24, v8, -v18
    v_mul_f32 v19, v25, v8
    v_fma_f32 v19, v24, v9, v19
    v_add_f32 v24, v18, v62
    v_add_f32 v25, v19, v63
    v_cvt_pk_bf16_f32 v26, v24, v24
    v_cvt_pk_bf16_f32 v27, -v25, -v25
    buffer_store_short v26, v2, s[24:27], s60 offen
    buffer_store_short v27, v2, s[24:27], s60 offen offset:1024
    s_add_u32 s60, s60, 2048

    buffer_load_dword v48, v3, s[36:39], s59 offen
    buffer_load_dword v49, v3, s[36:39], s59 offen offset:2048
    s_add_u32 s59, s59, 4096
    buffer_load_dword v50, v3, s[36:39], s59 offen
    buffer_load_dword v51, v3, s[36:39], s59 offen offset:2048
    s_add_u32 s59, s59, 4096
    buffer_load_dword v52, v3, s[36:39], s59 offen
    buffer_load_dword v53, v3, s[36:39], s59 offen offset:2048
    s_add_u32 s59, s59, 4096
    buffer_load_dword v54, v3, s[36:39], s59 offen
    buffer_load_dword v55, v3, s[36:39], s59 offen offset:2048
    s_add_u32 s59, s59, 4096
    buffer_load_dword v56, v3, s[36:39], s59 offen
    buffer_load_dword v57, v3, s[36:39], s59 offen offset:2048
    s_add_u32 s59, s59, 4096
    buffer_load_dword v58, v3, s[36:39], s59 offen
    buffer_load_dword v59, v3, s[36:39], s59 offen offset:2048
    s_add_u32 s59, s59, 4096
    buffer_load_dword v60, v3, s[36:39], s59 offen
    buffer_load_dword v61, v3, s[36:39], s59 offen offset:2048
    s_add_u32 s59, s59, 4096
    buffer_load_dword v62, v3, s[36:39], s59 offen
    buffer_load_dword v63, v3, s[36:39], s59 offen offset:2048
    s_add_u32 s59, s59, 4096
    s_waitcnt vmcnt(48)
    v_mul_f32 v18, v25, v9
    v_fma_f32 v18, v24, v8, -v18
    v_mul_f32 v19, v25, v8
    v_fma_f32 v19, v24, v9, v19
    v_add_f32 v24, v18, v64
    v_add_f32 v25, v19, v65
    v_cvt_pk_bf16_f32 v26, v24, v24
    v_cvt_pk_bf16_f32 v27, -v25, -v25
    buffer_store_short v26, v2, s[24:27], s60 offen
    buffer_store_short v27, v2, s[24:27], s60 offen offset:1024
    s_add_u32 s60, s60, 2048

    v_mul_f32 v18, v25, v9
    v_fma_f32 v18, v24, v8, -v18
    v_mul_f32 v19, v25, v8
    v_fma_f32 v19, v24, v9, v19
    v_add_f32 v24, v18, v66
    v_add_f32 v25, v19, v67
    v_cvt_pk_bf16_f32 v26, v24, v24
    v_cvt_pk_bf16_f32 v27, -v25, -v25
    buffer_store_short v26, v2, s[24:27], s60 offen
    buffer_store_short v27, v2, s[24:27], s60 offen offset:1024
    s_add_u32 s60, s60, 2048

    v_mul_f32 v18, v25, v9
    v_fma_f32 v18, v24, v8, -v18
    v_mul_f32 v19, v25, v8
    v_fma_f32 v19, v24, v9, v19
    v_add_f32 v24, v18, v68
    v_add_f32 v25, v19, v69
    v_cvt_pk_bf16_f32 v26, v24, v24
    v_cvt_pk_bf16_f32 v27, -v25, -v25
    buffer_store_short v26, v2, s[24:27], s60 offen
    buffer_store_short v27, v2, s[24:27], s60 offen offset:1024
    s_add_u32 s60, s60, 2048

    v_mul_f32 v18, v25, v9
    v_fma_f32 v18, v24, v8, -v18
    v_mul_f32 v19, v25, v8
    v_fma_f32 v19, v24, v9, v19
    v_add_f32 v24, v18, v70
    v_add_f32 v25, v19, v71
    v_cvt_pk_bf16_f32 v26, v24, v24
    v_cvt_pk_bf16_f32 v27, -v25, -v25
    buffer_store_short v26, v2, s[24:27], s60 offen
    buffer_store_short v27, v2, s[24:27], s60 offen offset:1024
    s_add_u32 s60, s60, 2048

    v_mul_f32 v18, v25, v9
    v_fma_f32 v18, v24, v8, -v18
    v_mul_f32 v19, v25, v8
    v_fma_f32 v19, v24, v9, v19
    v_add_f32 v24, v18, v72
    v_add_f32 v25, v19, v73
    v_cvt_pk_bf16_f32 v26, v24, v24
    v_cvt_pk_bf16_f32 v27, -v25, -v25
    buffer_store_short v26, v2, s[24:27], s60 offen
    buffer_store_short v27, v2, s[24:27], s60 offen offset:1024
    s_add_u32 s60, s60, 2048

    v_mul_f32 v18, v25, v9
    v_fma_f32 v18, v24, v8, -v18
    v_mul_f32 v19, v25, v8
    v_fma_f32 v19, v24, v9, v19
    v_add_f32 v24, v18, v74
    v_add_f32 v25, v19, v75
    v_cvt_pk_bf16_f32 v26, v24, v24
    v_cvt_pk_bf16_f32 v27, -v25, -v25
    buffer_store_short v26, v2, s[24:27], s60 offen
    buffer_store_short v27, v2, s[24:27], s60 offen offset:1024
    s_add_u32 s60, s60, 2048

    v_mul_f32 v18, v25, v9
    v_fma_f32 v18, v24, v8, -v18
    v_mul_f32 v19, v25, v8
    v_fma_f32 v19, v24, v9, v19
    v_add_f32 v24, v18, v76
    v_add_f32 v25, v19, v77
    v_cvt_pk_bf16_f32 v26, v24, v24
    v_cvt_pk_bf16_f32 v27, -v25, -v25
    buffer_store_short v26, v2, s[24:27], s60 offen
    buffer_store_short v27, v2, s[24:27], s60 offen offset:1024
    s_add_u32 s60, s60, 2048

    v_mul_f32 v18, v25, v9
    v_fma_f32 v18, v24, v8, -v18
    v_mul_f32 v19, v25, v8
    v_fma_f32 v19, v24, v9, v19
    v_add_f32 v24, v18, v78
    v_add_f32 v25, v19, v79
    v_cvt_pk_bf16_f32 v26, v24, v24
    v_cvt_pk_bf16_f32 v27, -v25, -v25
    buffer_store_short v26, v2, s[24:27], s60 offen
    buffer_store_short v27, v2, s[24:27], s60 offen offset:1024
    s_add_u32 s60, s60, 2048

    buffer_load_dword v64, v3, s[36:39], s59 offen
    buffer_load_dword v65, v3, s[36:39], s59 offen offset:2048
    s_add_u32 s59, s59, 4096
    buffer_load_dword v66, v3, s[36:39], s59 offen
    buffer_load_dword v67, v3, s[36:39], s59 offen offset:2048
    s_add_u32 s59, s59, 4096
    buffer_load_dword v68, v3, s[36:39], s59 offen
    buffer_load_dword v69, v3, s[36:39], s59 offen offset:2048
    s_add_u32 s59, s59, 4096
    buffer_load_dword v70, v3, s[36:39], s59 offen
    buffer_load_dword v71, v3, s[36:39], s59 offen offset:2048
    s_add_u32 s59, s59, 4096
    buffer_load_dword v72, v3, s[36:39], s59 offen
    buffer_load_dword v73, v3, s[36:39], s59 offen offset:2048
    s_add_u32 s59, s59, 4096
    buffer_load_dword v74, v3, s[36:39], s59 offen
    buffer_load_dword v75, v3, s[36:39], s59 offen offset:2048
    s_add_u32 s59, s59, 4096
    buffer_load_dword v76, v3, s[36:39], s59 offen
    buffer_load_dword v77, v3, s[36:39], s59 offen offset:2048
    s_add_u32 s59, s59, 4096
    buffer_load_dword v78, v3, s[36:39], s59 offen
    buffer_load_dword v79, v3, s[36:39], s59 offen offset:2048
    s_add_u32 s59, s59, 4096
    s_waitcnt vmcnt(48)
    v_mul_f32 v18, v25, v9
    v_fma_f32 v18, v24, v8, -v18
    v_mul_f32 v19, v25, v8
    v_fma_f32 v19, v24, v9, v19
    v_add_f32 v24, v18, v32
    v_add_f32 v25, v19, v33
    v_cvt_pk_bf16_f32 v26, v24, v24
    v_cvt_pk_bf16_f32 v27, -v25, -v25
    buffer_store_short v26, v2, s[24:27], s60 offen
    buffer_store_short v27, v2, s[24:27], s60 offen offset:1024
    s_add_u32 s60, s60, 2048

    v_mul_f32 v18, v25, v9
    v_fma_f32 v18, v24, v8, -v18
    v_mul_f32 v19, v25, v8
    v_fma_f32 v19, v24, v9, v19
    v_add_f32 v24, v18, v34
    v_add_f32 v25, v19, v35
    v_cvt_pk_bf16_f32 v26, v24, v24
    v_cvt_pk_bf16_f32 v27, -v25, -v25
    buffer_store_short v26, v2, s[24:27], s60 offen
    buffer_store_short v27, v2, s[24:27], s60 offen offset:1024
    s_add_u32 s60, s60, 2048

    v_mul_f32 v18, v25, v9
    v_fma_f32 v18, v24, v8, -v18
    v_mul_f32 v19, v25, v8
    v_fma_f32 v19, v24, v9, v19
    v_add_f32 v24, v18, v36
    v_add_f32 v25, v19, v37
    v_cvt_pk_bf16_f32 v26, v24, v24
    v_cvt_pk_bf16_f32 v27, -v25, -v25
    buffer_store_short v26, v2, s[24:27], s60 offen
    buffer_store_short v27, v2, s[24:27], s60 offen offset:1024
    s_add_u32 s60, s60, 2048

    v_mul_f32 v18, v25, v9
    v_fma_f32 v18, v24, v8, -v18
    v_mul_f32 v19, v25, v8
    v_fma_f32 v19, v24, v9, v19
    v_add_f32 v24, v18, v38
    v_add_f32 v25, v19, v39
    v_cvt_pk_bf16_f32 v26, v24, v24
    v_cvt_pk_bf16_f32 v27, -v25, -v25
    buffer_store_short v26, v2, s[24:27], s60 offen
    buffer_store_short v27, v2, s[24:27], s60 offen offset:1024
    s_add_u32 s60, s60, 2048

    v_mul_f32 v18, v25, v9
    v_fma_f32 v18, v24, v8, -v18
    v_mul_f32 v19, v25, v8
    v_fma_f32 v19, v24, v9, v19
    v_add_f32 v24, v18, v40
    v_add_f32 v25, v19, v41
    v_cvt_pk_bf16_f32 v26, v24, v24
    v_cvt_pk_bf16_f32 v27, -v25, -v25
    buffer_store_short v26, v2, s[24:27], s60 offen
    buffer_store_short v27, v2, s[24:27], s60 offen offset:1024
    s_add_u32 s60, s60, 2048

    v_mul_f32 v18, v25, v9
    v_fma_f32 v18, v24, v8, -v18
    v_mul_f32 v19, v25, v8
    v_fma_f32 v19, v24, v9, v19
    v_add_f32 v24, v18, v42
    v_add_f32 v25, v19, v43
    v_cvt_pk_bf16_f32 v26, v24, v24
    v_cvt_pk_bf16_f32 v27, -v25, -v25
    buffer_store_short v26, v2, s[24:27], s60 offen
    buffer_store_short v27, v2, s[24:27], s60 offen offset:1024
    s_add_u32 s60, s60, 2048

    v_mul_f32 v18, v25, v9
    v_fma_f32 v18, v24, v8, -v18
    v_mul_f32 v19, v25, v8
    v_fma_f32 v19, v24, v9, v19
    v_add_f32 v24, v18, v44
    v_add_f32 v25, v19, v45
    v_cvt_pk_bf16_f32 v26, v24, v24
    v_cvt_pk_bf16_f32 v27, -v25, -v25
    buffer_store_short v26, v2, s[24:27], s60 offen
    buffer_store_short v27, v2, s[24:27], s60 offen offset:1024
    s_add_u32 s60, s60, 2048

    v_mul_f32 v18, v25, v9
    v_fma_f32 v18, v24, v8, -v18
    v_mul_f32 v19, v25, v8
    v_fma_f32 v19, v24, v9, v19
    v_add_f32 v24, v18, v46
    v_add_f32 v25, v19, v47
    v_cvt_pk_bf16_f32 v26, v24, v24
    v_cvt_pk_bf16_f32 v27, -v25, -v25
    buffer_store_short v26, v2, s[24:27], s60 offen
    buffer_store_short v27, v2, s[24:27], s60 offen offset:1024
    s_add_u32 s60, s60, 2048

    buffer_load_dword v32, v3, s[36:39], s59 offen
    buffer_load_dword v33, v3, s[36:39], s59 offen offset:2048
    s_add_u32 s59, s59, 4096
    buffer_load_dword v34, v3, s[36:39], s59 offen
    buffer_load_dword v35, v3, s[36:39], s59 offen offset:2048
    s_add_u32 s59, s59, 4096
    buffer_load_dword v36, v3, s[36:39], s59 offen
    buffer_load_dword v37, v3, s[36:39], s59 offen offset:2048
    s_add_u32 s59, s59, 4096
    buffer_load_dword v38, v3, s[36:39], s59 offen
    buffer_load_dword v39, v3, s[36:39], s59 offen offset:2048
    s_add_u32 s59, s59, 4096
    buffer_load_dword v40, v3, s[36:39], s59 offen
    buffer_load_dword v41, v3, s[36:39], s59 offen offset:2048
    s_add_u32 s59, s59, 4096
    buffer_load_dword v42, v3, s[36:39], s59 offen
    buffer_load_dword v43, v3, s[36:39], s59 offen offset:2048
    s_add_u32 s59, s59, 4096
    buffer_load_dword v44, v3, s[36:39], s59 offen
    buffer_load_dword v45, v3, s[36:39], s59 offen offset:2048
    s_add_u32 s59, s59, 4096
    buffer_load_dword v46, v3, s[36:39], s59 offen
    buffer_load_dword v47, v3, s[36:39], s59 offen offset:2048
    s_add_u32 s59, s59, 4096
    s_waitcnt vmcnt(48)
    v_mul_f32 v18, v25, v9
    v_fma_f32 v18, v24, v8, -v18
    v_mul_f32 v19, v25, v8
    v_fma_f32 v19, v24, v9, v19
    v_add_f32 v24, v18, v48
    v_add_f32 v25, v19, v49
    v_cvt_pk_bf16_f32 v26, v24, v24
    v_cvt_pk_bf16_f32 v27, -v25, -v25
    buffer_store_short v26, v2, s[24:27], s60 offen
    buffer_store_short v27, v2, s[24:27], s60 offen offset:1024
    s_add_u32 s60, s60, 2048

    v_mul_f32 v18, v25, v9
    v_fma_f32 v18, v24, v8, -v18
    v_mul_f32 v19, v25, v8
    v_fma_f32 v19, v24, v9, v19
    v_add_f32 v24, v18, v50
    v_add_f32 v25, v19, v51
    v_cvt_pk_bf16_f32 v26, v24, v24
    v_cvt_pk_bf16_f32 v27, -v25, -v25
    buffer_store_short v26, v2, s[24:27], s60 offen
    buffer_store_short v27, v2, s[24:27], s60 offen offset:1024
    s_add_u32 s60, s60, 2048

    v_mul_f32 v18, v25, v9
    v_fma_f32 v18, v24, v8, -v18
    v_mul_f32 v19, v25, v8
    v_fma_f32 v19, v24, v9, v19
    v_add_f32 v24, v18, v52
    v_add_f32 v25, v19, v53
    v_cvt_pk_bf16_f32 v26, v24, v24
    v_cvt_pk_bf16_f32 v27, -v25, -v25
    buffer_store_short v26, v2, s[24:27], s60 offen
    buffer_store_short v27, v2, s[24:27], s60 offen offset:1024
    s_add_u32 s60, s60, 2048

    v_mul_f32 v18, v25, v9
    v_fma_f32 v18, v24, v8, -v18
    v_mul_f32 v19, v25, v8
    v_fma_f32 v19, v24, v9, v19
    v_add_f32 v24, v18, v54
    v_add_f32 v25, v19, v55
    v_cvt_pk_bf16_f32 v26, v24, v24
    v_cvt_pk_bf16_f32 v27, -v25, -v25
    buffer_store_short v26, v2, s[24:27], s60 offen
    buffer_store_short v27, v2, s[24:27], s60 offen offset:1024
    s_add_u32 s60, s60, 2048

    v_mul_f32 v18, v25, v9
    v_fma_f32 v18, v24, v8, -v18
    v_mul_f32 v19, v25, v8
    v_fma_f32 v19, v24, v9, v19
    v_add_f32 v24, v18, v56
    v_add_f32 v25, v19, v57
    v_cvt_pk_bf16_f32 v26, v24, v24
    v_cvt_pk_bf16_f32 v27, -v25, -v25
    buffer_store_short v26, v2, s[24:27], s60 offen
    buffer_store_short v27, v2, s[24:27], s60 offen offset:1024
    s_add_u32 s60, s60, 2048

    v_mul_f32 v18, v25, v9
    v_fma_f32 v18, v24, v8, -v18
    v_mul_f32 v19, v25, v8
    v_fma_f32 v19, v24, v9, v19
    v_add_f32 v24, v18, v58
    v_add_f32 v25, v19, v59
    v_cvt_pk_bf16_f32 v26, v24, v24
    v_cvt_pk_bf16_f32 v27, -v25, -v25
    buffer_store_short v26, v2, s[24:27], s60 offen
    buffer_store_short v27, v2, s[24:27], s60 offen offset:1024
    s_add_u32 s60, s60, 2048

    v_mul_f32 v18, v25, v9
    v_fma_f32 v18, v24, v8, -v18
    v_mul_f32 v19, v25, v8
    v_fma_f32 v19, v24, v9, v19
    v_add_f32 v24, v18, v60
    v_add_f32 v25, v19, v61
    v_cvt_pk_bf16_f32 v26, v24, v24
    v_cvt_pk_bf16_f32 v27, -v25, -v25
    buffer_store_short v26, v2, s[24:27], s60 offen
    buffer_store_short v27, v2, s[24:27], s60 offen offset:1024
    s_add_u32 s60, s60, 2048

    v_mul_f32 v18, v25, v9
    v_fma_f32 v18, v24, v8, -v18
    v_mul_f32 v19, v25, v8
    v_fma_f32 v19, v24, v9, v19
    v_add_f32 v24, v18, v62
    v_add_f32 v25, v19, v63
    v_cvt_pk_bf16_f32 v26, v24, v24
    v_cvt_pk_bf16_f32 v27, -v25, -v25
    buffer_store_short v26, v2, s[24:27], s60 offen
    buffer_store_short v27, v2, s[24:27], s60 offen offset:1024
    s_add_u32 s60, s60, 2048

    s_waitcnt vmcnt(32)
    v_mul_f32 v18, v25, v9
    v_fma_f32 v18, v24, v8, -v18
    v_mul_f32 v19, v25, v8
    v_fma_f32 v19, v24, v9, v19
    v_add_f32 v24, v18, v64
    v_add_f32 v25, v19, v65
    v_cvt_pk_bf16_f32 v26, v24, v24
    v_cvt_pk_bf16_f32 v27, -v25, -v25
    buffer_store_short v26, v2, s[24:27], s60 offen
    buffer_store_short v27, v2, s[24:27], s60 offen offset:1024
    s_add_u32 s60, s60, 2048

    v_mul_f32 v18, v25, v9
    v_fma_f32 v18, v24, v8, -v18
    v_mul_f32 v19, v25, v8
    v_fma_f32 v19, v24, v9, v19
    v_add_f32 v24, v18, v66
    v_add_f32 v25, v19, v67
    v_cvt_pk_bf16_f32 v26, v24, v24
    v_cvt_pk_bf16_f32 v27, -v25, -v25
    buffer_store_short v26, v2, s[24:27], s60 offen
    buffer_store_short v27, v2, s[24:27], s60 offen offset:1024
    s_add_u32 s60, s60, 2048

    v_mul_f32 v18, v25, v9
    v_fma_f32 v18, v24, v8, -v18
    v_mul_f32 v19, v25, v8
    v_fma_f32 v19, v24, v9, v19
    v_add_f32 v24, v18, v68
    v_add_f32 v25, v19, v69
    v_cvt_pk_bf16_f32 v26, v24, v24
    v_cvt_pk_bf16_f32 v27, -v25, -v25
    buffer_store_short v26, v2, s[24:27], s60 offen
    buffer_store_short v27, v2, s[24:27], s60 offen offset:1024
    s_add_u32 s60, s60, 2048

    v_mul_f32 v18, v25, v9
    v_fma_f32 v18, v24, v8, -v18
    v_mul_f32 v19, v25, v8
    v_fma_f32 v19, v24, v9, v19
    v_add_f32 v24, v18, v70
    v_add_f32 v25, v19, v71
    v_cvt_pk_bf16_f32 v26, v24, v24
    v_cvt_pk_bf16_f32 v27, -v25, -v25
    buffer_store_short v26, v2, s[24:27], s60 offen
    buffer_store_short v27, v2, s[24:27], s60 offen offset:1024
    s_add_u32 s60, s60, 2048

    v_mul_f32 v18, v25, v9
    v_fma_f32 v18, v24, v8, -v18
    v_mul_f32 v19, v25, v8
    v_fma_f32 v19, v24, v9, v19
    v_add_f32 v24, v18, v72
    v_add_f32 v25, v19, v73
    v_cvt_pk_bf16_f32 v26, v24, v24
    v_cvt_pk_bf16_f32 v27, -v25, -v25
    buffer_store_short v26, v2, s[24:27], s60 offen
    buffer_store_short v27, v2, s[24:27], s60 offen offset:1024
    s_add_u32 s60, s60, 2048

    v_mul_f32 v18, v25, v9
    v_fma_f32 v18, v24, v8, -v18
    v_mul_f32 v19, v25, v8
    v_fma_f32 v19, v24, v9, v19
    v_add_f32 v24, v18, v74
    v_add_f32 v25, v19, v75
    v_cvt_pk_bf16_f32 v26, v24, v24
    v_cvt_pk_bf16_f32 v27, -v25, -v25
    buffer_store_short v26, v2, s[24:27], s60 offen
    buffer_store_short v27, v2, s[24:27], s60 offen offset:1024
    s_add_u32 s60, s60, 2048

    v_mul_f32 v18, v25, v9
    v_fma_f32 v18, v24, v8, -v18
    v_mul_f32 v19, v25, v8
    v_fma_f32 v19, v24, v9, v19
    v_add_f32 v24, v18, v76
    v_add_f32 v25, v19, v77
    v_cvt_pk_bf16_f32 v26, v24, v24
    v_cvt_pk_bf16_f32 v27, -v25, -v25
    buffer_store_short v26, v2, s[24:27], s60 offen
    buffer_store_short v27, v2, s[24:27], s60 offen offset:1024
    s_add_u32 s60, s60, 2048

    v_mul_f32 v18, v25, v9
    v_fma_f32 v18, v24, v8, -v18
    v_mul_f32 v19, v25, v8
    v_fma_f32 v19, v24, v9, v19
    v_add_f32 v24, v18, v78
    v_add_f32 v25, v19, v79
    v_cvt_pk_bf16_f32 v26, v24, v24
    v_cvt_pk_bf16_f32 v27, -v25, -v25
    buffer_store_short v26, v2, s[24:27], s60 offen
    buffer_store_short v27, v2, s[24:27], s60 offen offset:1024
    s_add_u32 s60, s60, 2048

    s_waitcnt vmcnt(16)
    v_mul_f32 v18, v25, v9
    v_fma_f32 v18, v24, v8, -v18
    v_mul_f32 v19, v25, v8
    v_fma_f32 v19, v24, v9, v19
    v_add_f32 v24, v18, v32
    v_add_f32 v25, v19, v33
    v_cvt_pk_bf16_f32 v26, v24, v24
    v_cvt_pk_bf16_f32 v27, -v25, -v25
    buffer_store_short v26, v2, s[24:27], s60 offen
    buffer_store_short v27, v2, s[24:27], s60 offen offset:1024
    s_add_u32 s60, s60, 2048

    v_mul_f32 v18, v25, v9
    v_fma_f32 v18, v24, v8, -v18
    v_mul_f32 v19, v25, v8
    v_fma_f32 v19, v24, v9, v19
    v_add_f32 v24, v18, v34
    v_add_f32 v25, v19, v35
    v_cvt_pk_bf16_f32 v26, v24, v24
    v_cvt_pk_bf16_f32 v27, -v25, -v25
    buffer_store_short v26, v2, s[24:27], s60 offen
    buffer_store_short v27, v2, s[24:27], s60 offen offset:1024
    s_add_u32 s60, s60, 2048

    v_mul_f32 v18, v25, v9
    v_fma_f32 v18, v24, v8, -v18
    v_mul_f32 v19, v25, v8
    v_fma_f32 v19, v24, v9, v19
    v_add_f32 v24, v18, v36
    v_add_f32 v25, v19, v37
    v_cvt_pk_bf16_f32 v26, v24, v24
    v_cvt_pk_bf16_f32 v27, -v25, -v25
    buffer_store_short v26, v2, s[24:27], s60 offen
    buffer_store_short v27, v2, s[24:27], s60 offen offset:1024
    s_add_u32 s60, s60, 2048

    v_mul_f32 v18, v25, v9
    v_fma_f32 v18, v24, v8, -v18
    v_mul_f32 v19, v25, v8
    v_fma_f32 v19, v24, v9, v19
    v_add_f32 v24, v18, v38
    v_add_f32 v25, v19, v39
    v_cvt_pk_bf16_f32 v26, v24, v24
    v_cvt_pk_bf16_f32 v27, -v25, -v25
    buffer_store_short v26, v2, s[24:27], s60 offen
    buffer_store_short v27, v2, s[24:27], s60 offen offset:1024
    s_add_u32 s60, s60, 2048

    v_mul_f32 v18, v25, v9
    v_fma_f32 v18, v24, v8, -v18
    v_mul_f32 v19, v25, v8
    v_fma_f32 v19, v24, v9, v19
    v_add_f32 v24, v18, v40
    v_add_f32 v25, v19, v41
    v_cvt_pk_bf16_f32 v26, v24, v24
    v_cvt_pk_bf16_f32 v27, -v25, -v25
    buffer_store_short v26, v2, s[24:27], s60 offen
    buffer_store_short v27, v2, s[24:27], s60 offen offset:1024
    s_add_u32 s60, s60, 2048

    v_mul_f32 v18, v25, v9
    v_fma_f32 v18, v24, v8, -v18
    v_mul_f32 v19, v25, v8
    v_fma_f32 v19, v24, v9, v19
    v_add_f32 v24, v18, v42
    v_add_f32 v25, v19, v43
    v_cvt_pk_bf16_f32 v26, v24, v24
    v_cvt_pk_bf16_f32 v27, -v25, -v25
    buffer_store_short v26, v2, s[24:27], s60 offen
    buffer_store_short v27, v2, s[24:27], s60 offen offset:1024
    s_add_u32 s60, s60, 2048

    v_mul_f32 v18, v25, v9
    v_fma_f32 v18, v24, v8, -v18
    v_mul_f32 v19, v25, v8
    v_fma_f32 v19, v24, v9, v19
    v_add_f32 v24, v18, v44
    v_add_f32 v25, v19, v45
    v_cvt_pk_bf16_f32 v26, v24, v24
    v_cvt_pk_bf16_f32 v27, -v25, -v25
    buffer_store_short v26, v2, s[24:27], s60 offen
    buffer_store_short v27, v2, s[24:27], s60 offen offset:1024
    s_add_u32 s60, s60, 2048

    v_mul_f32 v18, v25, v9
    v_fma_f32 v18, v24, v8, -v18
    v_mul_f32 v19, v25, v8
    v_fma_f32 v19, v24, v9, v19
    v_add_f32 v24, v18, v46
    v_add_f32 v25, v19, v47
    v_cvt_pk_bf16_f32 v26, v24, v24
    v_cvt_pk_bf16_f32 v27, -v25, -v25
    buffer_store_short v26, v2, s[24:27], s60 offen
    buffer_store_short v27, v2, s[24:27], s60 offen offset:1024
    s_add_u32 s60, s60, 2048

    s_endpgm
K1_EXIT:
    s_endpgm
.p2align 8
.type k3_kernel,@function
k3_kernel:
    s_cmp_ge_u32 s2, 256
    s_cbranch_scc1 K3_EXIT
    s_load_dwordx2 s[4:5], s[0:1], 0
    s_load_dwordx2 s[6:7], s[0:1], 40
    s_load_dwordx2 s[8:9], s[0:1], 48
    s_load_dwordx2 s[10:11], s[0:1], 64
    s_load_dwordx2 s[12:13], s[0:1], 104
    s_load_dwordx2 s[16:17], s[0:1], 120
    v_and_b32 v1, 63, v0
    v_lshrrev_b32 v2, 6, v0
    s_and_b32 s56, s2, 7
    s_lshl_b32 s56, s56, 2
    s_lshr_b32 s57, s2, 3
    s_and_b32 s59, s57, 3
    s_add_u32 s56, s56, s59
    s_lshr_b32 s57, s2, 5
    v_and_b32 v3, 15, v1
    v_lshrrev_b32 v4, 4, v1
    v_readfirstlane_b32 s58, v2
    s_waitcnt lgkmcnt(0)

    s_add_u32 s20, s16, 0x1600000
    s_addc_u32 s21, s17, 0
    s_and_b32 s21, s21, 0xffff
    s_mov_b32 s22, 0x700000
    s_mov_b32 s23, 0x20000
    s_add_u32 s24, s16, 0x600000
    s_addc_u32 s25, s17, 0
    s_and_b32 s25, s25, 0xffff
    s_mov_b32 s26, 0x1c0000
    s_mov_b32 s27, 0x20000
    s_add_u32 s28, s16, 0x1100000
    s_addc_u32 s29, s17, 0
    s_and_b32 s29, s29, 0xffff
    s_mov_b32 s30, 0x400000
    s_mov_b32 s31, 0x20000
    s_mov_b32 s32, s6
    s_and_b32 s33, s7, 0xffff
    s_mov_b32 s34, 0x80000
    s_mov_b32 s35, 0x20000
    s_mov_b32 s36, s8
    s_and_b32 s37, s9, 0xffff
    s_mov_b32 s38, 0x80000
    s_mov_b32 s39, 0x20000
    s_mov_b32 s40, s4
    s_and_b32 s41, s5, 0xffff
    s_mov_b32 s42, 0x200000
    s_mov_b32 s43, 0x20000
    s_mov_b32 s44, s16
    s_and_b32 s45, s17, 0xffff
    s_mov_b32 s46, 0x200000
    s_mov_b32 s47, 0x20000
    s_mov_b32 s48, s10
    s_and_b32 s49, s11, 0xffff
    s_mov_b32 s50, 0x400
    s_mov_b32 s51, 0x20000
    s_mov_b32 s52, s12
    s_and_b32 s53, s13, 0xffff
    s_mov_b32 s54, 0x400000
    s_mov_b32 s55, 0x20000
    v_lshlrev_b32 v5, 5, v4
    v_mul_u32_u24 v6, 3584, v3
    v_add_u32 v6, v6, v5
    v_lshlrev_b32 v7, 11, v3
    v_add_u32 v7, v7, v5
    v_lshlrev_b32 v8, 10, v3
    v_add_u32 v8, v8, v5
    s_lshl_b32 s59, s56, 6
    s_mul_i32 s60, s59, 3584
    s_mul_i32 s61, s58, 896
    s_add_u32 s60, s60, s61
    s_lshl_b32 s62, s57, 6
    s_mul_i32 s62, s62, 3584
    s_add_u32 s62, s62, s61
    s_lshl_b32 s63, s59, 11
    s_lshl_b32 s61, s58, 8
    s_add_u32 s63, s63, s61
    s_lshl_b32 s64, s57, 16
    s_add_u32 s64, s64, s61

    v_accvgpr_write_b32 a0, 0
    v_accvgpr_write_b32 a1, 0
    v_accvgpr_write_b32 a2, 0
    v_accvgpr_write_b32 a3, 0
    v_accvgpr_write_b32 a4, 0
    v_accvgpr_write_b32 a5, 0
    v_accvgpr_write_b32 a6, 0
    v_accvgpr_write_b32 a7, 0
    v_accvgpr_write_b32 a8, 0
    v_accvgpr_write_b32 a9, 0
    v_accvgpr_write_b32 a10, 0
    v_accvgpr_write_b32 a11, 0
    v_accvgpr_write_b32 a12, 0
    v_accvgpr_write_b32 a13, 0
    v_accvgpr_write_b32 a14, 0
    v_accvgpr_write_b32 a15, 0
    v_accvgpr_write_b32 a16, 0
    v_accvgpr_write_b32 a17, 0
    v_accvgpr_write_b32 a18, 0
    v_accvgpr_write_b32 a19, 0
    v_accvgpr_write_b32 a20, 0
    v_accvgpr_write_b32 a21, 0
    v_accvgpr_write_b32 a22, 0
    v_accvgpr_write_b32 a23, 0
    v_accvgpr_write_b32 a24, 0
    v_accvgpr_write_b32 a25, 0
    v_accvgpr_write_b32 a26, 0
    v_accvgpr_write_b32 a27, 0
    v_accvgpr_write_b32 a28, 0
    v_accvgpr_write_b32 a29, 0
    v_accvgpr_write_b32 a30, 0
    v_accvgpr_write_b32 a31, 0
    v_accvgpr_write_b32 a32, 0
    v_accvgpr_write_b32 a33, 0
    v_accvgpr_write_b32 a34, 0
    v_accvgpr_write_b32 a35, 0
    v_accvgpr_write_b32 a36, 0
    v_accvgpr_write_b32 a37, 0
    v_accvgpr_write_b32 a38, 0
    v_accvgpr_write_b32 a39, 0
    v_accvgpr_write_b32 a40, 0
    v_accvgpr_write_b32 a41, 0
    v_accvgpr_write_b32 a42, 0
    v_accvgpr_write_b32 a43, 0
    v_accvgpr_write_b32 a44, 0
    v_accvgpr_write_b32 a45, 0
    v_accvgpr_write_b32 a46, 0
    v_accvgpr_write_b32 a47, 0
    v_accvgpr_write_b32 a48, 0
    v_accvgpr_write_b32 a49, 0
    v_accvgpr_write_b32 a50, 0
    v_accvgpr_write_b32 a51, 0
    v_accvgpr_write_b32 a52, 0
    v_accvgpr_write_b32 a53, 0
    v_accvgpr_write_b32 a54, 0
    v_accvgpr_write_b32 a55, 0
    v_accvgpr_write_b32 a56, 0
    v_accvgpr_write_b32 a57, 0
    v_accvgpr_write_b32 a58, 0
    v_accvgpr_write_b32 a59, 0
    v_accvgpr_write_b32 a60, 0
    v_accvgpr_write_b32 a61, 0
    v_accvgpr_write_b32 a62, 0
    v_accvgpr_write_b32 a63, 0
    v_accvgpr_write_b32 a64, 0
    v_accvgpr_write_b32 a65, 0
    v_accvgpr_write_b32 a66, 0
    v_accvgpr_write_b32 a67, 0
    v_accvgpr_write_b32 a68, 0
    v_accvgpr_write_b32 a69, 0
    v_accvgpr_write_b32 a70, 0
    v_accvgpr_write_b32 a71, 0
    v_accvgpr_write_b32 a72, 0
    v_accvgpr_write_b32 a73, 0
    v_accvgpr_write_b32 a74, 0
    v_accvgpr_write_b32 a75, 0
    v_accvgpr_write_b32 a76, 0
    v_accvgpr_write_b32 a77, 0
    v_accvgpr_write_b32 a78, 0
    v_accvgpr_write_b32 a79, 0
    v_accvgpr_write_b32 a80, 0
    v_accvgpr_write_b32 a81, 0
    v_accvgpr_write_b32 a82, 0
    v_accvgpr_write_b32 a83, 0
    v_accvgpr_write_b32 a84, 0
    v_accvgpr_write_b32 a85, 0
    v_accvgpr_write_b32 a86, 0
    v_accvgpr_write_b32 a87, 0
    v_accvgpr_write_b32 a88, 0
    v_accvgpr_write_b32 a89, 0
    v_accvgpr_write_b32 a90, 0
    v_accvgpr_write_b32 a91, 0
    v_accvgpr_write_b32 a92, 0
    v_accvgpr_write_b32 a93, 0
    v_accvgpr_write_b32 a94, 0
    v_accvgpr_write_b32 a95, 0
    v_accvgpr_write_b32 a96, 0
    v_accvgpr_write_b32 a97, 0
    v_accvgpr_write_b32 a98, 0
    v_accvgpr_write_b32 a99, 0
    v_accvgpr_write_b32 a100, 0
    v_accvgpr_write_b32 a101, 0
    v_accvgpr_write_b32 a102, 0
    v_accvgpr_write_b32 a103, 0
    v_accvgpr_write_b32 a104, 0
    v_accvgpr_write_b32 a105, 0
    v_accvgpr_write_b32 a106, 0
    v_accvgpr_write_b32 a107, 0
    v_accvgpr_write_b32 a108, 0
    v_accvgpr_write_b32 a109, 0
    v_accvgpr_write_b32 a110, 0
    v_accvgpr_write_b32 a111, 0
    v_accvgpr_write_b32 a112, 0
    v_accvgpr_write_b32 a113, 0
    v_accvgpr_write_b32 a114, 0
    v_accvgpr_write_b32 a115, 0
    v_accvgpr_write_b32 a116, 0
    v_accvgpr_write_b32 a117, 0
    v_accvgpr_write_b32 a118, 0
    v_accvgpr_write_b32 a119, 0
    v_accvgpr_write_b32 a120, 0
    v_accvgpr_write_b32 a121, 0
    v_accvgpr_write_b32 a122, 0
    v_accvgpr_write_b32 a123, 0
    v_accvgpr_write_b32 a124, 0
    v_accvgpr_write_b32 a125, 0
    v_accvgpr_write_b32 a126, 0
    v_accvgpr_write_b32 a127, 0
    v_lshrrev_b32 v9, 3, v1
    v_and_b32 v10, 7, v1
    v_xor_b32 v10, v10, v9
    v_lshlrev_b32 v10, 4, v10
    v_mul_u32_u24 v6, 3584, v9
    v_add_u32 v6, v6, v10
    v_lshlrev_b32 v7, 11, v9
    v_add_u32 v7, v7, v10
    v_lshlrev_b32 v8, 10, v9
    v_add_u32 v8, v8, v10
    v_and_b32 v10, 7, v1
    v_xor_b32 v11, v4, v10
    v_lshlrev_b32 v12, 7, v3
    v_lshl_add_u32 v13, v11, 4, v12
    v_xor_b32 v11, 4, v11
    v_lshl_add_u32 v14, v11, 4, v12
    s_lshl_b32 s67, s58, 15
    v_add_u32 v13, s67, v13
    v_add_u32 v14, s67, v14

    s_add_u32 s68, s67, 0
    s_add_u32 s65, s60, 0
    s_mov_b32 m0, s68
    s_add_u32 s68, s68, 1024
    buffer_load_dwordx4 v6, s[20:23], s65 offen lds
    s_add_u32 s65, s60, 28672
    s_mov_b32 m0, s68
    s_add_u32 s68, s68, 1024
    buffer_load_dwordx4 v6, s[20:23], s65 offen lds
    s_add_u32 s65, s60, 57344
    s_mov_b32 m0, s68
    s_add_u32 s68, s68, 1024
    buffer_load_dwordx4 v6, s[20:23], s65 offen lds
    s_add_u32 s65, s60, 86016
    s_mov_b32 m0, s68
    s_add_u32 s68, s68, 1024
    buffer_load_dwordx4 v6, s[20:23], s65 offen lds
    s_add_u32 s65, s60, 114688
    s_mov_b32 m0, s68
    s_add_u32 s68, s68, 1024
    buffer_load_dwordx4 v6, s[20:23], s65 offen lds
    s_add_u32 s65, s60, 143360
    s_mov_b32 m0, s68
    s_add_u32 s68, s68, 1024
    buffer_load_dwordx4 v6, s[20:23], s65 offen lds
    s_add_u32 s65, s60, 172032
    s_mov_b32 m0, s68
    s_add_u32 s68, s68, 1024
    buffer_load_dwordx4 v6, s[20:23], s65 offen lds
    s_add_u32 s65, s60, 200704
    s_mov_b32 m0, s68
    s_add_u32 s68, s68, 1024
    buffer_load_dwordx4 v6, s[20:23], s65 offen lds
    s_add_u32 s65, s62, 0
    s_mov_b32 m0, s68
    s_add_u32 s68, s68, 1024
    buffer_load_dwordx4 v6, s[24:27], s65 offen lds
    s_add_u32 s65, s62, 28672
    s_mov_b32 m0, s68
    s_add_u32 s68, s68, 1024
    buffer_load_dwordx4 v6, s[24:27], s65 offen lds
    s_add_u32 s65, s62, 57344
    s_mov_b32 m0, s68
    s_add_u32 s68, s68, 1024
    buffer_load_dwordx4 v6, s[24:27], s65 offen lds
    s_add_u32 s65, s62, 86016
    s_mov_b32 m0, s68
    s_add_u32 s68, s68, 1024
    buffer_load_dwordx4 v6, s[24:27], s65 offen lds
    s_add_u32 s65, s62, 114688
    s_mov_b32 m0, s68
    s_add_u32 s68, s68, 1024
    buffer_load_dwordx4 v6, s[24:27], s65 offen lds
    s_add_u32 s65, s62, 143360
    s_mov_b32 m0, s68
    s_add_u32 s68, s68, 1024
    buffer_load_dwordx4 v6, s[24:27], s65 offen lds
    s_add_u32 s65, s62, 172032
    s_mov_b32 m0, s68
    s_add_u32 s68, s68, 1024
    buffer_load_dwordx4 v6, s[24:27], s65 offen lds
    s_add_u32 s65, s62, 200704
    s_mov_b32 m0, s68
    s_add_u32 s68, s68, 1024
    buffer_load_dwordx4 v6, s[24:27], s65 offen lds
    s_add_u32 s68, s67, 16384
    s_add_u32 s65, s60, 128
    s_mov_b32 m0, s68
    s_add_u32 s68, s68, 1024
    buffer_load_dwordx4 v6, s[20:23], s65 offen lds
    s_add_u32 s65, s60, 28800
    s_mov_b32 m0, s68
    s_add_u32 s68, s68, 1024
    buffer_load_dwordx4 v6, s[20:23], s65 offen lds
    s_add_u32 s65, s60, 57472
    s_mov_b32 m0, s68
    s_add_u32 s68, s68, 1024
    buffer_load_dwordx4 v6, s[20:23], s65 offen lds
    s_add_u32 s65, s60, 86144
    s_mov_b32 m0, s68
    s_add_u32 s68, s68, 1024
    buffer_load_dwordx4 v6, s[20:23], s65 offen lds
    s_add_u32 s65, s60, 114816
    s_mov_b32 m0, s68
    s_add_u32 s68, s68, 1024
    buffer_load_dwordx4 v6, s[20:23], s65 offen lds
    s_add_u32 s65, s60, 143488
    s_mov_b32 m0, s68
    s_add_u32 s68, s68, 1024
    buffer_load_dwordx4 v6, s[20:23], s65 offen lds
    s_add_u32 s65, s60, 172160
    s_mov_b32 m0, s68
    s_add_u32 s68, s68, 1024
    buffer_load_dwordx4 v6, s[20:23], s65 offen lds
    s_add_u32 s65, s60, 200832
    s_mov_b32 m0, s68
    s_add_u32 s68, s68, 1024
    buffer_load_dwordx4 v6, s[20:23], s65 offen lds
    s_add_u32 s65, s62, 128
    s_mov_b32 m0, s68
    s_add_u32 s68, s68, 1024
    buffer_load_dwordx4 v6, s[24:27], s65 offen lds
    s_add_u32 s65, s62, 28800
    s_mov_b32 m0, s68
    s_add_u32 s68, s68, 1024
    buffer_load_dwordx4 v6, s[24:27], s65 offen lds
    s_add_u32 s65, s62, 57472
    s_mov_b32 m0, s68
    s_add_u32 s68, s68, 1024
    buffer_load_dwordx4 v6, s[24:27], s65 offen lds
    s_add_u32 s65, s62, 86144
    s_mov_b32 m0, s68
    s_add_u32 s68, s68, 1024
    buffer_load_dwordx4 v6, s[24:27], s65 offen lds
    s_add_u32 s65, s62, 114816
    s_mov_b32 m0, s68
    s_add_u32 s68, s68, 1024
    buffer_load_dwordx4 v6, s[24:27], s65 offen lds
    s_add_u32 s65, s62, 143488
    s_mov_b32 m0, s68
    s_add_u32 s68, s68, 1024
    buffer_load_dwordx4 v6, s[24:27], s65 offen lds
    s_add_u32 s65, s62, 172160
    s_mov_b32 m0, s68
    s_add_u32 s68, s68, 1024
    buffer_load_dwordx4 v6, s[24:27], s65 offen lds
    s_add_u32 s65, s62, 200832
    s_mov_b32 m0, s68
    s_add_u32 s68, s68, 1024
    buffer_load_dwordx4 v6, s[24:27], s65 offen lds
    s_waitcnt vmcnt(16)
    ds_read_b128 v[64:67], v13 offset:0
    ds_read_b128 v[80:83], v13 offset:8192
    ds_read_b128 v[68:71], v13 offset:2048
    ds_read_b128 v[84:87], v13 offset:10240
    ds_read_b128 v[72:75], v13 offset:4096
    ds_read_b128 v[88:91], v13 offset:12288
    ds_read_b128 v[76:79], v13 offset:6144
    ds_read_b128 v[92:95], v13 offset:14336
    ds_read_b128 v[96:99], v14 offset:0
    ds_read_b128 v[112:115], v14 offset:8192
    ds_read_b128 v[100:103], v14 offset:2048
    ds_read_b128 v[116:119], v14 offset:10240
    ds_read_b128 v[104:107], v14 offset:4096
    ds_read_b128 v[120:123], v14 offset:12288
    ds_read_b128 v[108:111], v14 offset:6144
    ds_read_b128 v[124:127], v14 offset:14336
    s_waitcnt lgkmcnt(8)
    v_mfma_f32_16x16x32_bf16 a[0:3], v[80:83], v[64:67], a[0:3]
    v_mfma_f32_16x16x32_bf16 a[4:7], v[84:87], v[64:67], a[4:7]
    v_mfma_f32_16x16x32_bf16 a[8:11], v[88:91], v[64:67], a[8:11]
    v_mfma_f32_16x16x32_bf16 a[12:15], v[92:95], v[64:67], a[12:15]
    v_mfma_f32_16x16x32_bf16 a[16:19], v[80:83], v[68:71], a[16:19]
    v_mfma_f32_16x16x32_bf16 a[20:23], v[84:87], v[68:71], a[20:23]
    v_mfma_f32_16x16x32_bf16 a[24:27], v[88:91], v[68:71], a[24:27]
    v_mfma_f32_16x16x32_bf16 a[28:31], v[92:95], v[68:71], a[28:31]
    v_mfma_f32_16x16x32_bf16 a[32:35], v[80:83], v[72:75], a[32:35]
    v_mfma_f32_16x16x32_bf16 a[36:39], v[84:87], v[72:75], a[36:39]
    v_mfma_f32_16x16x32_bf16 a[40:43], v[88:91], v[72:75], a[40:43]
    v_mfma_f32_16x16x32_bf16 a[44:47], v[92:95], v[72:75], a[44:47]
    v_mfma_f32_16x16x32_bf16 a[48:51], v[80:83], v[76:79], a[48:51]
    v_mfma_f32_16x16x32_bf16 a[52:55], v[84:87], v[76:79], a[52:55]
    v_mfma_f32_16x16x32_bf16 a[56:59], v[88:91], v[76:79], a[56:59]
    v_mfma_f32_16x16x32_bf16 a[60:63], v[92:95], v[76:79], a[60:63]
    s_waitcnt lgkmcnt(0)
    v_mfma_f32_16x16x32_bf16 a[0:3], v[112:115], v[96:99], a[0:3]
    v_mfma_f32_16x16x32_bf16 a[4:7], v[116:119], v[96:99], a[4:7]
    v_mfma_f32_16x16x32_bf16 a[8:11], v[120:123], v[96:99], a[8:11]
    v_mfma_f32_16x16x32_bf16 a[12:15], v[124:127], v[96:99], a[12:15]
    v_mfma_f32_16x16x32_bf16 a[16:19], v[112:115], v[100:103], a[16:19]
    v_mfma_f32_16x16x32_bf16 a[20:23], v[116:119], v[100:103], a[20:23]
    v_mfma_f32_16x16x32_bf16 a[24:27], v[120:123], v[100:103], a[24:27]
    v_mfma_f32_16x16x32_bf16 a[28:31], v[124:127], v[100:103], a[28:31]
    v_mfma_f32_16x16x32_bf16 a[32:35], v[112:115], v[104:107], a[32:35]
    v_mfma_f32_16x16x32_bf16 a[36:39], v[116:119], v[104:107], a[36:39]
    v_mfma_f32_16x16x32_bf16 a[40:43], v[120:123], v[104:107], a[40:43]
    v_mfma_f32_16x16x32_bf16 a[44:47], v[124:127], v[104:107], a[44:47]
    v_mfma_f32_16x16x32_bf16 a[48:51], v[112:115], v[108:111], a[48:51]
    v_mfma_f32_16x16x32_bf16 a[52:55], v[116:119], v[108:111], a[52:55]
    v_mfma_f32_16x16x32_bf16 a[56:59], v[120:123], v[108:111], a[56:59]
    v_mfma_f32_16x16x32_bf16 a[60:63], v[124:127], v[108:111], a[60:63]
    s_add_u32 s68, s67, 0
    s_add_u32 s65, s60, 256
    s_mov_b32 m0, s68
    s_add_u32 s68, s68, 1024
    buffer_load_dwordx4 v6, s[20:23], s65 offen lds
    s_add_u32 s65, s60, 28928
    s_mov_b32 m0, s68
    s_add_u32 s68, s68, 1024
    buffer_load_dwordx4 v6, s[20:23], s65 offen lds
    s_add_u32 s65, s60, 57600
    s_mov_b32 m0, s68
    s_add_u32 s68, s68, 1024
    buffer_load_dwordx4 v6, s[20:23], s65 offen lds
    s_add_u32 s65, s60, 86272
    s_mov_b32 m0, s68
    s_add_u32 s68, s68, 1024
    buffer_load_dwordx4 v6, s[20:23], s65 offen lds
    s_add_u32 s65, s60, 114944
    s_mov_b32 m0, s68
    s_add_u32 s68, s68, 1024
    buffer_load_dwordx4 v6, s[20:23], s65 offen lds
    s_add_u32 s65, s60, 143616
    s_mov_b32 m0, s68
    s_add_u32 s68, s68, 1024
    buffer_load_dwordx4 v6, s[20:23], s65 offen lds
    s_add_u32 s65, s60, 172288
    s_mov_b32 m0, s68
    s_add_u32 s68, s68, 1024
    buffer_load_dwordx4 v6, s[20:23], s65 offen lds
    s_add_u32 s65, s60, 200960
    s_mov_b32 m0, s68
    s_add_u32 s68, s68, 1024
    buffer_load_dwordx4 v6, s[20:23], s65 offen lds
    s_add_u32 s65, s62, 256
    s_mov_b32 m0, s68
    s_add_u32 s68, s68, 1024
    buffer_load_dwordx4 v6, s[24:27], s65 offen lds
    s_add_u32 s65, s62, 28928
    s_mov_b32 m0, s68
    s_add_u32 s68, s68, 1024
    buffer_load_dwordx4 v6, s[24:27], s65 offen lds
    s_add_u32 s65, s62, 57600
    s_mov_b32 m0, s68
    s_add_u32 s68, s68, 1024
    buffer_load_dwordx4 v6, s[24:27], s65 offen lds
    s_add_u32 s65, s62, 86272
    s_mov_b32 m0, s68
    s_add_u32 s68, s68, 1024
    buffer_load_dwordx4 v6, s[24:27], s65 offen lds
    s_add_u32 s65, s62, 114944
    s_mov_b32 m0, s68
    s_add_u32 s68, s68, 1024
    buffer_load_dwordx4 v6, s[24:27], s65 offen lds
    s_add_u32 s65, s62, 143616
    s_mov_b32 m0, s68
    s_add_u32 s68, s68, 1024
    buffer_load_dwordx4 v6, s[24:27], s65 offen lds
    s_add_u32 s65, s62, 172288
    s_mov_b32 m0, s68
    s_add_u32 s68, s68, 1024
    buffer_load_dwordx4 v6, s[24:27], s65 offen lds
    s_add_u32 s65, s62, 200960
    s_mov_b32 m0, s68
    s_add_u32 s68, s68, 1024
    buffer_load_dwordx4 v6, s[24:27], s65 offen lds
    s_waitcnt vmcnt(16)
    ds_read_b128 v[64:67], v13 offset:16384
    ds_read_b128 v[80:83], v13 offset:24576
    ds_read_b128 v[68:71], v13 offset:18432
    ds_read_b128 v[84:87], v13 offset:26624
    ds_read_b128 v[72:75], v13 offset:20480
    ds_read_b128 v[88:91], v13 offset:28672
    ds_read_b128 v[76:79], v13 offset:22528
    ds_read_b128 v[92:95], v13 offset:30720
    ds_read_b128 v[96:99], v14 offset:16384
    ds_read_b128 v[112:115], v14 offset:24576
    ds_read_b128 v[100:103], v14 offset:18432
    ds_read_b128 v[116:119], v14 offset:26624
    ds_read_b128 v[104:107], v14 offset:20480
    ds_read_b128 v[120:123], v14 offset:28672
    ds_read_b128 v[108:111], v14 offset:22528
    ds_read_b128 v[124:127], v14 offset:30720
    s_waitcnt lgkmcnt(8)
    v_mfma_f32_16x16x32_bf16 a[0:3], v[80:83], v[64:67], a[0:3]
    v_mfma_f32_16x16x32_bf16 a[4:7], v[84:87], v[64:67], a[4:7]
    v_mfma_f32_16x16x32_bf16 a[8:11], v[88:91], v[64:67], a[8:11]
    v_mfma_f32_16x16x32_bf16 a[12:15], v[92:95], v[64:67], a[12:15]
    v_mfma_f32_16x16x32_bf16 a[16:19], v[80:83], v[68:71], a[16:19]
    v_mfma_f32_16x16x32_bf16 a[20:23], v[84:87], v[68:71], a[20:23]
    v_mfma_f32_16x16x32_bf16 a[24:27], v[88:91], v[68:71], a[24:27]
    v_mfma_f32_16x16x32_bf16 a[28:31], v[92:95], v[68:71], a[28:31]
    v_mfma_f32_16x16x32_bf16 a[32:35], v[80:83], v[72:75], a[32:35]
    v_mfma_f32_16x16x32_bf16 a[36:39], v[84:87], v[72:75], a[36:39]
    v_mfma_f32_16x16x32_bf16 a[40:43], v[88:91], v[72:75], a[40:43]
    v_mfma_f32_16x16x32_bf16 a[44:47], v[92:95], v[72:75], a[44:47]
    v_mfma_f32_16x16x32_bf16 a[48:51], v[80:83], v[76:79], a[48:51]
    v_mfma_f32_16x16x32_bf16 a[52:55], v[84:87], v[76:79], a[52:55]
    v_mfma_f32_16x16x32_bf16 a[56:59], v[88:91], v[76:79], a[56:59]
    v_mfma_f32_16x16x32_bf16 a[60:63], v[92:95], v[76:79], a[60:63]
    s_waitcnt lgkmcnt(0)
    v_mfma_f32_16x16x32_bf16 a[0:3], v[112:115], v[96:99], a[0:3]
    v_mfma_f32_16x16x32_bf16 a[4:7], v[116:119], v[96:99], a[4:7]
    v_mfma_f32_16x16x32_bf16 a[8:11], v[120:123], v[96:99], a[8:11]
    v_mfma_f32_16x16x32_bf16 a[12:15], v[124:127], v[96:99], a[12:15]
    v_mfma_f32_16x16x32_bf16 a[16:19], v[112:115], v[100:103], a[16:19]
    v_mfma_f32_16x16x32_bf16 a[20:23], v[116:119], v[100:103], a[20:23]
    v_mfma_f32_16x16x32_bf16 a[24:27], v[120:123], v[100:103], a[24:27]
    v_mfma_f32_16x16x32_bf16 a[28:31], v[124:127], v[100:103], a[28:31]
    v_mfma_f32_16x16x32_bf16 a[32:35], v[112:115], v[104:107], a[32:35]
    v_mfma_f32_16x16x32_bf16 a[36:39], v[116:119], v[104:107], a[36:39]
    v_mfma_f32_16x16x32_bf16 a[40:43], v[120:123], v[104:107], a[40:43]
    v_mfma_f32_16x16x32_bf16 a[44:47], v[124:127], v[104:107], a[44:47]
    v_mfma_f32_16x16x32_bf16 a[48:51], v[112:115], v[108:111], a[48:51]
    v_mfma_f32_16x16x32_bf16 a[52:55], v[116:119], v[108:111], a[52:55]
    v_mfma_f32_16x16x32_bf16 a[56:59], v[120:123], v[108:111], a[56:59]
    v_mfma_f32_16x16x32_bf16 a[60:63], v[124:127], v[108:111], a[60:63]
    s_add_u32 s68, s67, 16384
    s_add_u32 s65, s60, 384
    s_mov_b32 m0, s68
    s_add_u32 s68, s68, 1024
    buffer_load_dwordx4 v6, s[20:23], s65 offen lds
    s_add_u32 s65, s60, 29056
    s_mov_b32 m0, s68
    s_add_u32 s68, s68, 1024
    buffer_load_dwordx4 v6, s[20:23], s65 offen lds
    s_add_u32 s65, s60, 57728
    s_mov_b32 m0, s68
    s_add_u32 s68, s68, 1024
    buffer_load_dwordx4 v6, s[20:23], s65 offen lds
    s_add_u32 s65, s60, 86400
    s_mov_b32 m0, s68
    s_add_u32 s68, s68, 1024
    buffer_load_dwordx4 v6, s[20:23], s65 offen lds
    s_add_u32 s65, s60, 115072
    s_mov_b32 m0, s68
    s_add_u32 s68, s68, 1024
    buffer_load_dwordx4 v6, s[20:23], s65 offen lds
    s_add_u32 s65, s60, 143744
    s_mov_b32 m0, s68
    s_add_u32 s68, s68, 1024
    buffer_load_dwordx4 v6, s[20:23], s65 offen lds
    s_add_u32 s65, s60, 172416
    s_mov_b32 m0, s68
    s_add_u32 s68, s68, 1024
    buffer_load_dwordx4 v6, s[20:23], s65 offen lds
    s_add_u32 s65, s60, 201088
    s_mov_b32 m0, s68
    s_add_u32 s68, s68, 1024
    buffer_load_dwordx4 v6, s[20:23], s65 offen lds
    s_add_u32 s65, s62, 384
    s_mov_b32 m0, s68
    s_add_u32 s68, s68, 1024
    buffer_load_dwordx4 v6, s[24:27], s65 offen lds
    s_add_u32 s65, s62, 29056
    s_mov_b32 m0, s68
    s_add_u32 s68, s68, 1024
    buffer_load_dwordx4 v6, s[24:27], s65 offen lds
    s_add_u32 s65, s62, 57728
    s_mov_b32 m0, s68
    s_add_u32 s68, s68, 1024
    buffer_load_dwordx4 v6, s[24:27], s65 offen lds
    s_add_u32 s65, s62, 86400
    s_mov_b32 m0, s68
    s_add_u32 s68, s68, 1024
    buffer_load_dwordx4 v6, s[24:27], s65 offen lds
    s_add_u32 s65, s62, 115072
    s_mov_b32 m0, s68
    s_add_u32 s68, s68, 1024
    buffer_load_dwordx4 v6, s[24:27], s65 offen lds
    s_add_u32 s65, s62, 143744
    s_mov_b32 m0, s68
    s_add_u32 s68, s68, 1024
    buffer_load_dwordx4 v6, s[24:27], s65 offen lds
    s_add_u32 s65, s62, 172416
    s_mov_b32 m0, s68
    s_add_u32 s68, s68, 1024
    buffer_load_dwordx4 v6, s[24:27], s65 offen lds
    s_add_u32 s65, s62, 201088
    s_mov_b32 m0, s68
    s_add_u32 s68, s68, 1024
    buffer_load_dwordx4 v6, s[24:27], s65 offen lds
    s_waitcnt vmcnt(16)
    ds_read_b128 v[64:67], v13 offset:0
    ds_read_b128 v[80:83], v13 offset:8192
    ds_read_b128 v[68:71], v13 offset:2048
    ds_read_b128 v[84:87], v13 offset:10240
    ds_read_b128 v[72:75], v13 offset:4096
    ds_read_b128 v[88:91], v13 offset:12288
    ds_read_b128 v[76:79], v13 offset:6144
    ds_read_b128 v[92:95], v13 offset:14336
    ds_read_b128 v[96:99], v14 offset:0
    ds_read_b128 v[112:115], v14 offset:8192
    ds_read_b128 v[100:103], v14 offset:2048
    ds_read_b128 v[116:119], v14 offset:10240
    ds_read_b128 v[104:107], v14 offset:4096
    ds_read_b128 v[120:123], v14 offset:12288
    ds_read_b128 v[108:111], v14 offset:6144
    ds_read_b128 v[124:127], v14 offset:14336
    s_waitcnt lgkmcnt(8)
    v_mfma_f32_16x16x32_bf16 a[0:3], v[80:83], v[64:67], a[0:3]
    v_mfma_f32_16x16x32_bf16 a[4:7], v[84:87], v[64:67], a[4:7]
    v_mfma_f32_16x16x32_bf16 a[8:11], v[88:91], v[64:67], a[8:11]
    v_mfma_f32_16x16x32_bf16 a[12:15], v[92:95], v[64:67], a[12:15]
    v_mfma_f32_16x16x32_bf16 a[16:19], v[80:83], v[68:71], a[16:19]
    v_mfma_f32_16x16x32_bf16 a[20:23], v[84:87], v[68:71], a[20:23]
    v_mfma_f32_16x16x32_bf16 a[24:27], v[88:91], v[68:71], a[24:27]
    v_mfma_f32_16x16x32_bf16 a[28:31], v[92:95], v[68:71], a[28:31]
    v_mfma_f32_16x16x32_bf16 a[32:35], v[80:83], v[72:75], a[32:35]
    v_mfma_f32_16x16x32_bf16 a[36:39], v[84:87], v[72:75], a[36:39]
    v_mfma_f32_16x16x32_bf16 a[40:43], v[88:91], v[72:75], a[40:43]
    v_mfma_f32_16x16x32_bf16 a[44:47], v[92:95], v[72:75], a[44:47]
    v_mfma_f32_16x16x32_bf16 a[48:51], v[80:83], v[76:79], a[48:51]
    v_mfma_f32_16x16x32_bf16 a[52:55], v[84:87], v[76:79], a[52:55]
    v_mfma_f32_16x16x32_bf16 a[56:59], v[88:91], v[76:79], a[56:59]
    v_mfma_f32_16x16x32_bf16 a[60:63], v[92:95], v[76:79], a[60:63]
    s_waitcnt lgkmcnt(0)
    v_mfma_f32_16x16x32_bf16 a[0:3], v[112:115], v[96:99], a[0:3]
    v_mfma_f32_16x16x32_bf16 a[4:7], v[116:119], v[96:99], a[4:7]
    v_mfma_f32_16x16x32_bf16 a[8:11], v[120:123], v[96:99], a[8:11]
    v_mfma_f32_16x16x32_bf16 a[12:15], v[124:127], v[96:99], a[12:15]
    v_mfma_f32_16x16x32_bf16 a[16:19], v[112:115], v[100:103], a[16:19]
    v_mfma_f32_16x16x32_bf16 a[20:23], v[116:119], v[100:103], a[20:23]
    v_mfma_f32_16x16x32_bf16 a[24:27], v[120:123], v[100:103], a[24:27]
    v_mfma_f32_16x16x32_bf16 a[28:31], v[124:127], v[100:103], a[28:31]
    v_mfma_f32_16x16x32_bf16 a[32:35], v[112:115], v[104:107], a[32:35]
    v_mfma_f32_16x16x32_bf16 a[36:39], v[116:119], v[104:107], a[36:39]
    v_mfma_f32_16x16x32_bf16 a[40:43], v[120:123], v[104:107], a[40:43]
    v_mfma_f32_16x16x32_bf16 a[44:47], v[124:127], v[104:107], a[44:47]
    v_mfma_f32_16x16x32_bf16 a[48:51], v[112:115], v[108:111], a[48:51]
    v_mfma_f32_16x16x32_bf16 a[52:55], v[116:119], v[108:111], a[52:55]
    v_mfma_f32_16x16x32_bf16 a[56:59], v[120:123], v[108:111], a[56:59]
    v_mfma_f32_16x16x32_bf16 a[60:63], v[124:127], v[108:111], a[60:63]
    s_add_u32 s68, s67, 0
    s_add_u32 s65, s60, 512
    s_mov_b32 m0, s68
    s_add_u32 s68, s68, 1024
    buffer_load_dwordx4 v6, s[20:23], s65 offen lds
    s_add_u32 s65, s60, 29184
    s_mov_b32 m0, s68
    s_add_u32 s68, s68, 1024
    buffer_load_dwordx4 v6, s[20:23], s65 offen lds
    s_add_u32 s65, s60, 57856
    s_mov_b32 m0, s68
    s_add_u32 s68, s68, 1024
    buffer_load_dwordx4 v6, s[20:23], s65 offen lds
    s_add_u32 s65, s60, 86528
    s_mov_b32 m0, s68
    s_add_u32 s68, s68, 1024
    buffer_load_dwordx4 v6, s[20:23], s65 offen lds
    s_add_u32 s65, s60, 115200
    s_mov_b32 m0, s68
    s_add_u32 s68, s68, 1024
    buffer_load_dwordx4 v6, s[20:23], s65 offen lds
    s_add_u32 s65, s60, 143872
    s_mov_b32 m0, s68
    s_add_u32 s68, s68, 1024
    buffer_load_dwordx4 v6, s[20:23], s65 offen lds
    s_add_u32 s65, s60, 172544
    s_mov_b32 m0, s68
    s_add_u32 s68, s68, 1024
    buffer_load_dwordx4 v6, s[20:23], s65 offen lds
    s_add_u32 s65, s60, 201216
    s_mov_b32 m0, s68
    s_add_u32 s68, s68, 1024
    buffer_load_dwordx4 v6, s[20:23], s65 offen lds
    s_add_u32 s65, s62, 512
    s_mov_b32 m0, s68
    s_add_u32 s68, s68, 1024
    buffer_load_dwordx4 v6, s[24:27], s65 offen lds
    s_add_u32 s65, s62, 29184
    s_mov_b32 m0, s68
    s_add_u32 s68, s68, 1024
    buffer_load_dwordx4 v6, s[24:27], s65 offen lds
    s_add_u32 s65, s62, 57856
    s_mov_b32 m0, s68
    s_add_u32 s68, s68, 1024
    buffer_load_dwordx4 v6, s[24:27], s65 offen lds
    s_add_u32 s65, s62, 86528
    s_mov_b32 m0, s68
    s_add_u32 s68, s68, 1024
    buffer_load_dwordx4 v6, s[24:27], s65 offen lds
    s_add_u32 s65, s62, 115200
    s_mov_b32 m0, s68
    s_add_u32 s68, s68, 1024
    buffer_load_dwordx4 v6, s[24:27], s65 offen lds
    s_add_u32 s65, s62, 143872
    s_mov_b32 m0, s68
    s_add_u32 s68, s68, 1024
    buffer_load_dwordx4 v6, s[24:27], s65 offen lds
    s_add_u32 s65, s62, 172544
    s_mov_b32 m0, s68
    s_add_u32 s68, s68, 1024
    buffer_load_dwordx4 v6, s[24:27], s65 offen lds
    s_add_u32 s65, s62, 201216
    s_mov_b32 m0, s68
    s_add_u32 s68, s68, 1024
    buffer_load_dwordx4 v6, s[24:27], s65 offen lds
    s_waitcnt vmcnt(16)
    ds_read_b128 v[64:67], v13 offset:16384
    ds_read_b128 v[80:83], v13 offset:24576
    ds_read_b128 v[68:71], v13 offset:18432
    ds_read_b128 v[84:87], v13 offset:26624
    ds_read_b128 v[72:75], v13 offset:20480
    ds_read_b128 v[88:91], v13 offset:28672
    ds_read_b128 v[76:79], v13 offset:22528
    ds_read_b128 v[92:95], v13 offset:30720
    ds_read_b128 v[96:99], v14 offset:16384
    ds_read_b128 v[112:115], v14 offset:24576
    ds_read_b128 v[100:103], v14 offset:18432
    ds_read_b128 v[116:119], v14 offset:26624
    ds_read_b128 v[104:107], v14 offset:20480
    ds_read_b128 v[120:123], v14 offset:28672
    ds_read_b128 v[108:111], v14 offset:22528
    ds_read_b128 v[124:127], v14 offset:30720
    s_waitcnt lgkmcnt(8)
    v_mfma_f32_16x16x32_bf16 a[0:3], v[80:83], v[64:67], a[0:3]
    v_mfma_f32_16x16x32_bf16 a[4:7], v[84:87], v[64:67], a[4:7]
    v_mfma_f32_16x16x32_bf16 a[8:11], v[88:91], v[64:67], a[8:11]
    v_mfma_f32_16x16x32_bf16 a[12:15], v[92:95], v[64:67], a[12:15]
    v_mfma_f32_16x16x32_bf16 a[16:19], v[80:83], v[68:71], a[16:19]
    v_mfma_f32_16x16x32_bf16 a[20:23], v[84:87], v[68:71], a[20:23]
    v_mfma_f32_16x16x32_bf16 a[24:27], v[88:91], v[68:71], a[24:27]
    v_mfma_f32_16x16x32_bf16 a[28:31], v[92:95], v[68:71], a[28:31]
    v_mfma_f32_16x16x32_bf16 a[32:35], v[80:83], v[72:75], a[32:35]
    v_mfma_f32_16x16x32_bf16 a[36:39], v[84:87], v[72:75], a[36:39]
    v_mfma_f32_16x16x32_bf16 a[40:43], v[88:91], v[72:75], a[40:43]
    v_mfma_f32_16x16x32_bf16 a[44:47], v[92:95], v[72:75], a[44:47]
    v_mfma_f32_16x16x32_bf16 a[48:51], v[80:83], v[76:79], a[48:51]
    v_mfma_f32_16x16x32_bf16 a[52:55], v[84:87], v[76:79], a[52:55]
    v_mfma_f32_16x16x32_bf16 a[56:59], v[88:91], v[76:79], a[56:59]
    v_mfma_f32_16x16x32_bf16 a[60:63], v[92:95], v[76:79], a[60:63]
    s_waitcnt lgkmcnt(0)
    v_mfma_f32_16x16x32_bf16 a[0:3], v[112:115], v[96:99], a[0:3]
    v_mfma_f32_16x16x32_bf16 a[4:7], v[116:119], v[96:99], a[4:7]
    v_mfma_f32_16x16x32_bf16 a[8:11], v[120:123], v[96:99], a[8:11]
    v_mfma_f32_16x16x32_bf16 a[12:15], v[124:127], v[96:99], a[12:15]
    v_mfma_f32_16x16x32_bf16 a[16:19], v[112:115], v[100:103], a[16:19]
    v_mfma_f32_16x16x32_bf16 a[20:23], v[116:119], v[100:103], a[20:23]
    v_mfma_f32_16x16x32_bf16 a[24:27], v[120:123], v[100:103], a[24:27]
    v_mfma_f32_16x16x32_bf16 a[28:31], v[124:127], v[100:103], a[28:31]
    v_mfma_f32_16x16x32_bf16 a[32:35], v[112:115], v[104:107], a[32:35]
    v_mfma_f32_16x16x32_bf16 a[36:39], v[116:119], v[104:107], a[36:39]
    v_mfma_f32_16x16x32_bf16 a[40:43], v[120:123], v[104:107], a[40:43]
    v_mfma_f32_16x16x32_bf16 a[44:47], v[124:127], v[104:107], a[44:47]
    v_mfma_f32_16x16x32_bf16 a[48:51], v[112:115], v[108:111], a[48:51]
    v_mfma_f32_16x16x32_bf16 a[52:55], v[116:119], v[108:111], a[52:55]
    v_mfma_f32_16x16x32_bf16 a[56:59], v[120:123], v[108:111], a[56:59]
    v_mfma_f32_16x16x32_bf16 a[60:63], v[124:127], v[108:111], a[60:63]
    s_add_u32 s68, s67, 16384
    s_add_u32 s65, s60, 640
    s_mov_b32 m0, s68
    s_add_u32 s68, s68, 1024
    buffer_load_dwordx4 v6, s[20:23], s65 offen lds
    s_add_u32 s65, s60, 29312
    s_mov_b32 m0, s68
    s_add_u32 s68, s68, 1024
    buffer_load_dwordx4 v6, s[20:23], s65 offen lds
    s_add_u32 s65, s60, 57984
    s_mov_b32 m0, s68
    s_add_u32 s68, s68, 1024
    buffer_load_dwordx4 v6, s[20:23], s65 offen lds
    s_add_u32 s65, s60, 86656
    s_mov_b32 m0, s68
    s_add_u32 s68, s68, 1024
    buffer_load_dwordx4 v6, s[20:23], s65 offen lds
    s_add_u32 s65, s60, 115328
    s_mov_b32 m0, s68
    s_add_u32 s68, s68, 1024
    buffer_load_dwordx4 v6, s[20:23], s65 offen lds
    s_add_u32 s65, s60, 144000
    s_mov_b32 m0, s68
    s_add_u32 s68, s68, 1024
    buffer_load_dwordx4 v6, s[20:23], s65 offen lds
    s_add_u32 s65, s60, 172672
    s_mov_b32 m0, s68
    s_add_u32 s68, s68, 1024
    buffer_load_dwordx4 v6, s[20:23], s65 offen lds
    s_add_u32 s65, s60, 201344
    s_mov_b32 m0, s68
    s_add_u32 s68, s68, 1024
    buffer_load_dwordx4 v6, s[20:23], s65 offen lds
    s_add_u32 s65, s62, 640
    s_mov_b32 m0, s68
    s_add_u32 s68, s68, 1024
    buffer_load_dwordx4 v6, s[24:27], s65 offen lds
    s_add_u32 s65, s62, 29312
    s_mov_b32 m0, s68
    s_add_u32 s68, s68, 1024
    buffer_load_dwordx4 v6, s[24:27], s65 offen lds
    s_add_u32 s65, s62, 57984
    s_mov_b32 m0, s68
    s_add_u32 s68, s68, 1024
    buffer_load_dwordx4 v6, s[24:27], s65 offen lds
    s_add_u32 s65, s62, 86656
    s_mov_b32 m0, s68
    s_add_u32 s68, s68, 1024
    buffer_load_dwordx4 v6, s[24:27], s65 offen lds
    s_add_u32 s65, s62, 115328
    s_mov_b32 m0, s68
    s_add_u32 s68, s68, 1024
    buffer_load_dwordx4 v6, s[24:27], s65 offen lds
    s_add_u32 s65, s62, 144000
    s_mov_b32 m0, s68
    s_add_u32 s68, s68, 1024
    buffer_load_dwordx4 v6, s[24:27], s65 offen lds
    s_add_u32 s65, s62, 172672
    s_mov_b32 m0, s68
    s_add_u32 s68, s68, 1024
    buffer_load_dwordx4 v6, s[24:27], s65 offen lds
    s_add_u32 s65, s62, 201344
    s_mov_b32 m0, s68
    s_add_u32 s68, s68, 1024
    buffer_load_dwordx4 v6, s[24:27], s65 offen lds
    s_waitcnt vmcnt(16)
    ds_read_b128 v[64:67], v13 offset:0
    ds_read_b128 v[80:83], v13 offset:8192
    ds_read_b128 v[68:71], v13 offset:2048
    ds_read_b128 v[84:87], v13 offset:10240
    ds_read_b128 v[72:75], v13 offset:4096
    ds_read_b128 v[88:91], v13 offset:12288
    ds_read_b128 v[76:79], v13 offset:6144
    ds_read_b128 v[92:95], v13 offset:14336
    ds_read_b128 v[96:99], v14 offset:0
    ds_read_b128 v[112:115], v14 offset:8192
    ds_read_b128 v[100:103], v14 offset:2048
    ds_read_b128 v[116:119], v14 offset:10240
    ds_read_b128 v[104:107], v14 offset:4096
    ds_read_b128 v[120:123], v14 offset:12288
    ds_read_b128 v[108:111], v14 offset:6144
    ds_read_b128 v[124:127], v14 offset:14336
    s_waitcnt lgkmcnt(8)
    v_mfma_f32_16x16x32_bf16 a[0:3], v[80:83], v[64:67], a[0:3]
    v_mfma_f32_16x16x32_bf16 a[4:7], v[84:87], v[64:67], a[4:7]
    v_mfma_f32_16x16x32_bf16 a[8:11], v[88:91], v[64:67], a[8:11]
    v_mfma_f32_16x16x32_bf16 a[12:15], v[92:95], v[64:67], a[12:15]
    v_mfma_f32_16x16x32_bf16 a[16:19], v[80:83], v[68:71], a[16:19]
    v_mfma_f32_16x16x32_bf16 a[20:23], v[84:87], v[68:71], a[20:23]
    v_mfma_f32_16x16x32_bf16 a[24:27], v[88:91], v[68:71], a[24:27]
    v_mfma_f32_16x16x32_bf16 a[28:31], v[92:95], v[68:71], a[28:31]
    v_mfma_f32_16x16x32_bf16 a[32:35], v[80:83], v[72:75], a[32:35]
    v_mfma_f32_16x16x32_bf16 a[36:39], v[84:87], v[72:75], a[36:39]
    v_mfma_f32_16x16x32_bf16 a[40:43], v[88:91], v[72:75], a[40:43]
    v_mfma_f32_16x16x32_bf16 a[44:47], v[92:95], v[72:75], a[44:47]
    v_mfma_f32_16x16x32_bf16 a[48:51], v[80:83], v[76:79], a[48:51]
    v_mfma_f32_16x16x32_bf16 a[52:55], v[84:87], v[76:79], a[52:55]
    v_mfma_f32_16x16x32_bf16 a[56:59], v[88:91], v[76:79], a[56:59]
    v_mfma_f32_16x16x32_bf16 a[60:63], v[92:95], v[76:79], a[60:63]
    s_waitcnt lgkmcnt(0)
    v_mfma_f32_16x16x32_bf16 a[0:3], v[112:115], v[96:99], a[0:3]
    v_mfma_f32_16x16x32_bf16 a[4:7], v[116:119], v[96:99], a[4:7]
    v_mfma_f32_16x16x32_bf16 a[8:11], v[120:123], v[96:99], a[8:11]
    v_mfma_f32_16x16x32_bf16 a[12:15], v[124:127], v[96:99], a[12:15]
    v_mfma_f32_16x16x32_bf16 a[16:19], v[112:115], v[100:103], a[16:19]
    v_mfma_f32_16x16x32_bf16 a[20:23], v[116:119], v[100:103], a[20:23]
    v_mfma_f32_16x16x32_bf16 a[24:27], v[120:123], v[100:103], a[24:27]
    v_mfma_f32_16x16x32_bf16 a[28:31], v[124:127], v[100:103], a[28:31]
    v_mfma_f32_16x16x32_bf16 a[32:35], v[112:115], v[104:107], a[32:35]
    v_mfma_f32_16x16x32_bf16 a[36:39], v[116:119], v[104:107], a[36:39]
    v_mfma_f32_16x16x32_bf16 a[40:43], v[120:123], v[104:107], a[40:43]
    v_mfma_f32_16x16x32_bf16 a[44:47], v[124:127], v[104:107], a[44:47]
    v_mfma_f32_16x16x32_bf16 a[48:51], v[112:115], v[108:111], a[48:51]
    v_mfma_f32_16x16x32_bf16 a[52:55], v[116:119], v[108:111], a[52:55]
    v_mfma_f32_16x16x32_bf16 a[56:59], v[120:123], v[108:111], a[56:59]
    v_mfma_f32_16x16x32_bf16 a[60:63], v[124:127], v[108:111], a[60:63]
    s_add_u32 s68, s67, 0
    s_add_u32 s65, s60, 768
    s_mov_b32 m0, s68
    s_add_u32 s68, s68, 1024
    buffer_load_dwordx4 v6, s[20:23], s65 offen lds
    s_add_u32 s65, s60, 29440
    s_mov_b32 m0, s68
    s_add_u32 s68, s68, 1024
    buffer_load_dwordx4 v6, s[20:23], s65 offen lds
    s_add_u32 s65, s60, 58112
    s_mov_b32 m0, s68
    s_add_u32 s68, s68, 1024
    buffer_load_dwordx4 v6, s[20:23], s65 offen lds
    s_add_u32 s65, s60, 86784
    s_mov_b32 m0, s68
    s_add_u32 s68, s68, 1024
    buffer_load_dwordx4 v6, s[20:23], s65 offen lds
    s_add_u32 s65, s60, 115456
    s_mov_b32 m0, s68
    s_add_u32 s68, s68, 1024
    buffer_load_dwordx4 v6, s[20:23], s65 offen lds
    s_add_u32 s65, s60, 144128
    s_mov_b32 m0, s68
    s_add_u32 s68, s68, 1024
    buffer_load_dwordx4 v6, s[20:23], s65 offen lds
    s_add_u32 s65, s60, 172800
    s_mov_b32 m0, s68
    s_add_u32 s68, s68, 1024
    buffer_load_dwordx4 v6, s[20:23], s65 offen lds
    s_add_u32 s65, s60, 201472
    s_mov_b32 m0, s68
    s_add_u32 s68, s68, 1024
    buffer_load_dwordx4 v6, s[20:23], s65 offen lds
    s_add_u32 s65, s62, 768
    s_mov_b32 m0, s68
    s_add_u32 s68, s68, 1024
    buffer_load_dwordx4 v6, s[24:27], s65 offen lds
    s_add_u32 s65, s62, 29440
    s_mov_b32 m0, s68
    s_add_u32 s68, s68, 1024
    buffer_load_dwordx4 v6, s[24:27], s65 offen lds
    s_add_u32 s65, s62, 58112
    s_mov_b32 m0, s68
    s_add_u32 s68, s68, 1024
    buffer_load_dwordx4 v6, s[24:27], s65 offen lds
    s_add_u32 s65, s62, 86784
    s_mov_b32 m0, s68
    s_add_u32 s68, s68, 1024
    buffer_load_dwordx4 v6, s[24:27], s65 offen lds
    s_add_u32 s65, s62, 115456
    s_mov_b32 m0, s68
    s_add_u32 s68, s68, 1024
    buffer_load_dwordx4 v6, s[24:27], s65 offen lds
    s_add_u32 s65, s62, 144128
    s_mov_b32 m0, s68
    s_add_u32 s68, s68, 1024
    buffer_load_dwordx4 v6, s[24:27], s65 offen lds
    s_add_u32 s65, s62, 172800
    s_mov_b32 m0, s68
    s_add_u32 s68, s68, 1024
    buffer_load_dwordx4 v6, s[24:27], s65 offen lds
    s_add_u32 s65, s62, 201472
    s_mov_b32 m0, s68
    s_add_u32 s68, s68, 1024
    buffer_load_dwordx4 v6, s[24:27], s65 offen lds
    s_waitcnt vmcnt(16)
    ds_read_b128 v[64:67], v13 offset:16384
    ds_read_b128 v[80:83], v13 offset:24576
    ds_read_b128 v[68:71], v13 offset:18432
    ds_read_b128 v[84:87], v13 offset:26624
    ds_read_b128 v[72:75], v13 offset:20480
    ds_read_b128 v[88:91], v13 offset:28672
    ds_read_b128 v[76:79], v13 offset:22528
    ds_read_b128 v[92:95], v13 offset:30720
    ds_read_b128 v[96:99], v14 offset:16384
    ds_read_b128 v[112:115], v14 offset:24576
    ds_read_b128 v[100:103], v14 offset:18432
    ds_read_b128 v[116:119], v14 offset:26624
    ds_read_b128 v[104:107], v14 offset:20480
    ds_read_b128 v[120:123], v14 offset:28672
    ds_read_b128 v[108:111], v14 offset:22528
    ds_read_b128 v[124:127], v14 offset:30720
    s_waitcnt lgkmcnt(8)
    v_mfma_f32_16x16x32_bf16 a[0:3], v[80:83], v[64:67], a[0:3]
    v_mfma_f32_16x16x32_bf16 a[4:7], v[84:87], v[64:67], a[4:7]
    v_mfma_f32_16x16x32_bf16 a[8:11], v[88:91], v[64:67], a[8:11]
    v_mfma_f32_16x16x32_bf16 a[12:15], v[92:95], v[64:67], a[12:15]
    v_mfma_f32_16x16x32_bf16 a[16:19], v[80:83], v[68:71], a[16:19]
    v_mfma_f32_16x16x32_bf16 a[20:23], v[84:87], v[68:71], a[20:23]
    v_mfma_f32_16x16x32_bf16 a[24:27], v[88:91], v[68:71], a[24:27]
    v_mfma_f32_16x16x32_bf16 a[28:31], v[92:95], v[68:71], a[28:31]
    v_mfma_f32_16x16x32_bf16 a[32:35], v[80:83], v[72:75], a[32:35]
    v_mfma_f32_16x16x32_bf16 a[36:39], v[84:87], v[72:75], a[36:39]
    v_mfma_f32_16x16x32_bf16 a[40:43], v[88:91], v[72:75], a[40:43]
    v_mfma_f32_16x16x32_bf16 a[44:47], v[92:95], v[72:75], a[44:47]
    v_mfma_f32_16x16x32_bf16 a[48:51], v[80:83], v[76:79], a[48:51]
    v_mfma_f32_16x16x32_bf16 a[52:55], v[84:87], v[76:79], a[52:55]
    v_mfma_f32_16x16x32_bf16 a[56:59], v[88:91], v[76:79], a[56:59]
    v_mfma_f32_16x16x32_bf16 a[60:63], v[92:95], v[76:79], a[60:63]
    s_waitcnt lgkmcnt(0)
    v_mfma_f32_16x16x32_bf16 a[0:3], v[112:115], v[96:99], a[0:3]
    v_mfma_f32_16x16x32_bf16 a[4:7], v[116:119], v[96:99], a[4:7]
    v_mfma_f32_16x16x32_bf16 a[8:11], v[120:123], v[96:99], a[8:11]
    v_mfma_f32_16x16x32_bf16 a[12:15], v[124:127], v[96:99], a[12:15]
    v_mfma_f32_16x16x32_bf16 a[16:19], v[112:115], v[100:103], a[16:19]
    v_mfma_f32_16x16x32_bf16 a[20:23], v[116:119], v[100:103], a[20:23]
    v_mfma_f32_16x16x32_bf16 a[24:27], v[120:123], v[100:103], a[24:27]
    v_mfma_f32_16x16x32_bf16 a[28:31], v[124:127], v[100:103], a[28:31]
    v_mfma_f32_16x16x32_bf16 a[32:35], v[112:115], v[104:107], a[32:35]
    v_mfma_f32_16x16x32_bf16 a[36:39], v[116:119], v[104:107], a[36:39]
    v_mfma_f32_16x16x32_bf16 a[40:43], v[120:123], v[104:107], a[40:43]
    v_mfma_f32_16x16x32_bf16 a[44:47], v[124:127], v[104:107], a[44:47]
    v_mfma_f32_16x16x32_bf16 a[48:51], v[112:115], v[108:111], a[48:51]
    v_mfma_f32_16x16x32_bf16 a[52:55], v[116:119], v[108:111], a[52:55]
    v_mfma_f32_16x16x32_bf16 a[56:59], v[120:123], v[108:111], a[56:59]
    v_mfma_f32_16x16x32_bf16 a[60:63], v[124:127], v[108:111], a[60:63]
    s_add_u32 s68, s67, 16384
    s_add_u32 s65, s63, 0
    s_mov_b32 m0, s68
    s_add_u32 s68, s68, 1024
    buffer_load_dwordx4 v7, s[28:31], s65 offen lds
    s_add_u32 s65, s63, 16384
    s_mov_b32 m0, s68
    s_add_u32 s68, s68, 1024
    buffer_load_dwordx4 v7, s[28:31], s65 offen lds
    s_add_u32 s65, s63, 32768
    s_mov_b32 m0, s68
    s_add_u32 s68, s68, 1024
    buffer_load_dwordx4 v7, s[28:31], s65 offen lds
    s_add_u32 s65, s63, 49152
    s_mov_b32 m0, s68
    s_add_u32 s68, s68, 1024
    buffer_load_dwordx4 v7, s[28:31], s65 offen lds
    s_add_u32 s65, s63, 65536
    s_mov_b32 m0, s68
    s_add_u32 s68, s68, 1024
    buffer_load_dwordx4 v7, s[28:31], s65 offen lds
    s_add_u32 s65, s63, 81920
    s_mov_b32 m0, s68
    s_add_u32 s68, s68, 1024
    buffer_load_dwordx4 v7, s[28:31], s65 offen lds
    s_add_u32 s65, s63, 98304
    s_mov_b32 m0, s68
    s_add_u32 s68, s68, 1024
    buffer_load_dwordx4 v7, s[28:31], s65 offen lds
    s_add_u32 s65, s63, 114688
    s_mov_b32 m0, s68
    s_add_u32 s68, s68, 1024
    buffer_load_dwordx4 v7, s[28:31], s65 offen lds
    s_add_u32 s65, s64, 0
    s_mov_b32 m0, s68
    s_add_u32 s68, s68, 1024
    buffer_load_dwordx4 v8, s[32:35], s65 offen lds
    s_add_u32 s65, s64, 8192
    s_mov_b32 m0, s68
    s_add_u32 s68, s68, 1024
    buffer_load_dwordx4 v8, s[32:35], s65 offen lds
    s_add_u32 s65, s64, 16384
    s_mov_b32 m0, s68
    s_add_u32 s68, s68, 1024
    buffer_load_dwordx4 v8, s[32:35], s65 offen lds
    s_add_u32 s65, s64, 24576
    s_mov_b32 m0, s68
    s_add_u32 s68, s68, 1024
    buffer_load_dwordx4 v8, s[32:35], s65 offen lds
    s_add_u32 s65, s64, 32768
    s_mov_b32 m0, s68
    s_add_u32 s68, s68, 1024
    buffer_load_dwordx4 v8, s[32:35], s65 offen lds
    s_add_u32 s65, s64, 40960
    s_mov_b32 m0, s68
    s_add_u32 s68, s68, 1024
    buffer_load_dwordx4 v8, s[32:35], s65 offen lds
    s_add_u32 s65, s64, 49152
    s_mov_b32 m0, s68
    s_add_u32 s68, s68, 1024
    buffer_load_dwordx4 v8, s[32:35], s65 offen lds
    s_add_u32 s65, s64, 57344
    s_mov_b32 m0, s68
    s_add_u32 s68, s68, 1024
    buffer_load_dwordx4 v8, s[32:35], s65 offen lds
    s_waitcnt vmcnt(16)
    ds_read_b128 v[64:67], v13 offset:0
    ds_read_b128 v[80:83], v13 offset:8192
    ds_read_b128 v[68:71], v13 offset:2048
    ds_read_b128 v[84:87], v13 offset:10240
    ds_read_b128 v[72:75], v13 offset:4096
    ds_read_b128 v[88:91], v13 offset:12288
    ds_read_b128 v[76:79], v13 offset:6144
    ds_read_b128 v[92:95], v13 offset:14336
    ds_read_b128 v[96:99], v14 offset:0
    ds_read_b128 v[112:115], v14 offset:8192
    ds_read_b128 v[100:103], v14 offset:2048
    ds_read_b128 v[116:119], v14 offset:10240
    ds_read_b128 v[104:107], v14 offset:4096
    ds_read_b128 v[120:123], v14 offset:12288
    ds_read_b128 v[108:111], v14 offset:6144
    ds_read_b128 v[124:127], v14 offset:14336
    s_waitcnt lgkmcnt(8)
    v_mfma_f32_16x16x32_bf16 a[0:3], v[80:83], v[64:67], a[0:3]
    v_mfma_f32_16x16x32_bf16 a[4:7], v[84:87], v[64:67], a[4:7]
    v_mfma_f32_16x16x32_bf16 a[8:11], v[88:91], v[64:67], a[8:11]
    v_mfma_f32_16x16x32_bf16 a[12:15], v[92:95], v[64:67], a[12:15]
    v_mfma_f32_16x16x32_bf16 a[16:19], v[80:83], v[68:71], a[16:19]
    v_mfma_f32_16x16x32_bf16 a[20:23], v[84:87], v[68:71], a[20:23]
    v_mfma_f32_16x16x32_bf16 a[24:27], v[88:91], v[68:71], a[24:27]
    v_mfma_f32_16x16x32_bf16 a[28:31], v[92:95], v[68:71], a[28:31]
    v_mfma_f32_16x16x32_bf16 a[32:35], v[80:83], v[72:75], a[32:35]
    v_mfma_f32_16x16x32_bf16 a[36:39], v[84:87], v[72:75], a[36:39]
    v_mfma_f32_16x16x32_bf16 a[40:43], v[88:91], v[72:75], a[40:43]
    v_mfma_f32_16x16x32_bf16 a[44:47], v[92:95], v[72:75], a[44:47]
    v_mfma_f32_16x16x32_bf16 a[48:51], v[80:83], v[76:79], a[48:51]
    v_mfma_f32_16x16x32_bf16 a[52:55], v[84:87], v[76:79], a[52:55]
    v_mfma_f32_16x16x32_bf16 a[56:59], v[88:91], v[76:79], a[56:59]
    v_mfma_f32_16x16x32_bf16 a[60:63], v[92:95], v[76:79], a[60:63]
    s_waitcnt lgkmcnt(0)
    v_mfma_f32_16x16x32_bf16 a[0:3], v[112:115], v[96:99], a[0:3]
    v_mfma_f32_16x16x32_bf16 a[4:7], v[116:119], v[96:99], a[4:7]
    v_mfma_f32_16x16x32_bf16 a[8:11], v[120:123], v[96:99], a[8:11]
    v_mfma_f32_16x16x32_bf16 a[12:15], v[124:127], v[96:99], a[12:15]
    v_mfma_f32_16x16x32_bf16 a[16:19], v[112:115], v[100:103], a[16:19]
    v_mfma_f32_16x16x32_bf16 a[20:23], v[116:119], v[100:103], a[20:23]
    v_mfma_f32_16x16x32_bf16 a[24:27], v[120:123], v[100:103], a[24:27]
    v_mfma_f32_16x16x32_bf16 a[28:31], v[124:127], v[100:103], a[28:31]
    v_mfma_f32_16x16x32_bf16 a[32:35], v[112:115], v[104:107], a[32:35]
    v_mfma_f32_16x16x32_bf16 a[36:39], v[116:119], v[104:107], a[36:39]
    v_mfma_f32_16x16x32_bf16 a[40:43], v[120:123], v[104:107], a[40:43]
    v_mfma_f32_16x16x32_bf16 a[44:47], v[124:127], v[104:107], a[44:47]
    v_mfma_f32_16x16x32_bf16 a[48:51], v[112:115], v[108:111], a[48:51]
    v_mfma_f32_16x16x32_bf16 a[52:55], v[116:119], v[108:111], a[52:55]
    v_mfma_f32_16x16x32_bf16 a[56:59], v[120:123], v[108:111], a[56:59]
    v_mfma_f32_16x16x32_bf16 a[60:63], v[124:127], v[108:111], a[60:63]
    s_add_u32 s68, s67, 0
    s_add_u32 s65, s63, 128
    s_mov_b32 m0, s68
    s_add_u32 s68, s68, 1024
    buffer_load_dwordx4 v7, s[28:31], s65 offen lds
    s_add_u32 s65, s63, 16512
    s_mov_b32 m0, s68
    s_add_u32 s68, s68, 1024
    buffer_load_dwordx4 v7, s[28:31], s65 offen lds
    s_add_u32 s65, s63, 32896
    s_mov_b32 m0, s68
    s_add_u32 s68, s68, 1024
    buffer_load_dwordx4 v7, s[28:31], s65 offen lds
    s_add_u32 s65, s63, 49280
    s_mov_b32 m0, s68
    s_add_u32 s68, s68, 1024
    buffer_load_dwordx4 v7, s[28:31], s65 offen lds
    s_add_u32 s65, s63, 65664
    s_mov_b32 m0, s68
    s_add_u32 s68, s68, 1024
    buffer_load_dwordx4 v7, s[28:31], s65 offen lds
    s_add_u32 s65, s63, 82048
    s_mov_b32 m0, s68
    s_add_u32 s68, s68, 1024
    buffer_load_dwordx4 v7, s[28:31], s65 offen lds
    s_add_u32 s65, s63, 98432
    s_mov_b32 m0, s68
    s_add_u32 s68, s68, 1024
    buffer_load_dwordx4 v7, s[28:31], s65 offen lds
    s_add_u32 s65, s63, 114816
    s_mov_b32 m0, s68
    s_add_u32 s68, s68, 1024
    buffer_load_dwordx4 v7, s[28:31], s65 offen lds
    s_add_u32 s65, s64, 128
    s_mov_b32 m0, s68
    s_add_u32 s68, s68, 1024
    buffer_load_dwordx4 v8, s[32:35], s65 offen lds
    s_add_u32 s65, s64, 8320
    s_mov_b32 m0, s68
    s_add_u32 s68, s68, 1024
    buffer_load_dwordx4 v8, s[32:35], s65 offen lds
    s_add_u32 s65, s64, 16512
    s_mov_b32 m0, s68
    s_add_u32 s68, s68, 1024
    buffer_load_dwordx4 v8, s[32:35], s65 offen lds
    s_add_u32 s65, s64, 24704
    s_mov_b32 m0, s68
    s_add_u32 s68, s68, 1024
    buffer_load_dwordx4 v8, s[32:35], s65 offen lds
    s_add_u32 s65, s64, 32896
    s_mov_b32 m0, s68
    s_add_u32 s68, s68, 1024
    buffer_load_dwordx4 v8, s[32:35], s65 offen lds
    s_add_u32 s65, s64, 41088
    s_mov_b32 m0, s68
    s_add_u32 s68, s68, 1024
    buffer_load_dwordx4 v8, s[32:35], s65 offen lds
    s_add_u32 s65, s64, 49280
    s_mov_b32 m0, s68
    s_add_u32 s68, s68, 1024
    buffer_load_dwordx4 v8, s[32:35], s65 offen lds
    s_add_u32 s65, s64, 57472
    s_mov_b32 m0, s68
    s_add_u32 s68, s68, 1024
    buffer_load_dwordx4 v8, s[32:35], s65 offen lds
    s_waitcnt vmcnt(16)
    ds_read_b128 v[64:67], v13 offset:16384
    ds_read_b128 v[80:83], v13 offset:24576
    ds_read_b128 v[68:71], v13 offset:18432
    ds_read_b128 v[84:87], v13 offset:26624
    ds_read_b128 v[72:75], v13 offset:20480
    ds_read_b128 v[88:91], v13 offset:28672
    ds_read_b128 v[76:79], v13 offset:22528
    ds_read_b128 v[92:95], v13 offset:30720
    ds_read_b128 v[96:99], v14 offset:16384
    ds_read_b128 v[112:115], v14 offset:24576
    ds_read_b128 v[100:103], v14 offset:18432
    ds_read_b128 v[116:119], v14 offset:26624
    ds_read_b128 v[104:107], v14 offset:20480
    ds_read_b128 v[120:123], v14 offset:28672
    ds_read_b128 v[108:111], v14 offset:22528
    ds_read_b128 v[124:127], v14 offset:30720
    s_waitcnt lgkmcnt(8)
    v_mfma_f32_16x16x32_bf16 a[64:67], v[80:83], v[64:67], a[64:67]
    v_mfma_f32_16x16x32_bf16 a[68:71], v[84:87], v[64:67], a[68:71]
    v_mfma_f32_16x16x32_bf16 a[72:75], v[88:91], v[64:67], a[72:75]
    v_mfma_f32_16x16x32_bf16 a[76:79], v[92:95], v[64:67], a[76:79]
    v_mfma_f32_16x16x32_bf16 a[80:83], v[80:83], v[68:71], a[80:83]
    v_mfma_f32_16x16x32_bf16 a[84:87], v[84:87], v[68:71], a[84:87]
    v_mfma_f32_16x16x32_bf16 a[88:91], v[88:91], v[68:71], a[88:91]
    v_mfma_f32_16x16x32_bf16 a[92:95], v[92:95], v[68:71], a[92:95]
    v_mfma_f32_16x16x32_bf16 a[96:99], v[80:83], v[72:75], a[96:99]
    v_mfma_f32_16x16x32_bf16 a[100:103], v[84:87], v[72:75], a[100:103]
    v_mfma_f32_16x16x32_bf16 a[104:107], v[88:91], v[72:75], a[104:107]
    v_mfma_f32_16x16x32_bf16 a[108:111], v[92:95], v[72:75], a[108:111]
    v_mfma_f32_16x16x32_bf16 a[112:115], v[80:83], v[76:79], a[112:115]
    v_mfma_f32_16x16x32_bf16 a[116:119], v[84:87], v[76:79], a[116:119]
    v_mfma_f32_16x16x32_bf16 a[120:123], v[88:91], v[76:79], a[120:123]
    v_mfma_f32_16x16x32_bf16 a[124:127], v[92:95], v[76:79], a[124:127]
    s_waitcnt lgkmcnt(0)
    v_mfma_f32_16x16x32_bf16 a[64:67], v[112:115], v[96:99], a[64:67]
    v_mfma_f32_16x16x32_bf16 a[68:71], v[116:119], v[96:99], a[68:71]
    v_mfma_f32_16x16x32_bf16 a[72:75], v[120:123], v[96:99], a[72:75]
    v_mfma_f32_16x16x32_bf16 a[76:79], v[124:127], v[96:99], a[76:79]
    v_mfma_f32_16x16x32_bf16 a[80:83], v[112:115], v[100:103], a[80:83]
    v_mfma_f32_16x16x32_bf16 a[84:87], v[116:119], v[100:103], a[84:87]
    v_mfma_f32_16x16x32_bf16 a[88:91], v[120:123], v[100:103], a[88:91]
    v_mfma_f32_16x16x32_bf16 a[92:95], v[124:127], v[100:103], a[92:95]
    v_mfma_f32_16x16x32_bf16 a[96:99], v[112:115], v[104:107], a[96:99]
    v_mfma_f32_16x16x32_bf16 a[100:103], v[116:119], v[104:107], a[100:103]
    v_mfma_f32_16x16x32_bf16 a[104:107], v[120:123], v[104:107], a[104:107]
    v_mfma_f32_16x16x32_bf16 a[108:111], v[124:127], v[104:107], a[108:111]
    v_mfma_f32_16x16x32_bf16 a[112:115], v[112:115], v[108:111], a[112:115]
    v_mfma_f32_16x16x32_bf16 a[116:119], v[116:119], v[108:111], a[116:119]
    v_mfma_f32_16x16x32_bf16 a[120:123], v[120:123], v[108:111], a[120:123]
    v_mfma_f32_16x16x32_bf16 a[124:127], v[124:127], v[108:111], a[124:127]
    s_add_u32 s68, s67, 16384
    s_add_u32 s65, s63, 1024
    s_mov_b32 m0, s68
    s_add_u32 s68, s68, 1024
    buffer_load_dwordx4 v7, s[28:31], s65 offen lds
    s_add_u32 s65, s63, 17408
    s_mov_b32 m0, s68
    s_add_u32 s68, s68, 1024
    buffer_load_dwordx4 v7, s[28:31], s65 offen lds
    s_add_u32 s65, s63, 33792
    s_mov_b32 m0, s68
    s_add_u32 s68, s68, 1024
    buffer_load_dwordx4 v7, s[28:31], s65 offen lds
    s_add_u32 s65, s63, 50176
    s_mov_b32 m0, s68
    s_add_u32 s68, s68, 1024
    buffer_load_dwordx4 v7, s[28:31], s65 offen lds
    s_add_u32 s65, s63, 66560
    s_mov_b32 m0, s68
    s_add_u32 s68, s68, 1024
    buffer_load_dwordx4 v7, s[28:31], s65 offen lds
    s_add_u32 s65, s63, 82944
    s_mov_b32 m0, s68
    s_add_u32 s68, s68, 1024
    buffer_load_dwordx4 v7, s[28:31], s65 offen lds
    s_add_u32 s65, s63, 99328
    s_mov_b32 m0, s68
    s_add_u32 s68, s68, 1024
    buffer_load_dwordx4 v7, s[28:31], s65 offen lds
    s_add_u32 s65, s63, 115712
    s_mov_b32 m0, s68
    s_add_u32 s68, s68, 1024
    buffer_load_dwordx4 v7, s[28:31], s65 offen lds
    s_add_u32 s65, s64, 0
    s_mov_b32 m0, s68
    s_add_u32 s68, s68, 1024
    buffer_load_dwordx4 v8, s[36:39], s65 offen lds
    s_add_u32 s65, s64, 8192
    s_mov_b32 m0, s68
    s_add_u32 s68, s68, 1024
    buffer_load_dwordx4 v8, s[36:39], s65 offen lds
    s_add_u32 s65, s64, 16384
    s_mov_b32 m0, s68
    s_add_u32 s68, s68, 1024
    buffer_load_dwordx4 v8, s[36:39], s65 offen lds
    s_add_u32 s65, s64, 24576
    s_mov_b32 m0, s68
    s_add_u32 s68, s68, 1024
    buffer_load_dwordx4 v8, s[36:39], s65 offen lds
    s_add_u32 s65, s64, 32768
    s_mov_b32 m0, s68
    s_add_u32 s68, s68, 1024
    buffer_load_dwordx4 v8, s[36:39], s65 offen lds
    s_add_u32 s65, s64, 40960
    s_mov_b32 m0, s68
    s_add_u32 s68, s68, 1024
    buffer_load_dwordx4 v8, s[36:39], s65 offen lds
    s_add_u32 s65, s64, 49152
    s_mov_b32 m0, s68
    s_add_u32 s68, s68, 1024
    buffer_load_dwordx4 v8, s[36:39], s65 offen lds
    s_add_u32 s65, s64, 57344
    s_mov_b32 m0, s68
    s_add_u32 s68, s68, 1024
    buffer_load_dwordx4 v8, s[36:39], s65 offen lds
    s_waitcnt vmcnt(16)
    ds_read_b128 v[64:67], v13 offset:0
    ds_read_b128 v[80:83], v13 offset:8192
    ds_read_b128 v[68:71], v13 offset:2048
    ds_read_b128 v[84:87], v13 offset:10240
    ds_read_b128 v[72:75], v13 offset:4096
    ds_read_b128 v[88:91], v13 offset:12288
    ds_read_b128 v[76:79], v13 offset:6144
    ds_read_b128 v[92:95], v13 offset:14336
    ds_read_b128 v[96:99], v14 offset:0
    ds_read_b128 v[112:115], v14 offset:8192
    ds_read_b128 v[100:103], v14 offset:2048
    ds_read_b128 v[116:119], v14 offset:10240
    ds_read_b128 v[104:107], v14 offset:4096
    ds_read_b128 v[120:123], v14 offset:12288
    ds_read_b128 v[108:111], v14 offset:6144
    ds_read_b128 v[124:127], v14 offset:14336
    s_waitcnt lgkmcnt(8)
    v_mfma_f32_16x16x32_bf16 a[64:67], v[80:83], v[64:67], a[64:67]
    v_mfma_f32_16x16x32_bf16 a[68:71], v[84:87], v[64:67], a[68:71]
    v_mfma_f32_16x16x32_bf16 a[72:75], v[88:91], v[64:67], a[72:75]
    v_mfma_f32_16x16x32_bf16 a[76:79], v[92:95], v[64:67], a[76:79]
    v_mfma_f32_16x16x32_bf16 a[80:83], v[80:83], v[68:71], a[80:83]
    v_mfma_f32_16x16x32_bf16 a[84:87], v[84:87], v[68:71], a[84:87]
    v_mfma_f32_16x16x32_bf16 a[88:91], v[88:91], v[68:71], a[88:91]
    v_mfma_f32_16x16x32_bf16 a[92:95], v[92:95], v[68:71], a[92:95]
    v_mfma_f32_16x16x32_bf16 a[96:99], v[80:83], v[72:75], a[96:99]
    v_mfma_f32_16x16x32_bf16 a[100:103], v[84:87], v[72:75], a[100:103]
    v_mfma_f32_16x16x32_bf16 a[104:107], v[88:91], v[72:75], a[104:107]
    v_mfma_f32_16x16x32_bf16 a[108:111], v[92:95], v[72:75], a[108:111]
    v_mfma_f32_16x16x32_bf16 a[112:115], v[80:83], v[76:79], a[112:115]
    v_mfma_f32_16x16x32_bf16 a[116:119], v[84:87], v[76:79], a[116:119]
    v_mfma_f32_16x16x32_bf16 a[120:123], v[88:91], v[76:79], a[120:123]
    v_mfma_f32_16x16x32_bf16 a[124:127], v[92:95], v[76:79], a[124:127]
    s_waitcnt lgkmcnt(0)
    v_mfma_f32_16x16x32_bf16 a[64:67], v[112:115], v[96:99], a[64:67]
    v_mfma_f32_16x16x32_bf16 a[68:71], v[116:119], v[96:99], a[68:71]
    v_mfma_f32_16x16x32_bf16 a[72:75], v[120:123], v[96:99], a[72:75]
    v_mfma_f32_16x16x32_bf16 a[76:79], v[124:127], v[96:99], a[76:79]
    v_mfma_f32_16x16x32_bf16 a[80:83], v[112:115], v[100:103], a[80:83]
    v_mfma_f32_16x16x32_bf16 a[84:87], v[116:119], v[100:103], a[84:87]
    v_mfma_f32_16x16x32_bf16 a[88:91], v[120:123], v[100:103], a[88:91]
    v_mfma_f32_16x16x32_bf16 a[92:95], v[124:127], v[100:103], a[92:95]
    v_mfma_f32_16x16x32_bf16 a[96:99], v[112:115], v[104:107], a[96:99]
    v_mfma_f32_16x16x32_bf16 a[100:103], v[116:119], v[104:107], a[100:103]
    v_mfma_f32_16x16x32_bf16 a[104:107], v[120:123], v[104:107], a[104:107]
    v_mfma_f32_16x16x32_bf16 a[108:111], v[124:127], v[104:107], a[108:111]
    v_mfma_f32_16x16x32_bf16 a[112:115], v[112:115], v[108:111], a[112:115]
    v_mfma_f32_16x16x32_bf16 a[116:119], v[116:119], v[108:111], a[116:119]
    v_mfma_f32_16x16x32_bf16 a[120:123], v[120:123], v[108:111], a[120:123]
    v_mfma_f32_16x16x32_bf16 a[124:127], v[124:127], v[108:111], a[124:127]
    s_add_u32 s68, s67, 0
    s_add_u32 s65, s63, 1152
    s_mov_b32 m0, s68
    s_add_u32 s68, s68, 1024
    buffer_load_dwordx4 v7, s[28:31], s65 offen lds
    s_add_u32 s65, s63, 17536
    s_mov_b32 m0, s68
    s_add_u32 s68, s68, 1024
    buffer_load_dwordx4 v7, s[28:31], s65 offen lds
    s_add_u32 s65, s63, 33920
    s_mov_b32 m0, s68
    s_add_u32 s68, s68, 1024
    buffer_load_dwordx4 v7, s[28:31], s65 offen lds
    s_add_u32 s65, s63, 50304
    s_mov_b32 m0, s68
    s_add_u32 s68, s68, 1024
    buffer_load_dwordx4 v7, s[28:31], s65 offen lds
    s_add_u32 s65, s63, 66688
    s_mov_b32 m0, s68
    s_add_u32 s68, s68, 1024
    buffer_load_dwordx4 v7, s[28:31], s65 offen lds
    s_add_u32 s65, s63, 83072
    s_mov_b32 m0, s68
    s_add_u32 s68, s68, 1024
    buffer_load_dwordx4 v7, s[28:31], s65 offen lds
    s_add_u32 s65, s63, 99456
    s_mov_b32 m0, s68
    s_add_u32 s68, s68, 1024
    buffer_load_dwordx4 v7, s[28:31], s65 offen lds
    s_add_u32 s65, s63, 115840
    s_mov_b32 m0, s68
    s_add_u32 s68, s68, 1024
    buffer_load_dwordx4 v7, s[28:31], s65 offen lds
    s_add_u32 s65, s64, 128
    s_mov_b32 m0, s68
    s_add_u32 s68, s68, 1024
    buffer_load_dwordx4 v8, s[36:39], s65 offen lds
    s_add_u32 s65, s64, 8320
    s_mov_b32 m0, s68
    s_add_u32 s68, s68, 1024
    buffer_load_dwordx4 v8, s[36:39], s65 offen lds
    s_add_u32 s65, s64, 16512
    s_mov_b32 m0, s68
    s_add_u32 s68, s68, 1024
    buffer_load_dwordx4 v8, s[36:39], s65 offen lds
    s_add_u32 s65, s64, 24704
    s_mov_b32 m0, s68
    s_add_u32 s68, s68, 1024
    buffer_load_dwordx4 v8, s[36:39], s65 offen lds
    s_add_u32 s65, s64, 32896
    s_mov_b32 m0, s68
    s_add_u32 s68, s68, 1024
    buffer_load_dwordx4 v8, s[36:39], s65 offen lds
    s_add_u32 s65, s64, 41088
    s_mov_b32 m0, s68
    s_add_u32 s68, s68, 1024
    buffer_load_dwordx4 v8, s[36:39], s65 offen lds
    s_add_u32 s65, s64, 49280
    s_mov_b32 m0, s68
    s_add_u32 s68, s68, 1024
    buffer_load_dwordx4 v8, s[36:39], s65 offen lds
    s_add_u32 s65, s64, 57472
    s_mov_b32 m0, s68
    s_add_u32 s68, s68, 1024
    buffer_load_dwordx4 v8, s[36:39], s65 offen lds
    s_waitcnt vmcnt(16)
    ds_read_b128 v[64:67], v13 offset:16384
    ds_read_b128 v[80:83], v13 offset:24576
    ds_read_b128 v[68:71], v13 offset:18432
    ds_read_b128 v[84:87], v13 offset:26624
    ds_read_b128 v[72:75], v13 offset:20480
    ds_read_b128 v[88:91], v13 offset:28672
    ds_read_b128 v[76:79], v13 offset:22528
    ds_read_b128 v[92:95], v13 offset:30720
    ds_read_b128 v[96:99], v14 offset:16384
    ds_read_b128 v[112:115], v14 offset:24576
    ds_read_b128 v[100:103], v14 offset:18432
    ds_read_b128 v[116:119], v14 offset:26624
    ds_read_b128 v[104:107], v14 offset:20480
    ds_read_b128 v[120:123], v14 offset:28672
    ds_read_b128 v[108:111], v14 offset:22528
    ds_read_b128 v[124:127], v14 offset:30720
    s_waitcnt lgkmcnt(8)
    v_mfma_f32_16x16x32_bf16 a[64:67], v[80:83], v[64:67], a[64:67]
    v_mfma_f32_16x16x32_bf16 a[68:71], v[84:87], v[64:67], a[68:71]
    v_mfma_f32_16x16x32_bf16 a[72:75], v[88:91], v[64:67], a[72:75]
    v_mfma_f32_16x16x32_bf16 a[76:79], v[92:95], v[64:67], a[76:79]
    v_mfma_f32_16x16x32_bf16 a[80:83], v[80:83], v[68:71], a[80:83]
    v_mfma_f32_16x16x32_bf16 a[84:87], v[84:87], v[68:71], a[84:87]
    v_mfma_f32_16x16x32_bf16 a[88:91], v[88:91], v[68:71], a[88:91]
    v_mfma_f32_16x16x32_bf16 a[92:95], v[92:95], v[68:71], a[92:95]
    v_mfma_f32_16x16x32_bf16 a[96:99], v[80:83], v[72:75], a[96:99]
    v_mfma_f32_16x16x32_bf16 a[100:103], v[84:87], v[72:75], a[100:103]
    v_mfma_f32_16x16x32_bf16 a[104:107], v[88:91], v[72:75], a[104:107]
    v_mfma_f32_16x16x32_bf16 a[108:111], v[92:95], v[72:75], a[108:111]
    v_mfma_f32_16x16x32_bf16 a[112:115], v[80:83], v[76:79], a[112:115]
    v_mfma_f32_16x16x32_bf16 a[116:119], v[84:87], v[76:79], a[116:119]
    v_mfma_f32_16x16x32_bf16 a[120:123], v[88:91], v[76:79], a[120:123]
    v_mfma_f32_16x16x32_bf16 a[124:127], v[92:95], v[76:79], a[124:127]
    s_waitcnt lgkmcnt(0)
    v_mfma_f32_16x16x32_bf16 a[64:67], v[112:115], v[96:99], a[64:67]
    v_mfma_f32_16x16x32_bf16 a[68:71], v[116:119], v[96:99], a[68:71]
    v_mfma_f32_16x16x32_bf16 a[72:75], v[120:123], v[96:99], a[72:75]
    v_mfma_f32_16x16x32_bf16 a[76:79], v[124:127], v[96:99], a[76:79]
    v_mfma_f32_16x16x32_bf16 a[80:83], v[112:115], v[100:103], a[80:83]
    v_mfma_f32_16x16x32_bf16 a[84:87], v[116:119], v[100:103], a[84:87]
    v_mfma_f32_16x16x32_bf16 a[88:91], v[120:123], v[100:103], a[88:91]
    v_mfma_f32_16x16x32_bf16 a[92:95], v[124:127], v[100:103], a[92:95]
    v_mfma_f32_16x16x32_bf16 a[96:99], v[112:115], v[104:107], a[96:99]
    v_mfma_f32_16x16x32_bf16 a[100:103], v[116:119], v[104:107], a[100:103]
    v_mfma_f32_16x16x32_bf16 a[104:107], v[120:123], v[104:107], a[104:107]
    v_mfma_f32_16x16x32_bf16 a[108:111], v[124:127], v[104:107], a[108:111]
    v_mfma_f32_16x16x32_bf16 a[112:115], v[112:115], v[108:111], a[112:115]
    v_mfma_f32_16x16x32_bf16 a[116:119], v[116:119], v[108:111], a[116:119]
    v_mfma_f32_16x16x32_bf16 a[120:123], v[120:123], v[108:111], a[120:123]
    v_mfma_f32_16x16x32_bf16 a[124:127], v[124:127], v[108:111], a[124:127]
    s_waitcnt vmcnt(0)
    ds_read_b128 v[64:67], v13 offset:0
    ds_read_b128 v[80:83], v13 offset:8192
    ds_read_b128 v[68:71], v13 offset:2048
    ds_read_b128 v[84:87], v13 offset:10240
    ds_read_b128 v[72:75], v13 offset:4096
    ds_read_b128 v[88:91], v13 offset:12288
    ds_read_b128 v[76:79], v13 offset:6144
    ds_read_b128 v[92:95], v13 offset:14336
    ds_read_b128 v[96:99], v14 offset:0
    ds_read_b128 v[112:115], v14 offset:8192
    ds_read_b128 v[100:103], v14 offset:2048
    ds_read_b128 v[116:119], v14 offset:10240
    ds_read_b128 v[104:107], v14 offset:4096
    ds_read_b128 v[120:123], v14 offset:12288
    ds_read_b128 v[108:111], v14 offset:6144
    ds_read_b128 v[124:127], v14 offset:14336
    s_waitcnt lgkmcnt(8)
    v_mfma_f32_16x16x32_bf16 a[64:67], v[80:83], v[64:67], a[64:67]
    v_mfma_f32_16x16x32_bf16 a[68:71], v[84:87], v[64:67], a[68:71]
    v_mfma_f32_16x16x32_bf16 a[72:75], v[88:91], v[64:67], a[72:75]
    v_mfma_f32_16x16x32_bf16 a[76:79], v[92:95], v[64:67], a[76:79]
    v_mfma_f32_16x16x32_bf16 a[80:83], v[80:83], v[68:71], a[80:83]
    v_mfma_f32_16x16x32_bf16 a[84:87], v[84:87], v[68:71], a[84:87]
    v_mfma_f32_16x16x32_bf16 a[88:91], v[88:91], v[68:71], a[88:91]
    v_mfma_f32_16x16x32_bf16 a[92:95], v[92:95], v[68:71], a[92:95]
    v_mfma_f32_16x16x32_bf16 a[96:99], v[80:83], v[72:75], a[96:99]
    v_mfma_f32_16x16x32_bf16 a[100:103], v[84:87], v[72:75], a[100:103]
    v_mfma_f32_16x16x32_bf16 a[104:107], v[88:91], v[72:75], a[104:107]
    v_mfma_f32_16x16x32_bf16 a[108:111], v[92:95], v[72:75], a[108:111]
    v_mfma_f32_16x16x32_bf16 a[112:115], v[80:83], v[76:79], a[112:115]
    v_mfma_f32_16x16x32_bf16 a[116:119], v[84:87], v[76:79], a[116:119]
    v_mfma_f32_16x16x32_bf16 a[120:123], v[88:91], v[76:79], a[120:123]
    v_mfma_f32_16x16x32_bf16 a[124:127], v[92:95], v[76:79], a[124:127]
    s_waitcnt lgkmcnt(0)
    v_mfma_f32_16x16x32_bf16 a[64:67], v[112:115], v[96:99], a[64:67]
    v_mfma_f32_16x16x32_bf16 a[68:71], v[116:119], v[96:99], a[68:71]
    v_mfma_f32_16x16x32_bf16 a[72:75], v[120:123], v[96:99], a[72:75]
    v_mfma_f32_16x16x32_bf16 a[76:79], v[124:127], v[96:99], a[76:79]
    v_mfma_f32_16x16x32_bf16 a[80:83], v[112:115], v[100:103], a[80:83]
    v_mfma_f32_16x16x32_bf16 a[84:87], v[116:119], v[100:103], a[84:87]
    v_mfma_f32_16x16x32_bf16 a[88:91], v[120:123], v[100:103], a[88:91]
    v_mfma_f32_16x16x32_bf16 a[92:95], v[124:127], v[100:103], a[92:95]
    v_mfma_f32_16x16x32_bf16 a[96:99], v[112:115], v[104:107], a[96:99]
    v_mfma_f32_16x16x32_bf16 a[100:103], v[116:119], v[104:107], a[100:103]
    v_mfma_f32_16x16x32_bf16 a[104:107], v[120:123], v[104:107], a[104:107]
    v_mfma_f32_16x16x32_bf16 a[108:111], v[124:127], v[104:107], a[108:111]
    v_mfma_f32_16x16x32_bf16 a[112:115], v[112:115], v[108:111], a[112:115]
    v_mfma_f32_16x16x32_bf16 a[116:119], v[116:119], v[108:111], a[116:119]
    v_mfma_f32_16x16x32_bf16 a[120:123], v[120:123], v[108:111], a[120:123]
    v_mfma_f32_16x16x32_bf16 a[124:127], v[124:127], v[108:111], a[124:127]
    s_barrier
    s_nop 7
    s_nop 7
    s_lshl_b32 s65, s58, 15
    v_lshlrev_b32 v9, 4, v1
    v_add_u32 v9, s65, v9

    v_accvgpr_read_b32 v64, a0
    v_accvgpr_read_b32 v65, a1
    v_accvgpr_read_b32 v66, a2
    v_accvgpr_read_b32 v67, a3
    ds_write_b128 v9, v[64:67] offset:0
    s_nop 1
    v_accvgpr_read_b32 v64, a4
    v_accvgpr_read_b32 v65, a5
    v_accvgpr_read_b32 v66, a6
    v_accvgpr_read_b32 v67, a7
    ds_write_b128 v9, v[64:67] offset:1024
    s_nop 1
    v_accvgpr_read_b32 v64, a8
    v_accvgpr_read_b32 v65, a9
    v_accvgpr_read_b32 v66, a10
    v_accvgpr_read_b32 v67, a11
    ds_write_b128 v9, v[64:67] offset:2048
    s_nop 1
    v_accvgpr_read_b32 v64, a12
    v_accvgpr_read_b32 v65, a13
    v_accvgpr_read_b32 v66, a14
    v_accvgpr_read_b32 v67, a15
    ds_write_b128 v9, v[64:67] offset:3072
    s_nop 1
    v_accvgpr_read_b32 v64, a16
    v_accvgpr_read_b32 v65, a17
    v_accvgpr_read_b32 v66, a18
    v_accvgpr_read_b32 v67, a19
    ds_write_b128 v9, v[64:67] offset:4096
    s_nop 1
    v_accvgpr_read_b32 v64, a20
    v_accvgpr_read_b32 v65, a21
    v_accvgpr_read_b32 v66, a22
    v_accvgpr_read_b32 v67, a23
    ds_write_b128 v9, v[64:67] offset:5120
    s_nop 1
    v_accvgpr_read_b32 v64, a24
    v_accvgpr_read_b32 v65, a25
    v_accvgpr_read_b32 v66, a26
    v_accvgpr_read_b32 v67, a27
    ds_write_b128 v9, v[64:67] offset:6144
    s_nop 1
    v_accvgpr_read_b32 v64, a28
    v_accvgpr_read_b32 v65, a29
    v_accvgpr_read_b32 v66, a30
    v_accvgpr_read_b32 v67, a31
    ds_write_b128 v9, v[64:67] offset:7168
    s_nop 1
    v_accvgpr_read_b32 v64, a32
    v_accvgpr_read_b32 v65, a33
    v_accvgpr_read_b32 v66, a34
    v_accvgpr_read_b32 v67, a35
    ds_write_b128 v9, v[64:67] offset:8192
    s_nop 1
    v_accvgpr_read_b32 v64, a36
    v_accvgpr_read_b32 v65, a37
    v_accvgpr_read_b32 v66, a38
    v_accvgpr_read_b32 v67, a39
    ds_write_b128 v9, v[64:67] offset:9216
    s_nop 1
    v_accvgpr_read_b32 v64, a40
    v_accvgpr_read_b32 v65, a41
    v_accvgpr_read_b32 v66, a42
    v_accvgpr_read_b32 v67, a43
    ds_write_b128 v9, v[64:67] offset:10240
    s_nop 1
    v_accvgpr_read_b32 v64, a44
    v_accvgpr_read_b32 v65, a45
    v_accvgpr_read_b32 v66, a46
    v_accvgpr_read_b32 v67, a47
    ds_write_b128 v9, v[64:67] offset:11264
    s_nop 1
    v_accvgpr_read_b32 v64, a48
    v_accvgpr_read_b32 v65, a49
    v_accvgpr_read_b32 v66, a50
    v_accvgpr_read_b32 v67, a51
    ds_write_b128 v9, v[64:67] offset:12288
    s_nop 1
    v_accvgpr_read_b32 v64, a52
    v_accvgpr_read_b32 v65, a53
    v_accvgpr_read_b32 v66, a54
    v_accvgpr_read_b32 v67, a55
    ds_write_b128 v9, v[64:67] offset:13312
    s_nop 1
    v_accvgpr_read_b32 v64, a56
    v_accvgpr_read_b32 v65, a57
    v_accvgpr_read_b32 v66, a58
    v_accvgpr_read_b32 v67, a59
    ds_write_b128 v9, v[64:67] offset:14336
    s_nop 1
    v_accvgpr_read_b32 v64, a60
    v_accvgpr_read_b32 v65, a61
    v_accvgpr_read_b32 v66, a62
    v_accvgpr_read_b32 v67, a63
    ds_write_b128 v9, v[64:67] offset:15360
    s_nop 1
    v_accvgpr_read_b32 v64, a64
    v_accvgpr_read_b32 v65, a65
    v_accvgpr_read_b32 v66, a66
    v_accvgpr_read_b32 v67, a67
    ds_write_b128 v9, v[64:67] offset:16384
    s_nop 1
    v_accvgpr_read_b32 v64, a68
    v_accvgpr_read_b32 v65, a69
    v_accvgpr_read_b32 v66, a70
    v_accvgpr_read_b32 v67, a71
    ds_write_b128 v9, v[64:67] offset:17408
    s_nop 1
    v_accvgpr_read_b32 v64, a72
    v_accvgpr_read_b32 v65, a73
    v_accvgpr_read_b32 v66, a74
    v_accvgpr_read_b32 v67, a75
    ds_write_b128 v9, v[64:67] offset:18432
    s_nop 1
    v_accvgpr_read_b32 v64, a76
    v_accvgpr_read_b32 v65, a77
    v_accvgpr_read_b32 v66, a78
    v_accvgpr_read_b32 v67, a79
    ds_write_b128 v9, v[64:67] offset:19456
    s_nop 1
    v_accvgpr_read_b32 v64, a80
    v_accvgpr_read_b32 v65, a81
    v_accvgpr_read_b32 v66, a82
    v_accvgpr_read_b32 v67, a83
    ds_write_b128 v9, v[64:67] offset:20480
    s_nop 1
    v_accvgpr_read_b32 v64, a84
    v_accvgpr_read_b32 v65, a85
    v_accvgpr_read_b32 v66, a86
    v_accvgpr_read_b32 v67, a87
    ds_write_b128 v9, v[64:67] offset:21504
    s_nop 1
    v_accvgpr_read_b32 v64, a88
    v_accvgpr_read_b32 v65, a89
    v_accvgpr_read_b32 v66, a90
    v_accvgpr_read_b32 v67, a91
    ds_write_b128 v9, v[64:67] offset:22528
    s_nop 1
    v_accvgpr_read_b32 v64, a92
    v_accvgpr_read_b32 v65, a93
    v_accvgpr_read_b32 v66, a94
    v_accvgpr_read_b32 v67, a95
    ds_write_b128 v9, v[64:67] offset:23552
    s_nop 1
    v_accvgpr_read_b32 v64, a96
    v_accvgpr_read_b32 v65, a97
    v_accvgpr_read_b32 v66, a98
    v_accvgpr_read_b32 v67, a99
    ds_write_b128 v9, v[64:67] offset:24576
    s_nop 1
    v_accvgpr_read_b32 v64, a100
    v_accvgpr_read_b32 v65, a101
    v_accvgpr_read_b32 v66, a102
    v_accvgpr_read_b32 v67, a103
    ds_write_b128 v9, v[64:67] offset:25600
    s_nop 1
    v_accvgpr_read_b32 v64, a104
    v_accvgpr_read_b32 v65, a105
    v_accvgpr_read_b32 v66, a106
    v_accvgpr_read_b32 v67, a107
    ds_write_b128 v9, v[64:67] offset:26624
    s_nop 1
    v_accvgpr_read_b32 v64, a108
    v_accvgpr_read_b32 v65, a109
    v_accvgpr_read_b32 v66, a110
    v_accvgpr_read_b32 v67, a111
    ds_write_b128 v9, v[64:67] offset:27648
    s_nop 1
    v_accvgpr_read_b32 v64, a112
    v_accvgpr_read_b32 v65, a113
    v_accvgpr_read_b32 v66, a114
    v_accvgpr_read_b32 v67, a115
    ds_write_b128 v9, v[64:67] offset:28672
    s_nop 1
    v_accvgpr_read_b32 v64, a116
    v_accvgpr_read_b32 v65, a117
    v_accvgpr_read_b32 v66, a118
    v_accvgpr_read_b32 v67, a119
    ds_write_b128 v9, v[64:67] offset:29696
    s_nop 1
    v_accvgpr_read_b32 v64, a120
    v_accvgpr_read_b32 v65, a121
    v_accvgpr_read_b32 v66, a122
    v_accvgpr_read_b32 v67, a123
    ds_write_b128 v9, v[64:67] offset:30720
    s_nop 1
    v_accvgpr_read_b32 v64, a124
    v_accvgpr_read_b32 v65, a125
    v_accvgpr_read_b32 v66, a126
    v_accvgpr_read_b32 v67, a127
    ds_write_b128 v9, v[64:67] offset:31744
    s_nop 1
    s_waitcnt lgkmcnt(0)
    s_barrier
    s_lshl_b32 s65, s58, 12
    v_lshlrev_b32 v9, 4, v1
    v_add_u32 v9, s65, v9
    s_lshl_b32 s65, s56, 6
    s_lshl_b32 s66, s58, 4
    s_add_u32 s65, s65, s66
    v_add_u32 v10, s65, v3
    s_lshl_b32 s66, s57, 6
    v_lshl_add_u32 v11, v4, 2, s66
    v_lshlrev_b32 v12, 10, v10
    v_lshl_add_u32 v12, v11, 1, v12
    v_lshlrev_b32 v13, 1, v11
    v_lshlrev_b32 v14, 11, v10
    v_lshl_add_u32 v14, v11, 2, v14
    v_add_u32 v15, 0x10000, v9

    buffer_load_dwordx2 v[16:17], v12, s[40:43], 0 offen offset:0
    buffer_load_dwordx2 v[24:25], v12, s[44:47], 0 offen offset:0
    buffer_load_dwordx2 v[32:33], v13, s[48:51], 0 offen offset:0
    buffer_load_dwordx2 v[18:19], v12, s[40:43], 0 offen offset:32
    buffer_load_dwordx2 v[26:27], v12, s[44:47], 0 offen offset:32
    buffer_load_dwordx2 v[34:35], v13, s[48:51], 0 offen offset:32
    buffer_load_dwordx2 v[20:21], v12, s[40:43], 0 offen offset:64
    buffer_load_dwordx2 v[28:29], v12, s[44:47], 0 offen offset:64
    buffer_load_dwordx2 v[36:37], v13, s[48:51], 0 offen offset:64
    buffer_load_dwordx2 v[22:23], v12, s[40:43], 0 offen offset:96
    buffer_load_dwordx2 v[30:31], v12, s[44:47], 0 offen offset:96
    buffer_load_dwordx2 v[38:39], v13, s[48:51], 0 offen offset:96
    ds_read_b128 v[72:75], v9 offset:0
    ds_read_b128 v[76:79], v9 offset:32768
    ds_read_b128 v[80:83], v15 offset:0
    ds_read_b128 v[84:87], v15 offset:32768
    s_waitcnt lgkmcnt(0)
    v_add_f32 v64, v72, v76
    v_add_f32 v88, v80, v84
    v_add_f32 v64, v64, v88
    v_add_f32 v65, v73, v77
    v_add_f32 v89, v81, v85
    v_add_f32 v65, v65, v89
    v_add_f32 v66, v74, v78
    v_add_f32 v90, v82, v86
    v_add_f32 v66, v66, v90
    v_add_f32 v67, v75, v79
    v_add_f32 v91, v83, v87
    v_add_f32 v67, v67, v91
    ds_read_b128 v[72:75], v9 offset:16384
    ds_read_b128 v[76:79], v9 offset:49152
    ds_read_b128 v[80:83], v15 offset:16384
    ds_read_b128 v[84:87], v15 offset:49152
    s_waitcnt lgkmcnt(0)
    v_add_f32 v68, v72, v76
    v_add_f32 v88, v80, v84
    v_add_f32 v68, v68, v88
    v_add_f32 v69, v73, v77
    v_add_f32 v89, v81, v85
    v_add_f32 v69, v69, v89
    v_add_f32 v70, v74, v78
    v_add_f32 v90, v82, v86
    v_add_f32 v70, v70, v90
    v_add_f32 v71, v75, v79
    v_add_f32 v91, v83, v87
    v_add_f32 v71, v71, v91
    s_waitcnt vmcnt(0)
    v_lshlrev_b32 v92, 16, v16
    v_lshlrev_b32 v93, 16, v24
    v_lshlrev_b32 v94, 16, v32
    v_cvt_pk_bf16_f32 v64, v64, v64
    v_lshlrev_b32 v64, 16, v64
    v_mul_f32 v95, 0xbfb8aa3b, v64
    v_exp_f32 v95, v95
    s_nop 0
    v_add_f32 v95, 1.0, v95
    v_rcp_f32 v95, v95
    s_nop 0
    v_mul_f32 v95, v64, v95
    v_cvt_pk_bf16_f32 v95, v95, v95
    v_lshlrev_b32 v95, 16, v95
    v_mul_f32 v93, v93, v94
    v_cvt_pk_bf16_f32 v93, v93, v93
    v_lshlrev_b32 v93, 16, v93
    v_fma_f32 v93, 2.0, v68, v93
    v_fma_f32 v40, v93, v95, v92
    v_and_b32 v92, 0xffff0000, v16
    v_and_b32 v93, 0xffff0000, v24
    v_and_b32 v94, 0xffff0000, v32
    v_cvt_pk_bf16_f32 v65, v65, v65
    v_lshlrev_b32 v65, 16, v65
    v_mul_f32 v95, 0xbfb8aa3b, v65
    v_exp_f32 v95, v95
    s_nop 0
    v_add_f32 v95, 1.0, v95
    v_rcp_f32 v95, v95
    s_nop 0
    v_mul_f32 v95, v65, v95
    v_cvt_pk_bf16_f32 v95, v95, v95
    v_lshlrev_b32 v95, 16, v95
    v_mul_f32 v93, v93, v94
    v_cvt_pk_bf16_f32 v93, v93, v93
    v_lshlrev_b32 v93, 16, v93
    v_fma_f32 v93, 2.0, v69, v93
    v_fma_f32 v41, v93, v95, v92
    v_lshlrev_b32 v92, 16, v17
    v_lshlrev_b32 v93, 16, v25
    v_lshlrev_b32 v94, 16, v33
    v_cvt_pk_bf16_f32 v66, v66, v66
    v_lshlrev_b32 v66, 16, v66
    v_mul_f32 v95, 0xbfb8aa3b, v66
    v_exp_f32 v95, v95
    s_nop 0
    v_add_f32 v95, 1.0, v95
    v_rcp_f32 v95, v95
    s_nop 0
    v_mul_f32 v95, v66, v95
    v_cvt_pk_bf16_f32 v95, v95, v95
    v_lshlrev_b32 v95, 16, v95
    v_mul_f32 v93, v93, v94
    v_cvt_pk_bf16_f32 v93, v93, v93
    v_lshlrev_b32 v93, 16, v93
    v_fma_f32 v93, 2.0, v70, v93
    v_fma_f32 v42, v93, v95, v92
    v_and_b32 v92, 0xffff0000, v17
    v_and_b32 v93, 0xffff0000, v25
    v_and_b32 v94, 0xffff0000, v33
    v_cvt_pk_bf16_f32 v67, v67, v67
    v_lshlrev_b32 v67, 16, v67
    v_mul_f32 v95, 0xbfb8aa3b, v67
    v_exp_f32 v95, v95
    s_nop 0
    v_add_f32 v95, 1.0, v95
    v_rcp_f32 v95, v95
    s_nop 0
    v_mul_f32 v95, v67, v95
    v_cvt_pk_bf16_f32 v95, v95, v95
    v_lshlrev_b32 v95, 16, v95
    v_mul_f32 v93, v93, v94
    v_cvt_pk_bf16_f32 v93, v93, v93
    v_lshlrev_b32 v93, 16, v93
    v_fma_f32 v93, 2.0, v71, v93
    v_fma_f32 v43, v93, v95, v92
    buffer_store_dwordx4 v[40:43], v14, s[52:55], 0 offen offset:0
    s_nop 1
    ds_read_b128 v[72:75], v9 offset:1024
    ds_read_b128 v[76:79], v9 offset:33792
    ds_read_b128 v[80:83], v15 offset:1024
    ds_read_b128 v[84:87], v15 offset:33792
    s_waitcnt lgkmcnt(0)
    v_add_f32 v64, v72, v76
    v_add_f32 v88, v80, v84
    v_add_f32 v64, v64, v88
    v_add_f32 v65, v73, v77
    v_add_f32 v89, v81, v85
    v_add_f32 v65, v65, v89
    v_add_f32 v66, v74, v78
    v_add_f32 v90, v82, v86
    v_add_f32 v66, v66, v90
    v_add_f32 v67, v75, v79
    v_add_f32 v91, v83, v87
    v_add_f32 v67, v67, v91
    ds_read_b128 v[72:75], v9 offset:17408
    ds_read_b128 v[76:79], v9 offset:50176
    ds_read_b128 v[80:83], v15 offset:17408
    ds_read_b128 v[84:87], v15 offset:50176
    s_waitcnt lgkmcnt(0)
    v_add_f32 v68, v72, v76
    v_add_f32 v88, v80, v84
    v_add_f32 v68, v68, v88
    v_add_f32 v69, v73, v77
    v_add_f32 v89, v81, v85
    v_add_f32 v69, v69, v89
    v_add_f32 v70, v74, v78
    v_add_f32 v90, v82, v86
    v_add_f32 v70, v70, v90
    v_add_f32 v71, v75, v79
    v_add_f32 v91, v83, v87
    v_add_f32 v71, v71, v91
    v_lshlrev_b32 v92, 16, v18
    v_lshlrev_b32 v93, 16, v26
    v_lshlrev_b32 v94, 16, v34
    v_cvt_pk_bf16_f32 v64, v64, v64
    v_lshlrev_b32 v64, 16, v64
    v_mul_f32 v95, 0xbfb8aa3b, v64
    v_exp_f32 v95, v95
    s_nop 0
    v_add_f32 v95, 1.0, v95
    v_rcp_f32 v95, v95
    s_nop 0
    v_mul_f32 v95, v64, v95
    v_cvt_pk_bf16_f32 v95, v95, v95
    v_lshlrev_b32 v95, 16, v95
    v_mul_f32 v93, v93, v94
    v_cvt_pk_bf16_f32 v93, v93, v93
    v_lshlrev_b32 v93, 16, v93
    v_fma_f32 v93, 2.0, v68, v93
    v_fma_f32 v40, v93, v95, v92
    v_and_b32 v92, 0xffff0000, v18
    v_and_b32 v93, 0xffff0000, v26
    v_and_b32 v94, 0xffff0000, v34
    v_cvt_pk_bf16_f32 v65, v65, v65
    v_lshlrev_b32 v65, 16, v65
    v_mul_f32 v95, 0xbfb8aa3b, v65
    v_exp_f32 v95, v95
    s_nop 0
    v_add_f32 v95, 1.0, v95
    v_rcp_f32 v95, v95
    s_nop 0
    v_mul_f32 v95, v65, v95
    v_cvt_pk_bf16_f32 v95, v95, v95
    v_lshlrev_b32 v95, 16, v95
    v_mul_f32 v93, v93, v94
    v_cvt_pk_bf16_f32 v93, v93, v93
    v_lshlrev_b32 v93, 16, v93
    v_fma_f32 v93, 2.0, v69, v93
    v_fma_f32 v41, v93, v95, v92
    v_lshlrev_b32 v92, 16, v19
    v_lshlrev_b32 v93, 16, v27
    v_lshlrev_b32 v94, 16, v35
    v_cvt_pk_bf16_f32 v66, v66, v66
    v_lshlrev_b32 v66, 16, v66
    v_mul_f32 v95, 0xbfb8aa3b, v66
    v_exp_f32 v95, v95
    s_nop 0
    v_add_f32 v95, 1.0, v95
    v_rcp_f32 v95, v95
    s_nop 0
    v_mul_f32 v95, v66, v95
    v_cvt_pk_bf16_f32 v95, v95, v95
    v_lshlrev_b32 v95, 16, v95
    v_mul_f32 v93, v93, v94
    v_cvt_pk_bf16_f32 v93, v93, v93
    v_lshlrev_b32 v93, 16, v93
    v_fma_f32 v93, 2.0, v70, v93
    v_fma_f32 v42, v93, v95, v92
    v_and_b32 v92, 0xffff0000, v19
    v_and_b32 v93, 0xffff0000, v27
    v_and_b32 v94, 0xffff0000, v35
    v_cvt_pk_bf16_f32 v67, v67, v67
    v_lshlrev_b32 v67, 16, v67
    v_mul_f32 v95, 0xbfb8aa3b, v67
    v_exp_f32 v95, v95
    s_nop 0
    v_add_f32 v95, 1.0, v95
    v_rcp_f32 v95, v95
    s_nop 0
    v_mul_f32 v95, v67, v95
    v_cvt_pk_bf16_f32 v95, v95, v95
    v_lshlrev_b32 v95, 16, v95
    v_mul_f32 v93, v93, v94
    v_cvt_pk_bf16_f32 v93, v93, v93
    v_lshlrev_b32 v93, 16, v93
    v_fma_f32 v93, 2.0, v71, v93
    v_fma_f32 v43, v93, v95, v92
    buffer_store_dwordx4 v[40:43], v14, s[52:55], 0 offen offset:64
    s_nop 1
    ds_read_b128 v[72:75], v9 offset:2048
    ds_read_b128 v[76:79], v9 offset:34816
    ds_read_b128 v[80:83], v15 offset:2048
    ds_read_b128 v[84:87], v15 offset:34816
    s_waitcnt lgkmcnt(0)
    v_add_f32 v64, v72, v76
    v_add_f32 v88, v80, v84
    v_add_f32 v64, v64, v88
    v_add_f32 v65, v73, v77
    v_add_f32 v89, v81, v85
    v_add_f32 v65, v65, v89
    v_add_f32 v66, v74, v78
    v_add_f32 v90, v82, v86
    v_add_f32 v66, v66, v90
    v_add_f32 v67, v75, v79
    v_add_f32 v91, v83, v87
    v_add_f32 v67, v67, v91
    ds_read_b128 v[72:75], v9 offset:18432
    ds_read_b128 v[76:79], v9 offset:51200
    ds_read_b128 v[80:83], v15 offset:18432
    ds_read_b128 v[84:87], v15 offset:51200
    s_waitcnt lgkmcnt(0)
    v_add_f32 v68, v72, v76
    v_add_f32 v88, v80, v84
    v_add_f32 v68, v68, v88
    v_add_f32 v69, v73, v77
    v_add_f32 v89, v81, v85
    v_add_f32 v69, v69, v89
    v_add_f32 v70, v74, v78
    v_add_f32 v90, v82, v86
    v_add_f32 v70, v70, v90
    v_add_f32 v71, v75, v79
    v_add_f32 v91, v83, v87
    v_add_f32 v71, v71, v91
    v_lshlrev_b32 v92, 16, v20
    v_lshlrev_b32 v93, 16, v28
    v_lshlrev_b32 v94, 16, v36
    v_cvt_pk_bf16_f32 v64, v64, v64
    v_lshlrev_b32 v64, 16, v64
    v_mul_f32 v95, 0xbfb8aa3b, v64
    v_exp_f32 v95, v95
    s_nop 0
    v_add_f32 v95, 1.0, v95
    v_rcp_f32 v95, v95
    s_nop 0
    v_mul_f32 v95, v64, v95
    v_cvt_pk_bf16_f32 v95, v95, v95
    v_lshlrev_b32 v95, 16, v95
    v_mul_f32 v93, v93, v94
    v_cvt_pk_bf16_f32 v93, v93, v93
    v_lshlrev_b32 v93, 16, v93
    v_fma_f32 v93, 2.0, v68, v93
    v_fma_f32 v40, v93, v95, v92
    v_and_b32 v92, 0xffff0000, v20
    v_and_b32 v93, 0xffff0000, v28
    v_and_b32 v94, 0xffff0000, v36
    v_cvt_pk_bf16_f32 v65, v65, v65
    v_lshlrev_b32 v65, 16, v65
    v_mul_f32 v95, 0xbfb8aa3b, v65
    v_exp_f32 v95, v95
    s_nop 0
    v_add_f32 v95, 1.0, v95
    v_rcp_f32 v95, v95
    s_nop 0
    v_mul_f32 v95, v65, v95
    v_cvt_pk_bf16_f32 v95, v95, v95
    v_lshlrev_b32 v95, 16, v95
    v_mul_f32 v93, v93, v94
    v_cvt_pk_bf16_f32 v93, v93, v93
    v_lshlrev_b32 v93, 16, v93
    v_fma_f32 v93, 2.0, v69, v93
    v_fma_f32 v41, v93, v95, v92
    v_lshlrev_b32 v92, 16, v21
    v_lshlrev_b32 v93, 16, v29
    v_lshlrev_b32 v94, 16, v37
    v_cvt_pk_bf16_f32 v66, v66, v66
    v_lshlrev_b32 v66, 16, v66
    v_mul_f32 v95, 0xbfb8aa3b, v66
    v_exp_f32 v95, v95
    s_nop 0
    v_add_f32 v95, 1.0, v95
    v_rcp_f32 v95, v95
    s_nop 0
    v_mul_f32 v95, v66, v95
    v_cvt_pk_bf16_f32 v95, v95, v95
    v_lshlrev_b32 v95, 16, v95
    v_mul_f32 v93, v93, v94
    v_cvt_pk_bf16_f32 v93, v93, v93
    v_lshlrev_b32 v93, 16, v93
    v_fma_f32 v93, 2.0, v70, v93
    v_fma_f32 v42, v93, v95, v92
    v_and_b32 v92, 0xffff0000, v21
    v_and_b32 v93, 0xffff0000, v29
    v_and_b32 v94, 0xffff0000, v37
    v_cvt_pk_bf16_f32 v67, v67, v67
    v_lshlrev_b32 v67, 16, v67
    v_mul_f32 v95, 0xbfb8aa3b, v67
    v_exp_f32 v95, v95
    s_nop 0
    v_add_f32 v95, 1.0, v95
    v_rcp_f32 v95, v95
    s_nop 0
    v_mul_f32 v95, v67, v95
    v_cvt_pk_bf16_f32 v95, v95, v95
    v_lshlrev_b32 v95, 16, v95
    v_mul_f32 v93, v93, v94
    v_cvt_pk_bf16_f32 v93, v93, v93
    v_lshlrev_b32 v93, 16, v93
    v_fma_f32 v93, 2.0, v71, v93
    v_fma_f32 v43, v93, v95, v92
    buffer_store_dwordx4 v[40:43], v14, s[52:55], 0 offen offset:128
    s_nop 1
    ds_read_b128 v[72:75], v9 offset:3072
    ds_read_b128 v[76:79], v9 offset:35840
    ds_read_b128 v[80:83], v15 offset:3072
    ds_read_b128 v[84:87], v15 offset:35840
    s_waitcnt lgkmcnt(0)
    v_add_f32 v64, v72, v76
    v_add_f32 v88, v80, v84
    v_add_f32 v64, v64, v88
    v_add_f32 v65, v73, v77
    v_add_f32 v89, v81, v85
    v_add_f32 v65, v65, v89
    v_add_f32 v66, v74, v78
    v_add_f32 v90, v82, v86
    v_add_f32 v66, v66, v90
    v_add_f32 v67, v75, v79
    v_add_f32 v91, v83, v87
    v_add_f32 v67, v67, v91
    ds_read_b128 v[72:75], v9 offset:19456
    ds_read_b128 v[76:79], v9 offset:52224
    ds_read_b128 v[80:83], v15 offset:19456
    ds_read_b128 v[84:87], v15 offset:52224
    s_waitcnt lgkmcnt(0)
    v_add_f32 v68, v72, v76
    v_add_f32 v88, v80, v84
    v_add_f32 v68, v68, v88
    v_add_f32 v69, v73, v77
    v_add_f32 v89, v81, v85
    v_add_f32 v69, v69, v89
    v_add_f32 v70, v74, v78
    v_add_f32 v90, v82, v86
    v_add_f32 v70, v70, v90
    v_add_f32 v71, v75, v79
    v_add_f32 v91, v83, v87
    v_add_f32 v71, v71, v91
    v_lshlrev_b32 v92, 16, v22
    v_lshlrev_b32 v93, 16, v30
    v_lshlrev_b32 v94, 16, v38
    v_cvt_pk_bf16_f32 v64, v64, v64
    v_lshlrev_b32 v64, 16, v64
    v_mul_f32 v95, 0xbfb8aa3b, v64
    v_exp_f32 v95, v95
    s_nop 0
    v_add_f32 v95, 1.0, v95
    v_rcp_f32 v95, v95
    s_nop 0
    v_mul_f32 v95, v64, v95
    v_cvt_pk_bf16_f32 v95, v95, v95
    v_lshlrev_b32 v95, 16, v95
    v_mul_f32 v93, v93, v94
    v_cvt_pk_bf16_f32 v93, v93, v93
    v_lshlrev_b32 v93, 16, v93
    v_fma_f32 v93, 2.0, v68, v93
    v_fma_f32 v40, v93, v95, v92
    v_and_b32 v92, 0xffff0000, v22
    v_and_b32 v93, 0xffff0000, v30
    v_and_b32 v94, 0xffff0000, v38
    v_cvt_pk_bf16_f32 v65, v65, v65
    v_lshlrev_b32 v65, 16, v65
    v_mul_f32 v95, 0xbfb8aa3b, v65
    v_exp_f32 v95, v95
    s_nop 0
    v_add_f32 v95, 1.0, v95
    v_rcp_f32 v95, v95
    s_nop 0
    v_mul_f32 v95, v65, v95
    v_cvt_pk_bf16_f32 v95, v95, v95
    v_lshlrev_b32 v95, 16, v95
    v_mul_f32 v93, v93, v94
    v_cvt_pk_bf16_f32 v93, v93, v93
    v_lshlrev_b32 v93, 16, v93
    v_fma_f32 v93, 2.0, v69, v93
    v_fma_f32 v41, v93, v95, v92
    v_lshlrev_b32 v92, 16, v23
    v_lshlrev_b32 v93, 16, v31
    v_lshlrev_b32 v94, 16, v39
    v_cvt_pk_bf16_f32 v66, v66, v66
    v_lshlrev_b32 v66, 16, v66
    v_mul_f32 v95, 0xbfb8aa3b, v66
    v_exp_f32 v95, v95
    s_nop 0
    v_add_f32 v95, 1.0, v95
    v_rcp_f32 v95, v95
    s_nop 0
    v_mul_f32 v95, v66, v95
    v_cvt_pk_bf16_f32 v95, v95, v95
    v_lshlrev_b32 v95, 16, v95
    v_mul_f32 v93, v93, v94
    v_cvt_pk_bf16_f32 v93, v93, v93
    v_lshlrev_b32 v93, 16, v93
    v_fma_f32 v93, 2.0, v70, v93
    v_fma_f32 v42, v93, v95, v92
    v_and_b32 v92, 0xffff0000, v23
    v_and_b32 v93, 0xffff0000, v31
    v_and_b32 v94, 0xffff0000, v39
    v_cvt_pk_bf16_f32 v67, v67, v67
    v_lshlrev_b32 v67, 16, v67
    v_mul_f32 v95, 0xbfb8aa3b, v67
    v_exp_f32 v95, v95
    s_nop 0
    v_add_f32 v95, 1.0, v95
    v_rcp_f32 v95, v95
    s_nop 0
    v_mul_f32 v95, v67, v95
    v_cvt_pk_bf16_f32 v95, v95, v95
    v_lshlrev_b32 v95, 16, v95
    v_mul_f32 v93, v93, v94
    v_cvt_pk_bf16_f32 v93, v93, v93
    v_lshlrev_b32 v93, 16, v93
    v_fma_f32 v93, 2.0, v71, v93
    v_fma_f32 v43, v93, v95, v92
    buffer_store_dwordx4 v[40:43], v14, s[52:55], 0 offen offset:192
    s_nop 1
    s_endpgm
K3_EXIT:
    s_endpgm
.section .rodata,"a"
.p2align 6
.amdhsa_kernel k0_kernel
  .amdhsa_next_free_vgpr 160
  .amdhsa_next_free_sgpr 70
  .amdhsa_accum_offset 160
  .amdhsa_group_segment_fixed_size 0
  .amdhsa_kernarg_size 128
  .amdhsa_user_sgpr_count 2
  .amdhsa_user_sgpr_kernarg_segment_ptr 1
  .amdhsa_system_sgpr_workgroup_id_x 1
.end_amdhsa_kernel
.p2align 6
.amdhsa_kernel k1_kernel
  .amdhsa_next_free_vgpr 256
  .amdhsa_next_free_sgpr 70
  .amdhsa_accum_offset 128
  .amdhsa_group_segment_fixed_size 0
  .amdhsa_kernarg_size 128
  .amdhsa_user_sgpr_count 2
  .amdhsa_user_sgpr_kernarg_segment_ptr 1
  .amdhsa_system_sgpr_workgroup_id_x 1
.end_amdhsa_kernel
.p2align 6
.amdhsa_kernel k3_kernel
  .amdhsa_next_free_vgpr 256
  .amdhsa_next_free_sgpr 72
  .amdhsa_accum_offset 128
  .amdhsa_group_segment_fixed_size 0
  .amdhsa_kernarg_size 128
  .amdhsa_user_sgpr_count 2
  .amdhsa_user_sgpr_kernarg_segment_ptr 1
  .amdhsa_system_sgpr_workgroup_id_x 1
.end_amdhsa_kernel
```
